```python
import torch

def _softmax(x, axis=-1):
    return torch.softmax(x, dim=axis)
def _gelu(x):
    return torch.nn.functional.gelu(x, approximate="tanh")
def _silu(x):
    return torch.nn.functional.silu(x)
def _sigmoid(x):
    return torch.sigmoid(x)
def _layernorm(x, axis=-1, eps=1e-5):
    m = x.mean(dim=axis, keepdim=True)
    v = x.var(dim=axis, keepdim=True, unbiased=False)
    return (x - m) / torch.sqrt(v + eps)
def _scatter_add(tgt, idx, src, axis=0):
    return tgt.clone().index_add_(axis, idx, src)
def _segment_sum(src, seg, n):
    out = torch.zeros((n,) + src.shape[1:], dtype=src.dtype)
    return out.index_add_(0, seg, src)
def _pad(x, pw):
    flat = tuple(v for pair in reversed(pw) for v in pair)
    return torch.nn.functional.pad(x, flat)

kernel_name = 'parallel_sum__linear_attn_block__mixer_token_mlp__prompt'

def setup_inputs():

    _w = (lambda a: (lambda t: t.to(torch.bfloat16) if t.is_floating_point() else t)(torch.as_tensor(a)))
    def _A_setup():
        B, S, D = 1, 2048, 576
        return {
            "x": _w((lambda *s: torch.randn(*s, dtype=torch.bfloat16) * 0.05)(B, S, D)),
            "wqkv": _w((lambda *s: torch.randn(*s, dtype=torch.bfloat16) * 0.05)(D, 3 * D)),
            "wo": _w((lambda *s: torch.randn(*s, dtype=torch.bfloat16) * 0.05)(D, D)),
        }
    _A_in = _A_setup()

    def _B_setup():
        B, S, D, F = 1, 2048, 576, 4608
        return {
            "x": _w((lambda *s: torch.randn(*s, dtype=torch.bfloat16) * 0.05)(B, S, D)),
            "w1": _w((lambda *s: torch.randn(*s, dtype=torch.bfloat16) * 0.4)(S, F) * (S ** -0.5)),
            "b1": _w((lambda *s: torch.randn(*s, dtype=torch.bfloat16) * 3.2)(F) * 0.02),
            "w2": _w((lambda *s: torch.randn(*s, dtype=torch.bfloat16) * 0.2)(F, S) * (F ** -0.5)),
            "b2": _w((lambda *s: torch.randn(*s, dtype=torch.bfloat16) * 0.4)(S) * 0.02),
        }
    _B_in = _B_setup()

    return {
        "A_x": _A_in["x"],
        "A_wqkv": _A_in["wqkv"],
        "A_wo": _A_in["wo"],
        "B_x": _B_in["x"],
        "B_w1": _B_in["w1"],
        "B_b1": _B_in["b1"],
        "B_w2": _B_in["w2"],
        "B_b2": _B_in["b2"],
    }

def reference(A_x, A_wqkv, A_wo, B_x, B_w1, B_b1, B_w2, B_b2):
    def _A_ref(x, wqkv, wo):
        B, S, D = x.shape
        H = 32; Dh = D // H
        qkv = (lambda x, *d: x.permute(*d))((x @ wqkv).reshape(B, S, 3, H, Dh), 2, 0, 3, 1, 4)
        q, k, v = qkv[0], qkv[1], qkv[2]
        phi = lambda t: torch.where(t > 0, t + 1, torch.exp(t)) + 1e-6
        pq, pk = phi(q), phi(k)
        kv = torch.einsum("bhsd,bhse->bhde", pk, v)
        z = torch.einsum("bhsd->bhd", pk)
        num = torch.einsum("bhqd,bhde->bhqe", pq, kv)
        den = torch.einsum("bhqd,bhd->bhq", pq, z)[..., None] + 1e-6
        o = num / den
        return (lambda x, *d: x.permute(*d))(o, 0, 2, 1, 3).reshape(B, S, D) @ wo

    def _B_ref(x, w1, b1, w2, b2):
        B, S, D = x.shape
        h = _layernorm(x, axis=-1)
        u = torch.einsum("bsd,sf->bdf", h, w1) + b1
        u = _gelu(u)
        y = torch.einsum("bdf,fs->bds", u, w2) + b2
        return (lambda x, *d: x.permute(*d))(y, 0, 2, 1)

    x = A_x
    xn = _layernorm(x, axis=-1)
    return x + _A_ref(xn, A_wqkv, A_wo) + _B_ref(xn, B_w1, B_b1, B_w2, B_b2)
```

```asm
; @launch grid=(256,1,1) block=(512,1,1) lds=163840
.amdgcn_target "amdgcn-amd-amdhsa--gfx950"
.text
.globl parallel_sum__linear_attn_block__mixer_token_mlp__prompt_kernel
.p2align 8
.type parallel_sum__linear_attn_block__mixer_token_mlp__prompt_kernel,@function
parallel_sum__linear_attn_block__mixer_token_mlp__prompt_kernel:
  s_cmp_ge_u32 s2, 256
  s_cbranch_scc1 L_end
  s_load_dwordx4 s[4:7], s[0:1], 0
  s_load_dwordx2 s[8:9], s[0:1], 16
  s_load_dwordx8 s[72:79], s[0:1], 32
  s_load_dwordx2 s[10:11], s[0:1], 64
  s_load_dwordx2 s[12:13], s[0:1], 80
  v_lshrrev_b32 v2, 6, v0
  v_and_b32 v1, 63, v0
  v_readfirstlane_b32 s3, v2
  s_and_b32 s52, s2, 7
  s_lshr_b32 s53, s2, 3
  s_and_b32 s55, s2, 1
  v_mov_b32 v2, 163808
  v_mov_b32 v4, 0
  v_mov_b32 v5, 0
  v_mov_b32 v6, 0
  v_mov_b32 v7, 0
  v_and_b32 v3, 31, v0
  v_lshrrev_b32 v8, 5, v0
  v_cmp_gt_u32 s[70:71], 24, v3
  v_mov_b32 v60, 2147479552
  v_mul_u32_u24 v10, 1152, v8
  v_lshl_add_u32 v10, v3, 4, v10
  v_mov_b32 v11, 9216
  s_mul_i32 s85, s2, 9216
  v_cndmask_b32 v9, v11, v10, s[70:71]
  v_cndmask_b32 v10, v60, v10, s[70:71]
  s_waitcnt lgkmcnt(0)
  s_mov_b32 s36, s4
  s_and_b32 s37, s5, 0xffff
  s_mov_b32 s38, 2359296
  s_mov_b32 s39, 0x20000
  s_cmp_ge_u32 s3, 4
  s_cbranch_scc1 L_nox
  buffer_load_dwordx4 v[12:15], v10, s[36:39], s85 offen offset:0
  buffer_load_dwordx4 v[16:19], v10, s[36:39], s85 offen offset:384
  buffer_load_dwordx4 v[20:23], v10, s[36:39], s85 offen offset:768
L_nox:
  s_add_u32 s14, s12, 28049408
  s_addc_u32 s15, s13, 0
  s_load_dword s54, s[14:15], 0
  s_mov_b32 s16, s12
  s_and_b32 s17, s13, 0xffff
  s_mov_b32 s18, 67108864
  s_mov_b32 s19, 0x20000
  s_mov_b32 s20, s72
  s_and_b32 s21, s73, 0xffff
  s_mov_b32 s22, 18874368
  s_mov_b32 s23, 0x20000
  s_mov_b32 s28, s6
  s_and_b32 s29, s7, 0xffff
  s_mov_b32 s30, 1990656
  s_mov_b32 s31, 0x20000
  s_mov_b32 s24, s76
  s_and_b32 s25, s77, 0xffff
  s_mov_b32 s26, 18874368
  s_mov_b32 s27, 0x20000
  s_mov_b32 s32, s8
  s_and_b32 s33, s9, 0xffff
  s_mov_b32 s34, 663552
  s_mov_b32 s35, 0x20000
  s_mov_b32 s40, s74
  s_and_b32 s41, s75, 0xffff
  s_mov_b32 s42, 9216
  s_mov_b32 s43, 0x20000
  s_mov_b32 s44, s78
  s_and_b32 s45, s79, 0xffff
  s_mov_b32 s46, 4096
  s_mov_b32 s47, 0x20000
  s_mov_b32 s48, s10
  s_and_b32 s49, s11, 0xffff
  s_mov_b32 s50, 2359296
  s_mov_b32 s51, 0x20000
  s_cmp_ge_u32 s3, 4
  s_cbranch_scc1 L_loaders
  s_cmp_lg_u32 s3, 0
  s_cbranch_scc1 L_noinit
  ds_write_b128 v2, v[4:7]
  ds_write_b128 v2, v[4:7] offset:16
L_noinit:
  s_waitcnt lgkmcnt(0)
  s_barrier
  s_add_u32 s54, s54, 0x9e3779b9
  s_lshl_b32 s100, s54, 16
  s_and_b32 s100, s100, 0x9fff0000
  s_or_b32 s100, s100, 0x20000000
  s_and_b32 s101, s54, 0x9fff0000
  s_or_b32 s101, s101, 0x20000000
  v_lshlrev_b32 v4, 4, v0
  v_cmp_gt_u32 vcc, 32, v0
  v_mov_b32 v24, 0
  v_mov_b32 v25, 0
  v_mov_b32 v26, 0
  v_mov_b32 v27, 0
  v_cndmask_b32 v4, v60, v4, vcc
  s_lshl_b32 s74, s2, 9
  s_add_u32 s74, s74, 27262976
  buffer_store_dwordx4 v[24:27], v4, s[16:19], s74 offen sc1
  s_cmp_ge_u32 s53, 24
  s_cselect_b32 s72, 135168, 0
  v_add_u32 v11, s72, v9
  v_add_u32 v9, 153600, v9
  s_lshr_b32 s75, s2, 1
  s_lshl_b32 s75, s75, 10
  s_and_b32 s76, s2, 1
  s_lshl_b32 s76, s76, 7
  s_add_u32 s75, s75, s76
  s_add_u32 s75, s75, 2359296
  s_add_u32 s76, s75, 1048576
  s_add_u32 s77, s75, 2097152
  s_lshr_b32 s78, s2, 2
  s_mul_i32 s78, s78, 36864
  s_and_b32 s79, s2, 3
  s_lshl_b32 s79, s79, 8
  s_add_u32 s78, s78, s79
  s_add_u32 s78, s78, 0
  s_add_u32 s79, s78, 16384
  s_add_u32 s80, s78, 32768
  s_mov_b32 s81, 0x3ae38e39
  s_mov_b32 s82, 0x3727c5ac
  v_bfe_u32 v5, v1, 2, 2
  v_mul_u32_u24 v48, 1152, v5
  v_lshrrev_b32 v5, 5, v1
  v_lshl_add_u32 v48, v5, 6, v48
  v_and_b32 v5, 3, v1
  v_lshl_add_u32 v48, v5, 4, v48
  v_bfe_u32 v5, v1, 4, 1
  v_lshl_add_u32 v48, v5, 3, v48
  s_lshl_b32 s83, s3, 7
  s_add_u32 s83, s83, 153600
  v_add_u32 v48, s83, v48
  v_lshrrev_b32 v5, 4, v1
  v_lshlrev_b32 v49, 10, v5
  v_and_b32 v5, 15, v1
  v_lshl_add_u32 v49, v5, 4, v49
  s_lshl_b32 s83, s3, 12
  v_add_u32 v49, s83, v49
  v_and_b32 v5, 7, v0
  v_lshrrev_b32 v6, 3, v0
  v_mul_u32_u24 v50, 1152, v5
  v_lshl_add_u32 v50, v6, 4, v50
  v_add_u32 v50, s72, v50
  v_lshrrev_b32 v7, 2, v6
  v_lshlrev_b32 v51, 17, v7
  v_and_b32 v7, 3, v6
  v_lshl_add_u32 v51, v7, 8, v51
  v_lshl_add_u32 v51, v5, 4, v51
  s_waitcnt vmcnt(1)
  v_lshlrev_b32 v24, 16, v12
  v_and_b32 v25, 0xffff0000, v12
  v_lshlrev_b32 v26, 16, v13
  v_and_b32 v27, 0xffff0000, v13
  v_lshlrev_b32 v28, 16, v14
  v_and_b32 v29, 0xffff0000, v14
  v_lshlrev_b32 v30, 16, v15
  v_and_b32 v31, 0xffff0000, v15
  v_lshlrev_b32 v32, 16, v16
  v_and_b32 v33, 0xffff0000, v16
  v_lshlrev_b32 v34, 16, v17
  v_and_b32 v35, 0xffff0000, v17
  v_lshlrev_b32 v36, 16, v18
  v_and_b32 v37, 0xffff0000, v18
  v_lshlrev_b32 v38, 16, v19
  v_and_b32 v39, 0xffff0000, v19
  v_lshlrev_b32 v40, 16, v20
  v_and_b32 v41, 0xffff0000, v20
  v_lshlrev_b32 v42, 16, v21
  v_and_b32 v43, 0xffff0000, v21
  v_lshlrev_b32 v44, 16, v22
  v_and_b32 v45, 0xffff0000, v22
  v_lshlrev_b32 v46, 16, v23
  v_and_b32 v47, 0xffff0000, v23
  v_pk_add_f32 v[4:5], v[24:25], v[28:29]
  v_pk_add_f32 v[6:7], v[26:27], v[30:31]
  v_pk_add_f32 v[4:5], v[4:5], v[32:33]
  v_pk_add_f32 v[6:7], v[6:7], v[34:35]
  v_pk_add_f32 v[4:5], v[4:5], v[36:37]
  v_pk_add_f32 v[6:7], v[6:7], v[38:39]
  v_pk_add_f32 v[4:5], v[4:5], v[40:41]
  v_pk_add_f32 v[6:7], v[6:7], v[42:43]
  v_pk_add_f32 v[4:5], v[4:5], v[44:45]
  v_pk_add_f32 v[6:7], v[6:7], v[46:47]
  v_pk_add_f32 v[4:5], v[4:5], v[6:7]
  v_add_f32 v8, v4, v5
  s_nop 1
  v_add_f32_dpp v8, v8, v8 quad_perm:[1,0,3,2] row_mask:0xf bank_mask:0xf
  s_nop 1
  v_add_f32_dpp v8, v8, v8 quad_perm:[2,3,0,1] row_mask:0xf bank_mask:0xf
  s_nop 1
  v_add_f32_dpp v8, v8, v8 row_half_mirror row_mask:0xf bank_mask:0xf
  s_nop 1
  v_add_f32_dpp v8, v8, v8 row_mirror row_mask:0xf bank_mask:0xf
  s_nop 1
  v_mov_b32 v4, v8
  s_nop 1
  v_permlane16_swap_b32 v8, v4
  s_nop 1
  v_add_f32 v8, v8, v4
  v_mul_f32 v8, s81, v8
  v_pk_add_f32 v[24:25], v[24:25], v[8:9] op_sel_hi:[1,0] neg_lo:[0,1] neg_hi:[0,1]
  v_pk_add_f32 v[26:27], v[26:27], v[8:9] op_sel_hi:[1,0] neg_lo:[0,1] neg_hi:[0,1]
  v_pk_add_f32 v[28:29], v[28:29], v[8:9] op_sel_hi:[1,0] neg_lo:[0,1] neg_hi:[0,1]
  v_pk_add_f32 v[30:31], v[30:31], v[8:9] op_sel_hi:[1,0] neg_lo:[0,1] neg_hi:[0,1]
  v_pk_add_f32 v[32:33], v[32:33], v[8:9] op_sel_hi:[1,0] neg_lo:[0,1] neg_hi:[0,1]
  v_pk_add_f32 v[34:35], v[34:35], v[8:9] op_sel_hi:[1,0] neg_lo:[0,1] neg_hi:[0,1]
  v_pk_add_f32 v[36:37], v[36:37], v[8:9] op_sel_hi:[1,0] neg_lo:[0,1] neg_hi:[0,1]
  v_pk_add_f32 v[38:39], v[38:39], v[8:9] op_sel_hi:[1,0] neg_lo:[0,1] neg_hi:[0,1]
  v_pk_add_f32 v[40:41], v[40:41], v[8:9] op_sel_hi:[1,0] neg_lo:[0,1] neg_hi:[0,1]
  v_pk_add_f32 v[42:43], v[42:43], v[8:9] op_sel_hi:[1,0] neg_lo:[0,1] neg_hi:[0,1]
  v_pk_add_f32 v[44:45], v[44:45], v[8:9] op_sel_hi:[1,0] neg_lo:[0,1] neg_hi:[0,1]
  v_pk_add_f32 v[46:47], v[46:47], v[8:9] op_sel_hi:[1,0] neg_lo:[0,1] neg_hi:[0,1]
  v_pk_mul_f32 v[4:5], v[24:25], v[24:25]
  v_pk_mul_f32 v[6:7], v[26:27], v[26:27]
  v_pk_fma_f32 v[4:5], v[28:29], v[28:29], v[4:5]
  v_pk_fma_f32 v[6:7], v[30:31], v[30:31], v[6:7]
  v_pk_fma_f32 v[4:5], v[32:33], v[32:33], v[4:5]
  v_pk_fma_f32 v[6:7], v[34:35], v[34:35], v[6:7]
  v_pk_fma_f32 v[4:5], v[36:37], v[36:37], v[4:5]
  v_pk_fma_f32 v[6:7], v[38:39], v[38:39], v[6:7]
  v_pk_fma_f32 v[4:5], v[40:41], v[40:41], v[4:5]
  v_pk_fma_f32 v[6:7], v[42:43], v[42:43], v[6:7]
  v_pk_fma_f32 v[4:5], v[44:45], v[44:45], v[4:5]
  v_pk_fma_f32 v[6:7], v[46:47], v[46:47], v[6:7]
  v_pk_add_f32 v[4:5], v[4:5], v[6:7]
  v_add_f32 v8, v4, v5
  v_cndmask_b32 v8, 0, v8, s[70:71]
  s_nop 1
  v_add_f32_dpp v8, v8, v8 quad_perm:[1,0,3,2] row_mask:0xf bank_mask:0xf
  s_nop 1
  v_add_f32_dpp v8, v8, v8 quad_perm:[2,3,0,1] row_mask:0xf bank_mask:0xf
  s_nop 1
  v_add_f32_dpp v8, v8, v8 row_half_mirror row_mask:0xf bank_mask:0xf
  s_nop 1
  v_add_f32_dpp v8, v8, v8 row_mirror row_mask:0xf bank_mask:0xf
  s_nop 1
  v_mov_b32 v4, v8
  s_nop 1
  v_permlane16_swap_b32 v8, v4
  s_nop 1
  v_add_f32 v8, v8, v4
  v_mov_b32 v4, s82
  v_fmac_f32 v4, s81, v8
  v_rsq_f32 v8, v4
  s_nop 0
  v_cndmask_b32 v8, 0, v8, s[70:71]
  v_pk_mul_f32 v[24:25], v[24:25], v[8:9] op_sel_hi:[1,0]
  v_pk_mul_f32 v[26:27], v[26:27], v[8:9] op_sel_hi:[1,0]
  v_pk_mul_f32 v[28:29], v[28:29], v[8:9] op_sel_hi:[1,0]
  v_pk_mul_f32 v[30:31], v[30:31], v[8:9] op_sel_hi:[1,0]
  v_pk_mul_f32 v[32:33], v[32:33], v[8:9] op_sel_hi:[1,0]
  v_pk_mul_f32 v[34:35], v[34:35], v[8:9] op_sel_hi:[1,0]
  v_pk_mul_f32 v[36:37], v[36:37], v[8:9] op_sel_hi:[1,0]
  v_pk_mul_f32 v[38:39], v[38:39], v[8:9] op_sel_hi:[1,0]
  v_pk_mul_f32 v[40:41], v[40:41], v[8:9] op_sel_hi:[1,0]
  v_pk_mul_f32 v[42:43], v[42:43], v[8:9] op_sel_hi:[1,0]
  v_pk_mul_f32 v[44:45], v[44:45], v[8:9] op_sel_hi:[1,0]
  v_pk_mul_f32 v[46:47], v[46:47], v[8:9] op_sel_hi:[1,0]
  v_cvt_pk_bf16_f32 v12, v24, v25
  v_cvt_pk_bf16_f32 v13, v26, v27
  v_cvt_pk_bf16_f32 v14, v28, v29
  v_cvt_pk_bf16_f32 v15, v30, v31
  v_cvt_pk_bf16_f32 v16, v32, v33
  v_cvt_pk_bf16_f32 v17, v34, v35
  v_cvt_pk_bf16_f32 v18, v36, v37
  v_cvt_pk_bf16_f32 v19, v38, v39
  v_cvt_pk_bf16_f32 v20, v40, v41
  v_cvt_pk_bf16_f32 v21, v42, v43
  v_cvt_pk_bf16_f32 v22, v44, v45
  v_cvt_pk_bf16_f32 v23, v46, v47
  ds_write_b128 v11, v[12:15] offset:0
  ds_write_b128 v11, v[16:19] offset:384
  ds_write_b128 v11, v[20:23] offset:768
  v_lshlrev_b32 v24, 16, v12
  v_and_b32 v25, 0xffff0000, v12
  v_lshlrev_b32 v26, 16, v13
  v_and_b32 v27, 0xffff0000, v13
  v_lshlrev_b32 v28, 16, v14
  v_and_b32 v29, 0xffff0000, v14
  v_lshlrev_b32 v30, 16, v15
  v_and_b32 v31, 0xffff0000, v15
  v_lshlrev_b32 v32, 16, v16
  v_and_b32 v33, 0xffff0000, v16
  v_lshlrev_b32 v34, 16, v17
  v_and_b32 v35, 0xffff0000, v17
  v_lshlrev_b32 v36, 16, v18
  v_and_b32 v37, 0xffff0000, v18
  v_lshlrev_b32 v38, 16, v19
  v_and_b32 v39, 0xffff0000, v19
  v_lshlrev_b32 v40, 16, v20
  v_and_b32 v41, 0xffff0000, v20
  v_lshlrev_b32 v42, 16, v21
  v_and_b32 v43, 0xffff0000, v21
  v_lshlrev_b32 v44, 16, v22
  v_and_b32 v45, 0xffff0000, v22
  v_lshlrev_b32 v46, 16, v23
  v_and_b32 v47, 0xffff0000, v23
  v_pk_add_f32 v[4:5], v[24:25], v[28:29]
  v_pk_add_f32 v[6:7], v[26:27], v[30:31]
  v_pk_add_f32 v[4:5], v[4:5], v[32:33]
  v_pk_add_f32 v[6:7], v[6:7], v[34:35]
  v_pk_add_f32 v[4:5], v[4:5], v[36:37]
  v_pk_add_f32 v[6:7], v[6:7], v[38:39]
  v_pk_add_f32 v[4:5], v[4:5], v[40:41]
  v_pk_add_f32 v[6:7], v[6:7], v[42:43]
  v_pk_add_f32 v[4:5], v[4:5], v[44:45]
  v_pk_add_f32 v[6:7], v[6:7], v[46:47]
  v_pk_add_f32 v[4:5], v[4:5], v[6:7]
  v_add_f32 v8, v4, v5
  v_pk_mul_f32 v[54:55], v[24:25], v[24:25]
  v_pk_mul_f32 v[56:57], v[26:27], v[26:27]
  v_pk_fma_f32 v[54:55], v[28:29], v[28:29], v[54:55]
  v_pk_fma_f32 v[56:57], v[30:31], v[30:31], v[56:57]
  v_pk_fma_f32 v[54:55], v[32:33], v[32:33], v[54:55]
  v_pk_fma_f32 v[56:57], v[34:35], v[34:35], v[56:57]
  v_pk_fma_f32 v[54:55], v[36:37], v[36:37], v[54:55]
  v_pk_fma_f32 v[56:57], v[38:39], v[38:39], v[56:57]
  v_pk_fma_f32 v[54:55], v[40:41], v[40:41], v[54:55]
  v_pk_fma_f32 v[56:57], v[42:43], v[42:43], v[56:57]
  v_pk_fma_f32 v[54:55], v[44:45], v[44:45], v[54:55]
  v_pk_fma_f32 v[56:57], v[46:47], v[46:47], v[56:57]
  v_pk_add_f32 v[54:55], v[54:55], v[56:57]
  v_add_f32 v52, v54, v55
  s_nop 0
  v_add_f32_dpp v8, v8, v8 quad_perm:[1,0,3,2] row_mask:0xf bank_mask:0xf
  v_add_f32_dpp v52, v52, v52 quad_perm:[1,0,3,2] row_mask:0xf bank_mask:0xf
  s_nop 0
  v_add_f32_dpp v8, v8, v8 quad_perm:[2,3,0,1] row_mask:0xf bank_mask:0xf
  v_add_f32_dpp v52, v52, v52 quad_perm:[2,3,0,1] row_mask:0xf bank_mask:0xf
  s_nop 0
  v_add_f32_dpp v8, v8, v8 row_half_mirror row_mask:0xf bank_mask:0xf
  v_add_f32_dpp v52, v52, v52 row_half_mirror row_mask:0xf bank_mask:0xf
  s_nop 0
  v_add_f32_dpp v8, v8, v8 row_mirror row_mask:0xf bank_mask:0xf
  v_add_f32_dpp v52, v52, v52 row_mirror row_mask:0xf bank_mask:0xf
  s_nop 0
  v_mov_b32 v4, v8
  v_mov_b32 v5, v52
  s_nop 0
  v_permlane16_swap_b32 v8, v4
  v_permlane16_swap_b32 v52, v5
  s_nop 0
  v_add_f32 v8, v8, v4
  v_add_f32 v52, v52, v5
  v_mul_f32 v8, s81, v8
  v_mov_b32 v4, s82
  v_fmac_f32 v4, s81, v52
  v_fma_f32 v4, -v8, v8, v4
  v_max_f32 v4, s82, v4
  v_rsq_f32 v52, v4
  s_nop 0
  v_mul_f32 v8, v8, v52
  v_pk_fma_f32 v[24:25], v[24:25], v[52:53], v[8:9] op_sel_hi:[1,0,0] neg_lo:[0,0,1] neg_hi:[0,0,1]
  v_pk_fma_f32 v[26:27], v[26:27], v[52:53], v[8:9] op_sel_hi:[1,0,0] neg_lo:[0,0,1] neg_hi:[0,0,1]
  v_pk_fma_f32 v[28:29], v[28:29], v[52:53], v[8:9] op_sel_hi:[1,0,0] neg_lo:[0,0,1] neg_hi:[0,0,1]
  v_pk_fma_f32 v[30:31], v[30:31], v[52:53], v[8:9] op_sel_hi:[1,0,0] neg_lo:[0,0,1] neg_hi:[0,0,1]
  v_pk_fma_f32 v[32:33], v[32:33], v[52:53], v[8:9] op_sel_hi:[1,0,0] neg_lo:[0,0,1] neg_hi:[0,0,1]
  v_pk_fma_f32 v[34:35], v[34:35], v[52:53], v[8:9] op_sel_hi:[1,0,0] neg_lo:[0,0,1] neg_hi:[0,0,1]
  v_pk_fma_f32 v[36:37], v[36:37], v[52:53], v[8:9] op_sel_hi:[1,0,0] neg_lo:[0,0,1] neg_hi:[0,0,1]
  v_pk_fma_f32 v[38:39], v[38:39], v[52:53], v[8:9] op_sel_hi:[1,0,0] neg_lo:[0,0,1] neg_hi:[0,0,1]
  v_pk_fma_f32 v[40:41], v[40:41], v[52:53], v[8:9] op_sel_hi:[1,0,0] neg_lo:[0,0,1] neg_hi:[0,0,1]
  v_pk_fma_f32 v[42:43], v[42:43], v[52:53], v[8:9] op_sel_hi:[1,0,0] neg_lo:[0,0,1] neg_hi:[0,0,1]
  v_pk_fma_f32 v[44:45], v[44:45], v[52:53], v[8:9] op_sel_hi:[1,0,0] neg_lo:[0,0,1] neg_hi:[0,0,1]
  v_pk_fma_f32 v[46:47], v[46:47], v[52:53], v[8:9] op_sel_hi:[1,0,0] neg_lo:[0,0,1] neg_hi:[0,0,1]
  v_cvt_pk_bf16_f32 v12, v24, v25
  v_cvt_pk_bf16_f32 v13, v26, v27
  v_cvt_pk_bf16_f32 v14, v28, v29
  v_cvt_pk_bf16_f32 v15, v30, v31
  v_cvt_pk_bf16_f32 v16, v32, v33
  v_cvt_pk_bf16_f32 v17, v34, v35
  v_cvt_pk_bf16_f32 v18, v36, v37
  v_cvt_pk_bf16_f32 v19, v38, v39
  v_cvt_pk_bf16_f32 v20, v40, v41
  v_cvt_pk_bf16_f32 v21, v42, v43
  v_cvt_pk_bf16_f32 v22, v44, v45
  v_cvt_pk_bf16_f32 v23, v46, v47
  ds_write_b128 v9, v[12:15] offset:0
  ds_write_b128 v9, v[16:19] offset:384
  ds_write_b128 v9, v[20:23] offset:768
  s_waitcnt lgkmcnt(0)
  v_mov_b32 v4, 163820
  v_mov_b32 v5, 1
  s_mov_b64 exec, 1
  ds_add_u32 v4, v5
  s_mov_b64 exec, -1
  v_mov_b32 v4, 163820
  s_mov_b32 s68, 0x80000
L_ln_sync:
  ds_read_b32 v5, v4
  s_sub_u32 s68, s68, 1
  s_cmp_eq_u32 s68, 0
  s_cbranch_scc1 L_ln_sync_x
  s_waitcnt lgkmcnt(0)
  v_readfirstlane_b32 s67, v5
  s_cmp_ge_u32 s67, 4
  s_cbranch_scc1 L_ln_sync_x
  s_branch L_ln_sync
L_ln_sync_x:
  s_waitcnt lgkmcnt(0)
  ds_read_b64_tr_b16 v[24:25], v48 offset:0
  ds_read_b64_tr_b16 v[26:27], v48 offset:4608
  ds_read_b64_tr_b16 v[28:29], v48 offset:512
  ds_read_b64_tr_b16 v[30:31], v48 offset:5120
  ds_read_b64_tr_b16 v[32:33], v48 offset:1024
  ds_read_b64_tr_b16 v[34:35], v48 offset:5632
  ds_read_b128 v[12:15], v50 offset:0
  ds_read_b128 v[16:19], v50 offset:512
  ds_read_b128 v[20:23], v50 offset:1024
  s_waitcnt lgkmcnt(7)
  buffer_store_dwordx4 v[24:27], v49, s[16:19], s78 offen sc1
  s_waitcnt lgkmcnt(5)
  buffer_store_dwordx4 v[28:31], v49, s[16:19], s79 offen sc1
  s_waitcnt lgkmcnt(2)
  buffer_store_dwordx4 v[12:15], v51, s[16:19], s75 offen sc1
  s_waitcnt lgkmcnt(1)
  buffer_store_dwordx4 v[16:19], v51, s[16:19], s76 offen sc1
  s_cmp_lg_u32 s3, 0
  s_cbranch_scc1 L_ln_skip
  s_waitcnt lgkmcnt(0)
  buffer_store_dwordx4 v[32:35], v49, s[16:19], s80 offen sc1
  buffer_store_dwordx4 v[20:23], v51, s[16:19], s77 offen sc1
L_ln_skip:
  s_waitcnt lgkmcnt(0)
  s_waitcnt vmcnt(0)
  v_mov_b32 v4, 163808
  v_mov_b32 v5, 1
  s_mov_b64 exec, 1
  ds_add_rtn_u32 v5, v4, v5
  s_lshl_b32 s67, s2, 7
  s_add_u32 s67, s67, 27525120
  s_waitcnt lgkmcnt(0)
  v_readfirstlane_b32 s68, v5
  s_mov_b64 exec, -1
  s_cmp_lg_u32 s68, 3
  s_cbranch_scc1 L_pub0
  v_mov_b32 v4, s54
  v_lshlrev_b32 v5, 2, v1
  s_mov_b64 exec, 1
  buffer_store_dword v4, v5, s[16:19], s67 offen sc1
  s_mov_b64 exec, -1
L_pub0:
  s_cmp_ge_u32 s53, 24
  s_cbranch_scc1 L_kv_cons
  s_and_b32 s71, s53, 3
  s_lshr_b32 s72, s53, 2
  s_mul_i32 s73, s52, 6
  s_add_u32 s73, s73, s72
  v_lshrrev_b32 v10, 4, v1
  v_bfe_u32 v11, v1, 2, 2
  v_and_b32 v12, 3, v1
  s_and_b32 s74, s3, 1
  s_lshr_b32 s75, s3, 1
  v_lshlrev_b32 v13, 3, v10
  s_mul_i32 s67, s73, 192
  s_mul_i32 s68, s75, 96
  s_add_u32 s67, s67, s68
  buffer_load_dwordx2 v[220:221], v13, s[40:43], s67 offen offset:0
  buffer_load_dwordx2 v[222:223], v13, s[40:43], s67 offen offset:32
  buffer_load_dwordx2 v[224:225], v13, s[40:43], s67 offen offset:64
  v_lshl_add_u32 v13, v10, 3, v11
  v_mul_u32_u24 v13, 192, v13
  v_lshl_add_u32 v13, v12, 3, v13
  s_mul_i32 s67, s74, 6144
  s_add_u32 s67, s67, 18432
  v_add_u32 v13, s67, v13
  v_and_b32 v14, 1, v10
  s_mul_i32 s67, s75, 3
  s_add_u32 s67, s67, 0
  v_xor_b32 v15, s67, v14
  v_lshl_add_u32 v2, v15, 5, v13
  s_mul_i32 s67, s75, 3
  s_add_u32 s67, s67, 1
  v_xor_b32 v15, s67, v14
  v_lshl_add_u32 v3, v15, 5, v13
  v_lshlrev_b32 v5, 4, v1
  s_mul_i32 s67, s74, 9216
  v_add_u32 v4, s67, v5
  s_mul_i32 s67, s75, 6
  s_add_u32 s67, s67, s74
  s_lshl_b32 s67, s67, 10
  v_add_u32 v5, s67, v5
  v_add_u32 v6, 61440, v5
  s_mov_b32 s60, 0
  s_cmp_eq_u32 s74, 0
  s_cselect_b32 s67, -1, 0
  s_waitcnt vmcnt(0)
  v_and_b32 v220, s67, v220
  v_and_b32 v221, s67, v221
  v_and_b32 v222, s67, v222
  v_and_b32 v223, s67, v223
  v_and_b32 v224, s67, v224
  v_and_b32 v225, s67, v225
  v_lshlrev_b32 v16, 16, v220
  v_and_b32 v17, 0xffff0000, v220
  v_lshlrev_b32 v18, 16, v221
  v_and_b32 v19, 0xffff0000, v221
  v_lshlrev_b32 v20, 16, v222
  v_and_b32 v21, 0xffff0000, v222
  v_lshlrev_b32 v22, 16, v223
  v_and_b32 v23, 0xffff0000, v223
  v_lshlrev_b32 v24, 16, v224
  v_and_b32 v25, 0xffff0000, v224
  v_lshlrev_b32 v26, 16, v225
  v_and_b32 v27, 0xffff0000, v225
  v_lshlrev_b32 v28, 16, v220
  v_and_b32 v29, 0xffff0000, v220
  v_lshlrev_b32 v30, 16, v221
  v_and_b32 v31, 0xffff0000, v221
  v_lshlrev_b32 v32, 16, v222
  v_and_b32 v33, 0xffff0000, v222
  v_lshlrev_b32 v34, 16, v223
  v_and_b32 v35, 0xffff0000, v223
  v_lshlrev_b32 v36, 16, v224
  v_and_b32 v37, 0xffff0000, v224
  v_lshlrev_b32 v38, 16, v225
  v_and_b32 v39, 0xffff0000, v225
  v_lshlrev_b32 v40, 16, v220
  v_and_b32 v41, 0xffff0000, v220
  v_lshlrev_b32 v42, 16, v221
  v_and_b32 v43, 0xffff0000, v221
  v_lshlrev_b32 v44, 16, v222
  v_and_b32 v45, 0xffff0000, v222
  v_lshlrev_b32 v46, 16, v223
  v_and_b32 v47, 0xffff0000, v223
  v_lshlrev_b32 v48, 16, v224
  v_and_b32 v49, 0xffff0000, v224
  v_lshlrev_b32 v50, 16, v225
  v_and_b32 v51, 0xffff0000, v225
  v_lshlrev_b32 v52, 16, v220
  v_and_b32 v53, 0xffff0000, v220
  v_lshlrev_b32 v54, 16, v221
  v_and_b32 v55, 0xffff0000, v221
  v_lshlrev_b32 v56, 16, v222
  v_and_b32 v57, 0xffff0000, v222
  v_lshlrev_b32 v58, 16, v223
  v_and_b32 v59, 0xffff0000, v223
  v_lshlrev_b32 v60, 16, v224
  v_and_b32 v61, 0xffff0000, v224
  v_lshlrev_b32 v62, 16, v225
  v_and_b32 v63, 0xffff0000, v225
  v_lshlrev_b32 v64, 16, v220
  v_and_b32 v65, 0xffff0000, v220
  v_lshlrev_b32 v66, 16, v221
  v_and_b32 v67, 0xffff0000, v221
  v_lshlrev_b32 v68, 16, v222
  v_and_b32 v69, 0xffff0000, v222
  v_lshlrev_b32 v70, 16, v223
  v_and_b32 v71, 0xffff0000, v223
  v_lshlrev_b32 v72, 16, v224
  v_and_b32 v73, 0xffff0000, v224
  v_lshlrev_b32 v74, 16, v225
  v_and_b32 v75, 0xffff0000, v225
  v_lshlrev_b32 v76, 16, v220
  v_and_b32 v77, 0xffff0000, v220
  v_lshlrev_b32 v78, 16, v221
  v_and_b32 v79, 0xffff0000, v221
  v_lshlrev_b32 v80, 16, v222
  v_and_b32 v81, 0xffff0000, v222
  v_lshlrev_b32 v82, 16, v223
  v_and_b32 v83, 0xffff0000, v223
  v_lshlrev_b32 v84, 16, v224
  v_and_b32 v85, 0xffff0000, v224
  v_lshlrev_b32 v86, 16, v225
  v_and_b32 v87, 0xffff0000, v225
  v_lshlrev_b32 v88, 16, v220
  v_and_b32 v89, 0xffff0000, v220
  v_lshlrev_b32 v90, 16, v221
  v_and_b32 v91, 0xffff0000, v221
  v_lshlrev_b32 v92, 16, v222
  v_and_b32 v93, 0xffff0000, v222
  v_lshlrev_b32 v94, 16, v223
  v_and_b32 v95, 0xffff0000, v223
  v_lshlrev_b32 v96, 16, v224
  v_and_b32 v97, 0xffff0000, v224
  v_lshlrev_b32 v98, 16, v225
  v_and_b32 v99, 0xffff0000, v225
  v_lshlrev_b32 v100, 16, v220
  v_and_b32 v101, 0xffff0000, v220
  v_lshlrev_b32 v102, 16, v221
  v_and_b32 v103, 0xffff0000, v221
  v_lshlrev_b32 v104, 16, v222
  v_and_b32 v105, 0xffff0000, v222
  v_lshlrev_b32 v106, 16, v223
  v_and_b32 v107, 0xffff0000, v223
  v_lshlrev_b32 v108, 16, v224
  v_and_b32 v109, 0xffff0000, v224
  v_lshlrev_b32 v110, 16, v225
  v_and_b32 v111, 0xffff0000, v225
  v_lshlrev_b32 v112, 16, v220
  v_and_b32 v113, 0xffff0000, v220
  v_lshlrev_b32 v114, 16, v221
  v_and_b32 v115, 0xffff0000, v221
  v_lshlrev_b32 v116, 16, v222
  v_and_b32 v117, 0xffff0000, v222
  v_lshlrev_b32 v118, 16, v223
  v_and_b32 v119, 0xffff0000, v223
  v_lshlrev_b32 v120, 16, v224
  v_and_b32 v121, 0xffff0000, v224
  v_lshlrev_b32 v122, 16, v225
  v_and_b32 v123, 0xffff0000, v225
  s_barrier
  s_barrier
  ds_read_b64_tr_b16 v[124:125], v2 offset:0
  ds_read_b64_tr_b16 v[126:127], v2 offset:768
  ds_read_b128 v[136:139], v4 offset:0
  ds_read_b64_tr_b16 v[128:129], v3 offset:0
  ds_read_b64_tr_b16 v[130:131], v3 offset:768
  ds_read_b64_tr_b16 v[132:133], v2 offset:64
  ds_read_b64_tr_b16 v[134:135], v2 offset:832
  ds_read_b128 v[140:143], v4 offset:1024
  ds_read_b128 v[144:147], v4 offset:2048
  ds_read_b128 v[148:151], v4 offset:3072
  ds_read_b128 v[152:155], v4 offset:4096
  ds_read_b128 v[156:159], v4 offset:5120
  ds_read_b128 v[160:163], v4 offset:6144
  ds_read_b128 v[164:167], v4 offset:7168
  ds_read_b128 v[168:171], v4 offset:8192
  s_add_u32 s69, s60, 30720
  s_cmp_eq_u32 s69, 153600
  s_cselect_b32 s69, 0, s69
  s_sub_u32 s60, s69, s60
  v_add_u32 v2, s60, v2
  v_add_u32 v3, s60, v3
  v_add_u32 v4, s60, v4
  s_mov_b32 s60, s69
  s_mov_b32 s61, 15
L_g1_main:
  s_waitcnt lgkmcnt(0)
  v_mfma_f32_16x16x32_bf16 v[16:19], v[124:127], v[136:139], v[16:19]
  s_barrier
  v_mfma_f32_16x16x32_bf16 v[20:23], v[128:131], v[136:139], v[20:23]
  ds_read_b64_tr_b16 v[172:173], v2 offset:0
  v_mfma_f32_16x16x32_bf16 v[24:27], v[132:135], v[136:139], v[24:27]
  ds_read_b64_tr_b16 v[174:175], v2 offset:768
  v_mfma_f32_16x16x32_bf16 v[28:31], v[124:127], v[140:143], v[28:31]
  ds_read_b128 v[184:187], v4 offset:0
  v_mfma_f32_16x16x32_bf16 v[32:35], v[128:131], v[140:143], v[32:35]
  ds_read_b64_tr_b16 v[176:177], v3 offset:0
  v_mfma_f32_16x16x32_bf16 v[36:39], v[132:135], v[140:143], v[36:39]
  ds_read_b64_tr_b16 v[178:179], v3 offset:768
  v_mfma_f32_16x16x32_bf16 v[40:43], v[124:127], v[144:147], v[40:43]
  ds_read_b64_tr_b16 v[180:181], v2 offset:64
  v_mfma_f32_16x16x32_bf16 v[44:47], v[128:131], v[144:147], v[44:47]
  ds_read_b64_tr_b16 v[182:183], v2 offset:832
  v_mfma_f32_16x16x32_bf16 v[48:51], v[132:135], v[144:147], v[48:51]
  ds_read_b128 v[188:191], v4 offset:1024
  v_mfma_f32_16x16x32_bf16 v[52:55], v[124:127], v[148:151], v[52:55]
  ds_read_b128 v[192:195], v4 offset:2048
  v_mfma_f32_16x16x32_bf16 v[56:59], v[128:131], v[148:151], v[56:59]
  ds_read_b128 v[196:199], v4 offset:3072
  v_mfma_f32_16x16x32_bf16 v[60:63], v[132:135], v[148:151], v[60:63]
  ds_read_b128 v[200:203], v4 offset:4096
  v_mfma_f32_16x16x32_bf16 v[64:67], v[124:127], v[152:155], v[64:67]
  ds_read_b128 v[204:207], v4 offset:5120
  v_mfma_f32_16x16x32_bf16 v[68:71], v[128:131], v[152:155], v[68:71]
  ds_read_b128 v[208:211], v4 offset:6144
  v_mfma_f32_16x16x32_bf16 v[72:75], v[132:135], v[152:155], v[72:75]
  ds_read_b128 v[212:215], v4 offset:7168
  v_mfma_f32_16x16x32_bf16 v[76:79], v[124:127], v[156:159], v[76:79]
  ds_read_b128 v[216:219], v4 offset:8192
  v_mfma_f32_16x16x32_bf16 v[80:83], v[128:131], v[156:159], v[80:83]
  s_add_u32 s69, s60, 30720
  s_cmp_eq_u32 s69, 153600
  v_mfma_f32_16x16x32_bf16 v[84:87], v[132:135], v[156:159], v[84:87]
  s_cselect_b32 s69, 0, s69
  s_sub_u32 s60, s69, s60
  v_mfma_f32_16x16x32_bf16 v[88:91], v[124:127], v[160:163], v[88:91]
  v_add_u32 v2, s60, v2
  v_add_u32 v3, s60, v3
  v_mfma_f32_16x16x32_bf16 v[92:95], v[128:131], v[160:163], v[92:95]
  v_add_u32 v4, s60, v4
  s_mov_b32 s60, s69
  v_mfma_f32_16x16x32_bf16 v[96:99], v[132:135], v[160:163], v[96:99]
  v_mfma_f32_16x16x32_bf16 v[100:103], v[124:127], v[164:167], v[100:103]
  v_mfma_f32_16x16x32_bf16 v[104:107], v[128:131], v[164:167], v[104:107]
  v_mfma_f32_16x16x32_bf16 v[108:111], v[132:135], v[164:167], v[108:111]
  v_mfma_f32_16x16x32_bf16 v[112:115], v[124:127], v[168:171], v[112:115]
  v_mfma_f32_16x16x32_bf16 v[116:119], v[128:131], v[168:171], v[116:119]
  v_mfma_f32_16x16x32_bf16 v[120:123], v[132:135], v[168:171], v[120:123]
  s_waitcnt lgkmcnt(0)
  v_mfma_f32_16x16x32_bf16 v[16:19], v[172:175], v[184:187], v[16:19]
  s_barrier
  v_mfma_f32_16x16x32_bf16 v[20:23], v[176:179], v[184:187], v[20:23]
  ds_read_b64_tr_b16 v[124:125], v2 offset:0
  v_mfma_f32_16x16x32_bf16 v[24:27], v[180:183], v[184:187], v[24:27]
  ds_read_b64_tr_b16 v[126:127], v2 offset:768
  v_mfma_f32_16x16x32_bf16 v[28:31], v[172:175], v[188:191], v[28:31]
  ds_read_b128 v[136:139], v4 offset:0
  v_mfma_f32_16x16x32_bf16 v[32:35], v[176:179], v[188:191], v[32:35]
  ds_read_b64_tr_b16 v[128:129], v3 offset:0
  v_mfma_f32_16x16x32_bf16 v[36:39], v[180:183], v[188:191], v[36:39]
  ds_read_b64_tr_b16 v[130:131], v3 offset:768
  v_mfma_f32_16x16x32_bf16 v[40:43], v[172:175], v[192:195], v[40:43]
  ds_read_b64_tr_b16 v[132:133], v2 offset:64
  v_mfma_f32_16x16x32_bf16 v[44:47], v[176:179], v[192:195], v[44:47]
  ds_read_b64_tr_b16 v[134:135], v2 offset:832
  v_mfma_f32_16x16x32_bf16 v[48:51], v[180:183], v[192:195], v[48:51]
  ds_read_b128 v[140:143], v4 offset:1024
  v_mfma_f32_16x16x32_bf16 v[52:55], v[172:175], v[196:199], v[52:55]
  ds_read_b128 v[144:147], v4 offset:2048
  v_mfma_f32_16x16x32_bf16 v[56:59], v[176:179], v[196:199], v[56:59]
  ds_read_b128 v[148:151], v4 offset:3072
  v_mfma_f32_16x16x32_bf16 v[60:63], v[180:183], v[196:199], v[60:63]
  ds_read_b128 v[152:155], v4 offset:4096
  v_mfma_f32_16x16x32_bf16 v[64:67], v[172:175], v[200:203], v[64:67]
  ds_read_b128 v[156:159], v4 offset:5120
  v_mfma_f32_16x16x32_bf16 v[68:71], v[176:179], v[200:203], v[68:71]
  ds_read_b128 v[160:163], v4 offset:6144
  v_mfma_f32_16x16x32_bf16 v[72:75], v[180:183], v[200:203], v[72:75]
  ds_read_b128 v[164:167], v4 offset:7168
  v_mfma_f32_16x16x32_bf16 v[76:79], v[172:175], v[204:207], v[76:79]
  ds_read_b128 v[168:171], v4 offset:8192
  v_mfma_f32_16x16x32_bf16 v[80:83], v[176:179], v[204:207], v[80:83]
  s_add_u32 s69, s60, 30720
  s_cmp_eq_u32 s69, 153600
  v_mfma_f32_16x16x32_bf16 v[84:87], v[180:183], v[204:207], v[84:87]
  s_cselect_b32 s69, 0, s69
  s_sub_u32 s60, s69, s60
  v_mfma_f32_16x16x32_bf16 v[88:91], v[172:175], v[208:211], v[88:91]
  v_add_u32 v2, s60, v2
  v_add_u32 v3, s60, v3
  v_mfma_f32_16x16x32_bf16 v[92:95], v[176:179], v[208:211], v[92:95]
  v_add_u32 v4, s60, v4
  s_mov_b32 s60, s69
  v_mfma_f32_16x16x32_bf16 v[96:99], v[180:183], v[208:211], v[96:99]
  v_mfma_f32_16x16x32_bf16 v[100:103], v[172:175], v[212:215], v[100:103]
  v_mfma_f32_16x16x32_bf16 v[104:107], v[176:179], v[212:215], v[104:107]
  v_mfma_f32_16x16x32_bf16 v[108:111], v[180:183], v[212:215], v[108:111]
  v_mfma_f32_16x16x32_bf16 v[112:115], v[172:175], v[216:219], v[112:115]
  v_mfma_f32_16x16x32_bf16 v[116:119], v[176:179], v[216:219], v[116:119]
  s_sub_u32 s61, s61, 1
  s_cmp_lg_u32 s61, 0
  v_mfma_f32_16x16x32_bf16 v[120:123], v[180:183], v[216:219], v[120:123]
  s_cbranch_scc1 L_g1_main
  s_waitcnt lgkmcnt(0)
  v_mfma_f32_16x16x32_bf16 v[16:19], v[124:127], v[136:139], v[16:19]
  s_barrier
  v_mfma_f32_16x16x32_bf16 v[20:23], v[128:131], v[136:139], v[20:23]
  ds_read_b64_tr_b16 v[172:173], v2 offset:0
  v_mfma_f32_16x16x32_bf16 v[24:27], v[132:135], v[136:139], v[24:27]
  ds_read_b64_tr_b16 v[174:175], v2 offset:768
  v_mfma_f32_16x16x32_bf16 v[28:31], v[124:127], v[140:143], v[28:31]
  ds_read_b128 v[184:187], v4 offset:0
  v_mfma_f32_16x16x32_bf16 v[32:35], v[128:131], v[140:143], v[32:35]
  ds_read_b64_tr_b16 v[176:177], v3 offset:0
  v_mfma_f32_16x16x32_bf16 v[36:39], v[132:135], v[140:143], v[36:39]
  ds_read_b64_tr_b16 v[178:179], v3 offset:768
  v_mfma_f32_16x16x32_bf16 v[40:43], v[124:127], v[144:147], v[40:43]
  ds_read_b64_tr_b16 v[180:181], v2 offset:64
  v_mfma_f32_16x16x32_bf16 v[44:47], v[128:131], v[144:147], v[44:47]
  ds_read_b64_tr_b16 v[182:183], v2 offset:832
  v_mfma_f32_16x16x32_bf16 v[48:51], v[132:135], v[144:147], v[48:51]
  ds_read_b128 v[188:191], v4 offset:1024
  v_mfma_f32_16x16x32_bf16 v[52:55], v[124:127], v[148:151], v[52:55]
  ds_read_b128 v[192:195], v4 offset:2048
  v_mfma_f32_16x16x32_bf16 v[56:59], v[128:131], v[148:151], v[56:59]
  ds_read_b128 v[196:199], v4 offset:3072
  v_mfma_f32_16x16x32_bf16 v[60:63], v[132:135], v[148:151], v[60:63]
  ds_read_b128 v[200:203], v4 offset:4096
  v_mfma_f32_16x16x32_bf16 v[64:67], v[124:127], v[152:155], v[64:67]
  ds_read_b128 v[204:207], v4 offset:5120
  v_mfma_f32_16x16x32_bf16 v[68:71], v[128:131], v[152:155], v[68:71]
  ds_read_b128 v[208:211], v4 offset:6144
  v_mfma_f32_16x16x32_bf16 v[72:75], v[132:135], v[152:155], v[72:75]
  ds_read_b128 v[212:215], v4 offset:7168
  v_mfma_f32_16x16x32_bf16 v[76:79], v[124:127], v[156:159], v[76:79]
  ds_read_b128 v[216:219], v4 offset:8192
  v_mfma_f32_16x16x32_bf16 v[80:83], v[128:131], v[156:159], v[80:83]
  s_add_u32 s69, s60, 30720
  s_cmp_eq_u32 s69, 153600
  v_mfma_f32_16x16x32_bf16 v[84:87], v[132:135], v[156:159], v[84:87]
  s_cselect_b32 s69, 0, s69
  s_sub_u32 s60, s69, s60
  v_mfma_f32_16x16x32_bf16 v[88:91], v[124:127], v[160:163], v[88:91]
  v_add_u32 v2, s60, v2
  v_add_u32 v3, s60, v3
  v_mfma_f32_16x16x32_bf16 v[92:95], v[128:131], v[160:163], v[92:95]
  v_add_u32 v4, s60, v4
  s_mov_b32 s60, s69
  v_mfma_f32_16x16x32_bf16 v[96:99], v[132:135], v[160:163], v[96:99]
  v_mfma_f32_16x16x32_bf16 v[100:103], v[124:127], v[164:167], v[100:103]
  v_mfma_f32_16x16x32_bf16 v[104:107], v[128:131], v[164:167], v[104:107]
  v_mfma_f32_16x16x32_bf16 v[108:111], v[132:135], v[164:167], v[108:111]
  v_mfma_f32_16x16x32_bf16 v[112:115], v[124:127], v[168:171], v[112:115]
  v_mfma_f32_16x16x32_bf16 v[116:119], v[128:131], v[168:171], v[116:119]
  v_mfma_f32_16x16x32_bf16 v[120:123], v[132:135], v[168:171], v[120:123]
  s_waitcnt lgkmcnt(0)
  v_mfma_f32_16x16x32_bf16 v[16:19], v[172:175], v[184:187], v[16:19]
  v_mfma_f32_16x16x32_bf16 v[20:23], v[176:179], v[184:187], v[20:23]
  v_mfma_f32_16x16x32_bf16 v[24:27], v[180:183], v[184:187], v[24:27]
  v_mfma_f32_16x16x32_bf16 v[28:31], v[172:175], v[188:191], v[28:31]
  v_mfma_f32_16x16x32_bf16 v[32:35], v[176:179], v[188:191], v[32:35]
  v_mfma_f32_16x16x32_bf16 v[36:39], v[180:183], v[188:191], v[36:39]
  v_mfma_f32_16x16x32_bf16 v[40:43], v[172:175], v[192:195], v[40:43]
  v_mfma_f32_16x16x32_bf16 v[44:47], v[176:179], v[192:195], v[44:47]
  v_mfma_f32_16x16x32_bf16 v[48:51], v[180:183], v[192:195], v[48:51]
  v_mfma_f32_16x16x32_bf16 v[52:55], v[172:175], v[196:199], v[52:55]
  v_mfma_f32_16x16x32_bf16 v[56:59], v[176:179], v[196:199], v[56:59]
  v_mfma_f32_16x16x32_bf16 v[60:63], v[180:183], v[196:199], v[60:63]
  v_mfma_f32_16x16x32_bf16 v[64:67], v[172:175], v[200:203], v[64:67]
  v_mfma_f32_16x16x32_bf16 v[68:71], v[176:179], v[200:203], v[68:71]
  v_mfma_f32_16x16x32_bf16 v[72:75], v[180:183], v[200:203], v[72:75]
  v_mfma_f32_16x16x32_bf16 v[76:79], v[172:175], v[204:207], v[76:79]
  v_mfma_f32_16x16x32_bf16 v[80:83], v[176:179], v[204:207], v[80:83]
  v_mfma_f32_16x16x32_bf16 v[84:87], v[180:183], v[204:207], v[84:87]
  v_mfma_f32_16x16x32_bf16 v[88:91], v[172:175], v[208:211], v[88:91]
  v_mfma_f32_16x16x32_bf16 v[92:95], v[176:179], v[208:211], v[92:95]
  v_mfma_f32_16x16x32_bf16 v[96:99], v[180:183], v[208:211], v[96:99]
  v_mfma_f32_16x16x32_bf16 v[100:103], v[172:175], v[212:215], v[100:103]
  v_mfma_f32_16x16x32_bf16 v[104:107], v[176:179], v[212:215], v[104:107]
  v_mfma_f32_16x16x32_bf16 v[108:111], v[180:183], v[212:215], v[108:111]
  v_mfma_f32_16x16x32_bf16 v[112:115], v[172:175], v[216:219], v[112:115]
  v_mfma_f32_16x16x32_bf16 v[116:119], v[176:179], v[216:219], v[116:119]
  v_mfma_f32_16x16x32_bf16 v[120:123], v[180:183], v[216:219], v[120:123]
  s_barrier
  ds_write_b128 v5, v[16:19] offset:0
  ds_write_b128 v5, v[20:23] offset:2048
  ds_write_b128 v5, v[24:27] offset:4096
  ds_write_b128 v5, v[28:31] offset:12288
  ds_write_b128 v5, v[32:35] offset:14336
  ds_write_b128 v5, v[36:39] offset:16384
  ds_write_b128 v5, v[40:43] offset:24576
  ds_write_b128 v5, v[44:47] offset:26624
  ds_write_b128 v5, v[48:51] offset:28672
  ds_write_b128 v5, v[52:55] offset:36864
  ds_write_b128 v5, v[56:59] offset:38912
  ds_write_b128 v5, v[60:63] offset:40960
  ds_write_b128 v5, v[64:67] offset:49152
  ds_write_b128 v5, v[68:71] offset:51200
  ds_write_b128 v5, v[72:75] offset:53248
  ds_write_b128 v6, v[76:79] offset:0
  ds_write_b128 v6, v[80:83] offset:2048
  ds_write_b128 v6, v[84:87] offset:4096
  ds_write_b128 v6, v[88:91] offset:12288
  ds_write_b128 v6, v[92:95] offset:14336
  ds_write_b128 v6, v[96:99] offset:16384
  ds_write_b128 v6, v[100:103] offset:24576
  ds_write_b128 v6, v[104:107] offset:26624
  ds_write_b128 v6, v[108:111] offset:28672
  ds_write_b128 v6, v[112:115] offset:36864
  ds_write_b128 v6, v[116:119] offset:38912
  ds_write_b128 v6, v[120:123] offset:40960
  v_lshlrev_b32 v210, 4, v1
  s_lshl_b32 s67, s3, 12
  v_add_u32 v208, s67, v210
  v_add_u32 v209, 65536, v208
  s_mov_b32 s82, 0xbdd2d3e8
  s_mov_b32 s83, 0xbdd2d3e8
  v_mov_b32 v212, 0xc0135761
  v_mov_b32 v213, 0xc0135761
  s_mul_i32 s84, s73, 110592
  s_mul_i32 s67, s71, 9216
  s_add_u32 s84, s84, s67
  s_add_u32 s84, s84, 4718592
  s_waitcnt lgkmcnt(0)
  s_barrier
  ds_read_b128 v[128:131], v208 offset:0
  ds_read_b128 v[132:135], v208 offset:1024
  ds_read_b128 v[136:139], v208 offset:2048
  ds_read_b128 v[140:143], v208 offset:3072
  ds_read_b128 v[144:147], v208 offset:32768
  ds_read_b128 v[148:151], v208 offset:33792
  ds_read_b128 v[152:155], v208 offset:34816
  ds_read_b128 v[156:159], v208 offset:35840
  ds_read_b128 v[160:163], v209 offset:0
  ds_read_b128 v[164:167], v209 offset:1024
  ds_read_b128 v[168:171], v209 offset:2048
  ds_read_b128 v[172:175], v209 offset:3072
  ds_read_b128 v[176:179], v209 offset:32768
  ds_read_b128 v[180:183], v209 offset:33792
  ds_read_b128 v[184:187], v209 offset:34816
  ds_read_b128 v[188:191], v209 offset:35840
  s_add_u32 s85, s3, 0
  s_mul_hi_u32 s67, s85, 1431655766
  s_mul_i32 s68, s67, 3
  s_sub_u32 s85, s85, s68
  s_mul_i32 s85, s85, 36864
  s_lshl_b32 s67, s67, 10
  s_add_u32 s85, s85, s67
  s_add_u32 s85, s85, s84
  s_waitcnt lgkmcnt(12)
  v_pk_add_f32 v[128:129], v[128:129], v[132:133]
  v_pk_add_f32 v[130:131], v[130:131], v[134:135]
  v_pk_add_f32 v[132:133], v[136:137], v[140:141]
  v_pk_add_f32 v[134:135], v[138:139], v[142:143]
  v_pk_mul_f32 v[192:193], v[128:129], v[128:129]
  v_pk_mul_f32 v[194:195], v[130:131], v[130:131]
  v_pk_mul_f32 v[196:197], v[132:133], v[132:133]
  v_pk_mul_f32 v[198:199], v[134:135], v[134:135]
  v_pk_fma_f32 v[192:193], v[192:193], s[82:83], v[212:213]
  v_pk_fma_f32 v[194:195], v[194:195], s[82:83], v[212:213]
  v_pk_fma_f32 v[196:197], v[196:197], s[82:83], v[212:213]
  v_pk_fma_f32 v[198:199], v[198:199], s[82:83], v[212:213]
  v_pk_mul_f32 v[192:193], v[192:193], v[128:129]
  v_pk_mul_f32 v[194:195], v[194:195], v[130:131]
  v_pk_mul_f32 v[196:197], v[196:197], v[132:133]
  v_pk_mul_f32 v[198:199], v[198:199], v[134:135]
  v_exp_f32 v192, v192
  v_exp_f32 v193, v193
  v_exp_f32 v194, v194
  v_exp_f32 v195, v195
  v_exp_f32 v196, v196
  v_exp_f32 v197, v197
  v_exp_f32 v198, v198
  v_exp_f32 v199, v199
  v_pk_add_f32 v[192:193], v[192:193], 1.0 op_sel_hi:[1,0]
  v_pk_add_f32 v[194:195], v[194:195], 1.0 op_sel_hi:[1,0]
  v_pk_add_f32 v[196:197], v[196:197], 1.0 op_sel_hi:[1,0]
  v_pk_add_f32 v[198:199], v[198:199], 1.0 op_sel_hi:[1,0]
  v_rcp_f32 v192, v192
  v_rcp_f32 v193, v193
  v_rcp_f32 v194, v194
  v_rcp_f32 v195, v195
  v_rcp_f32 v196, v196
  v_rcp_f32 v197, v197
  v_rcp_f32 v198, v198
  v_rcp_f32 v199, v199
  v_pk_mul_f32 v[192:193], v[192:193], v[128:129]
  v_pk_mul_f32 v[194:195], v[194:195], v[130:131]
  v_pk_mul_f32 v[196:197], v[196:197], v[132:133]
  v_pk_mul_f32 v[198:199], v[198:199], v[134:135]
  v_cvt_pk_bf16_f32 v136, v192, v193
  v_cvt_pk_bf16_f32 v137, v194, v195
  v_cvt_pk_bf16_f32 v138, v196, v197
  v_cvt_pk_bf16_f32 v139, v198, v199
  buffer_store_dwordx4 v[136:139], v210, s[16:19], s85 offen sc1
  s_add_u32 s85, s3, 8
  s_mul_hi_u32 s67, s85, 1431655766
  s_mul_i32 s68, s67, 3
  s_sub_u32 s85, s85, s68
  s_mul_i32 s85, s85, 36864
  s_lshl_b32 s67, s67, 10
  s_add_u32 s85, s85, s67
  s_add_u32 s85, s85, s84
  s_waitcnt lgkmcnt(8)
  v_pk_add_f32 v[144:145], v[144:145], v[148:149]
  v_pk_add_f32 v[146:147], v[146:147], v[150:151]
  v_pk_add_f32 v[148:149], v[152:153], v[156:157]
  v_pk_add_f32 v[150:151], v[154:155], v[158:159]
  v_pk_mul_f32 v[200:201], v[144:145], v[144:145]
  v_pk_mul_f32 v[202:203], v[146:147], v[146:147]
  v_pk_mul_f32 v[204:205], v[148:149], v[148:149]
  v_pk_mul_f32 v[206:207], v[150:151], v[150:151]
  v_pk_fma_f32 v[200:201], v[200:201], s[82:83], v[212:213]
  v_pk_fma_f32 v[202:203], v[202:203], s[82:83], v[212:213]
  v_pk_fma_f32 v[204:205], v[204:205], s[82:83], v[212:213]
  v_pk_fma_f32 v[206:207], v[206:207], s[82:83], v[212:213]
  v_pk_mul_f32 v[200:201], v[200:201], v[144:145]
  v_pk_mul_f32 v[202:203], v[202:203], v[146:147]
  v_pk_mul_f32 v[204:205], v[204:205], v[148:149]
  v_pk_mul_f32 v[206:207], v[206:207], v[150:151]
  v_exp_f32 v200, v200
  v_exp_f32 v201, v201
  v_exp_f32 v202, v202
  v_exp_f32 v203, v203
  v_exp_f32 v204, v204
  v_exp_f32 v205, v205
  v_exp_f32 v206, v206
  v_exp_f32 v207, v207
  v_pk_add_f32 v[200:201], v[200:201], 1.0 op_sel_hi:[1,0]
  v_pk_add_f32 v[202:203], v[202:203], 1.0 op_sel_hi:[1,0]
  v_pk_add_f32 v[204:205], v[204:205], 1.0 op_sel_hi:[1,0]
  v_pk_add_f32 v[206:207], v[206:207], 1.0 op_sel_hi:[1,0]
  v_rcp_f32 v200, v200
  v_rcp_f32 v201, v201
  v_rcp_f32 v202, v202
  v_rcp_f32 v203, v203
  v_rcp_f32 v204, v204
  v_rcp_f32 v205, v205
  v_rcp_f32 v206, v206
  v_rcp_f32 v207, v207
  v_pk_mul_f32 v[200:201], v[200:201], v[144:145]
  v_pk_mul_f32 v[202:203], v[202:203], v[146:147]
  v_pk_mul_f32 v[204:205], v[204:205], v[148:149]
  v_pk_mul_f32 v[206:207], v[206:207], v[150:151]
  v_cvt_pk_bf16_f32 v152, v200, v201
  v_cvt_pk_bf16_f32 v153, v202, v203
  v_cvt_pk_bf16_f32 v154, v204, v205
  v_cvt_pk_bf16_f32 v155, v206, v207
  buffer_store_dwordx4 v[152:155], v210, s[16:19], s85 offen sc1
  s_add_u32 s85, s3, 16
  s_mul_hi_u32 s67, s85, 1431655766
  s_mul_i32 s68, s67, 3
  s_sub_u32 s85, s85, s68
  s_mul_i32 s85, s85, 36864
  s_lshl_b32 s67, s67, 10
  s_add_u32 s85, s85, s67
  s_add_u32 s85, s85, s84
  s_waitcnt lgkmcnt(4)
  v_pk_add_f32 v[160:161], v[160:161], v[164:165]
  v_pk_add_f32 v[162:163], v[162:163], v[166:167]
  v_pk_add_f32 v[164:165], v[168:169], v[172:173]
  v_pk_add_f32 v[166:167], v[170:171], v[174:175]
  v_pk_mul_f32 v[192:193], v[160:161], v[160:161]
  v_pk_mul_f32 v[194:195], v[162:163], v[162:163]
  v_pk_mul_f32 v[196:197], v[164:165], v[164:165]
  v_pk_mul_f32 v[198:199], v[166:167], v[166:167]
  v_pk_fma_f32 v[192:193], v[192:193], s[82:83], v[212:213]
  v_pk_fma_f32 v[194:195], v[194:195], s[82:83], v[212:213]
  v_pk_fma_f32 v[196:197], v[196:197], s[82:83], v[212:213]
  v_pk_fma_f32 v[198:199], v[198:199], s[82:83], v[212:213]
  v_pk_mul_f32 v[192:193], v[192:193], v[160:161]
  v_pk_mul_f32 v[194:195], v[194:195], v[162:163]
  v_pk_mul_f32 v[196:197], v[196:197], v[164:165]
  v_pk_mul_f32 v[198:199], v[198:199], v[166:167]
  v_exp_f32 v192, v192
  v_exp_f32 v193, v193
  v_exp_f32 v194, v194
  v_exp_f32 v195, v195
  v_exp_f32 v196, v196
  v_exp_f32 v197, v197
  v_exp_f32 v198, v198
  v_exp_f32 v199, v199
  v_pk_add_f32 v[192:193], v[192:193], 1.0 op_sel_hi:[1,0]
  v_pk_add_f32 v[194:195], v[194:195], 1.0 op_sel_hi:[1,0]
  v_pk_add_f32 v[196:197], v[196:197], 1.0 op_sel_hi:[1,0]
  v_pk_add_f32 v[198:199], v[198:199], 1.0 op_sel_hi:[1,0]
  v_rcp_f32 v192, v192
  v_rcp_f32 v193, v193
  v_rcp_f32 v194, v194
  v_rcp_f32 v195, v195
  v_rcp_f32 v196, v196
  v_rcp_f32 v197, v197
  v_rcp_f32 v198, v198
  v_rcp_f32 v199, v199
  v_pk_mul_f32 v[192:193], v[192:193], v[160:161]
  v_pk_mul_f32 v[194:195], v[194:195], v[162:163]
  v_pk_mul_f32 v[196:197], v[196:197], v[164:165]
  v_pk_mul_f32 v[198:199], v[198:199], v[166:167]
  v_cvt_pk_bf16_f32 v168, v192, v193
  v_cvt_pk_bf16_f32 v169, v194, v195
  v_cvt_pk_bf16_f32 v170, v196, v197
  v_cvt_pk_bf16_f32 v171, v198, v199
  buffer_store_dwordx4 v[168:171], v210, s[16:19], s85 offen sc1
  s_cmp_ge_u32 s3, 3
  s_cbranch_scc1 L_g1fc
  s_add_u32 s85, s3, 24
  s_mul_hi_u32 s67, s85, 1431655766
  s_mul_i32 s68, s67, 3
  s_sub_u32 s85, s85, s68
  s_mul_i32 s85, s85, 36864
  s_lshl_b32 s67, s67, 10
  s_add_u32 s85, s85, s67
  s_add_u32 s85, s85, s84
  s_waitcnt lgkmcnt(0)
  v_pk_add_f32 v[176:177], v[176:177], v[180:181]
  v_pk_add_f32 v[178:179], v[178:179], v[182:183]
  v_pk_add_f32 v[180:181], v[184:185], v[188:189]
  v_pk_add_f32 v[182:183], v[186:187], v[190:191]
  v_pk_mul_f32 v[200:201], v[176:177], v[176:177]
  v_pk_mul_f32 v[202:203], v[178:179], v[178:179]
  v_pk_mul_f32 v[204:205], v[180:181], v[180:181]
  v_pk_mul_f32 v[206:207], v[182:183], v[182:183]
  v_pk_fma_f32 v[200:201], v[200:201], s[82:83], v[212:213]
  v_pk_fma_f32 v[202:203], v[202:203], s[82:83], v[212:213]
  v_pk_fma_f32 v[204:205], v[204:205], s[82:83], v[212:213]
  v_pk_fma_f32 v[206:207], v[206:207], s[82:83], v[212:213]
  v_pk_mul_f32 v[200:201], v[200:201], v[176:177]
  v_pk_mul_f32 v[202:203], v[202:203], v[178:179]
  v_pk_mul_f32 v[204:205], v[204:205], v[180:181]
  v_pk_mul_f32 v[206:207], v[206:207], v[182:183]
  v_exp_f32 v200, v200
  v_exp_f32 v201, v201
  v_exp_f32 v202, v202
  v_exp_f32 v203, v203
  v_exp_f32 v204, v204
  v_exp_f32 v205, v205
  v_exp_f32 v206, v206
  v_exp_f32 v207, v207
  v_pk_add_f32 v[200:201], v[200:201], 1.0 op_sel_hi:[1,0]
  v_pk_add_f32 v[202:203], v[202:203], 1.0 op_sel_hi:[1,0]
  v_pk_add_f32 v[204:205], v[204:205], 1.0 op_sel_hi:[1,0]
  v_pk_add_f32 v[206:207], v[206:207], 1.0 op_sel_hi:[1,0]
  v_rcp_f32 v200, v200
  v_rcp_f32 v201, v201
  v_rcp_f32 v202, v202
  v_rcp_f32 v203, v203
  v_rcp_f32 v204, v204
  v_rcp_f32 v205, v205
  v_rcp_f32 v206, v206
  v_rcp_f32 v207, v207
  v_pk_mul_f32 v[200:201], v[200:201], v[176:177]
  v_pk_mul_f32 v[202:203], v[202:203], v[178:179]
  v_pk_mul_f32 v[204:205], v[204:205], v[180:181]
  v_pk_mul_f32 v[206:207], v[206:207], v[182:183]
  v_cvt_pk_bf16_f32 v184, v200, v201
  v_cvt_pk_bf16_f32 v185, v202, v203
  v_cvt_pk_bf16_f32 v186, v204, v205
  v_cvt_pk_bf16_f32 v187, v206, v207
  buffer_store_dwordx4 v[184:187], v210, s[16:19], s85 offen sc1
L_g1fc:
  s_waitcnt lgkmcnt(0)
  s_barrier
  s_waitcnt vmcnt(0)
  v_mov_b32 v4, 163812
  v_mov_b32 v5, 1
  s_mov_b64 exec, 1
  ds_add_rtn_u32 v5, v4, v5
  s_lshl_b32 s67, s52, 5
  s_add_u32 s67, s67, s53
  s_lshl_b32 s67, s67, 7
  s_add_u32 s67, s67, 27557888
  s_waitcnt lgkmcnt(0)
  v_readfirstlane_b32 s68, v5
  s_mov_b64 exec, -1
  s_cmp_lg_u32 s68, 7
  s_cbranch_scc1 L_pub1gc
  v_mov_b32 v4, s54
  v_lshlrev_b32 v5, 2, v1
  s_mov_b64 exec, 1
  buffer_store_dword v4, v5, s[16:19], s67 offen sc1
  s_mov_b64 exec, -1
L_pub1gc:
  s_and_b32 s73, s52, 3
  s_lshr_b32 s71, s52, 2
  s_lshl_b32 s71, s71, 3
  s_and_b32 s67, s53, 7
  s_add_u32 s71, s71, s67
  s_lshr_b32 s72, s53, 3
  v_lshrrev_b32 v7, 4, v1
  v_bfe_u32 v12, v1, 2, 2
  v_and_b32 v13, 3, v1
  v_lshl_add_u32 v8, v7, 2, v12
  v_lshlrev_b32 v9, 8, v8
  v_lshl_add_u32 v9, v13, 3, v9
  v_add_u32 v9, 12288, v9
  v_and_b32 v8, 7, v8
  s_and_b32 s85, s3, 2
  s_lshl_b32 s85, s85, 1
  s_add_u32 s67, s73, 0
  s_and_b32 s67, s67, 3
  s_add_u32 s67, s67, s85
  v_xor_b32 v10, s67, v8
  v_lshl_add_u32 v2, v10, 5, v9
  s_add_u32 s67, s73, 1
  s_and_b32 s67, s67, 3
  s_add_u32 s67, s67, s85
  v_xor_b32 v10, s67, v8
  v_lshl_add_u32 v3, v10, 5, v9
  s_add_u32 s67, s73, 2
  s_and_b32 s67, s67, 3
  s_add_u32 s67, s67, s85
  v_xor_b32 v10, s67, v8
  v_lshl_add_u32 v4, v10, 5, v9
  s_add_u32 s67, s73, 3
  s_and_b32 s67, s67, 3
  s_add_u32 s67, s67, s85
  v_xor_b32 v10, s67, v8
  v_lshl_add_u32 v5, v10, 5, v9
  v_lshlrev_b32 v8, 4, v1
  s_and_b32 s84, s3, 1
  s_mul_i32 s67, s84, 6144
  v_add_u32 v6, s67, v8
  v_mov_b32 v16, 0
  v_mov_b32 v17, 0
  v_mov_b32 v18, 0
  v_mov_b32 v19, 0
  v_mov_b32 v20, 0
  v_mov_b32 v21, 0
  v_mov_b32 v22, 0
  v_mov_b32 v23, 0
  v_mov_b32 v24, 0
  v_mov_b32 v25, 0
  v_mov_b32 v26, 0
  v_mov_b32 v27, 0
  v_mov_b32 v28, 0
  v_mov_b32 v29, 0
  v_mov_b32 v30, 0
  v_mov_b32 v31, 0
  v_mov_b32 v32, 0
  v_mov_b32 v33, 0
  v_mov_b32 v34, 0
  v_mov_b32 v35, 0
  v_mov_b32 v36, 0
  v_mov_b32 v37, 0
  v_mov_b32 v38, 0
  v_mov_b32 v39, 0
  v_mov_b32 v40, 0
  v_mov_b32 v41, 0
  v_mov_b32 v42, 0
  v_mov_b32 v43, 0
  v_mov_b32 v44, 0
  v_mov_b32 v45, 0
  v_mov_b32 v46, 0
  v_mov_b32 v47, 0
  v_mov_b32 v48, 0
  v_mov_b32 v49, 0
  v_mov_b32 v50, 0
  v_mov_b32 v51, 0
  v_mov_b32 v52, 0
  v_mov_b32 v53, 0
  v_mov_b32 v54, 0
  v_mov_b32 v55, 0
  v_mov_b32 v56, 0
  v_mov_b32 v57, 0
  v_mov_b32 v58, 0
  v_mov_b32 v59, 0
  v_mov_b32 v60, 0
  v_mov_b32 v61, 0
  v_mov_b32 v62, 0
  v_mov_b32 v63, 0
  v_mov_b32 v64, 0
  v_mov_b32 v65, 0
  v_mov_b32 v66, 0
  v_mov_b32 v67, 0
  v_mov_b32 v68, 0
  v_mov_b32 v69, 0
  v_mov_b32 v70, 0
  v_mov_b32 v71, 0
  v_mov_b32 v72, 0
  v_mov_b32 v73, 0
  v_mov_b32 v74, 0
  v_mov_b32 v75, 0
  v_mov_b32 v76, 0
  v_mov_b32 v77, 0
  v_mov_b32 v78, 0
  v_mov_b32 v79, 0
  v_mov_b32 v80, 0
  v_mov_b32 v81, 0
  v_mov_b32 v82, 0
  v_mov_b32 v83, 0
  v_mov_b32 v84, 0
  v_mov_b32 v85, 0
  v_mov_b32 v86, 0
  v_mov_b32 v87, 0
  v_mov_b32 v88, 0
  v_mov_b32 v89, 0
  v_mov_b32 v90, 0
  v_mov_b32 v91, 0
  v_mov_b32 v92, 0
  v_mov_b32 v93, 0
  v_mov_b32 v94, 0
  v_mov_b32 v95, 0
  v_mov_b32 v96, 0
  v_mov_b32 v97, 0
  v_mov_b32 v98, 0
  v_mov_b32 v99, 0
  v_mov_b32 v100, 0
  v_mov_b32 v101, 0
  v_mov_b32 v102, 0
  v_mov_b32 v103, 0
  v_mov_b32 v104, 0
  v_mov_b32 v105, 0
  v_mov_b32 v106, 0
  v_mov_b32 v107, 0
  v_mov_b32 v108, 0
  v_mov_b32 v109, 0
  v_mov_b32 v110, 0
  v_mov_b32 v111, 0
  s_mov_b32 s60, 0
  v_and_b32 v10, 15, v1
  v_mul_u32_u24 v9, 1152, v10
  v_lshl_add_u32 v9, v7, 4, v9
  v_lshlrev_b32 v10, 1, v10
  s_lshl_b32 s74, s71, 3
  s_add_u32 s74, s74, s85
  s_add_u32 s74, s74, s73
  s_lshl_b32 s76, s72, 1
  s_add_u32 s76, s76, s84
  s_mul_i32 s75, s74, 18432
  s_mul_i32 s67, s76, 192
  s_add_u32 s75, s75, s67
  s_lshl_b32 s77, s74, 5
  buffer_load_dwordx4 v[192:195], v9, s[36:39], s75 offen offset:0
  buffer_load_dwordx4 v[196:199], v9, s[36:39], s75 offen offset:64
  buffer_load_dwordx4 v[200:203], v9, s[36:39], s75 offen offset:128
  buffer_load_ushort v240, v10, s[44:47], s77 offen
  v_lshl_add_u32 v10, v7, 2, v12
  v_mul_u32_u24 v11, 384, v10
  v_lshl_add_u32 v11, v13, 4, v11
  v_bfe_u32 v10, v10, 1, 1
  s_mul_i32 s67, s84, 3
  s_add_u32 s67, s67, 0
  v_xor_b32 v14, s67, v10
  v_lshl_add_u32 v242, v14, 6, v11
  s_mul_i32 s67, s84, 3
  s_add_u32 s67, s67, 1
  v_xor_b32 v14, s67, v10
  v_lshl_add_u32 v243, v14, 6, v11
  s_add_u32 s67, s73, 0
  s_and_b32 s67, s67, 3
  s_add_u32 s67, s67, s85
  s_lshl_b32 s67, s67, 10
  s_add_u32 s67, s67, 12288
  v_add_u32 v244, s67, v8
  s_add_u32 s67, s73, 1
  s_and_b32 s67, s67, 3
  s_add_u32 s67, s67, s85
  s_lshl_b32 s67, s67, 10
  s_add_u32 s67, s67, 12288
  v_add_u32 v245, s67, v8
  s_add_u32 s67, s73, 2
  s_and_b32 s67, s67, 3
  s_add_u32 s67, s67, s85
  s_lshl_b32 s67, s67, 10
  s_add_u32 s67, s67, 12288
  v_add_u32 v246, s67, v8
  s_add_u32 s67, s73, 3
  s_and_b32 s67, s67, 3
  s_add_u32 s67, s67, s85
  s_lshl_b32 s67, s67, 10
  s_add_u32 s67, s67, 12288
  v_add_u32 v247, s67, v8
  s_lshl_b32 s67, s53, 2
  s_add_u32 s67, s67, s3
  s_lshl_b32 s67, s67, 13
  v_lshlrev_b32 v14, 7, v1
  v_add_u32 v14, s67, v14
  s_mul_i32 s83, s73, 1327104
  s_add_u32 s83, s83, 4976640
  s_barrier
  s_barrier
  ds_read_b64_tr_b16 v[112:113], v2 offset:0
  ds_read_b64_tr_b16 v[114:115], v2 offset:4096
  ds_read_b128 v[128:131], v6 offset:0
  ds_read_b64_tr_b16 v[116:117], v3 offset:0
  ds_read_b64_tr_b16 v[118:119], v3 offset:4096
  ds_read_b64_tr_b16 v[120:121], v4 offset:0
  ds_read_b64_tr_b16 v[122:123], v4 offset:4096
  ds_read_b64_tr_b16 v[124:125], v5 offset:0
  ds_read_b64_tr_b16 v[126:127], v5 offset:4096
  ds_read_b128 v[132:135], v6 offset:1024
  ds_read_b128 v[136:139], v6 offset:2048
  ds_read_b128 v[140:143], v6 offset:3072
  ds_read_b128 v[144:147], v6 offset:4096
  ds_read_b128 v[148:151], v6 offset:5120
  s_add_u32 s69, s60, 20480
  s_cmp_eq_u32 s69, 143360
  s_cselect_b32 s69, 0, s69
  s_sub_u32 s60, s69, s60
  v_add_u32 v2, s60, v2
  v_add_u32 v3, s60, v3
  v_add_u32 v4, s60, v4
  v_add_u32 v5, s60, v5
  v_add_u32 v6, s60, v6
  s_mov_b32 s60, s69
  s_mov_b32 s61, 17
L_g2_main:
  s_waitcnt lgkmcnt(0)
  v_mfma_f32_16x16x32_bf16 v[16:19], v[128:131], v[112:115], v[16:19]
  s_barrier
  v_mfma_f32_16x16x32_bf16 v[40:43], v[128:131], v[116:119], v[40:43]
  ds_read_b64_tr_b16 v[152:153], v2 offset:0
  v_mfma_f32_16x16x32_bf16 v[64:67], v[128:131], v[120:123], v[64:67]
  ds_read_b64_tr_b16 v[154:155], v2 offset:4096
  v_mfma_f32_16x16x32_bf16 v[88:91], v[128:131], v[124:127], v[88:91]
  ds_read_b128 v[168:171], v6 offset:0
  v_mfma_f32_16x16x32_bf16 v[20:23], v[132:135], v[112:115], v[20:23]
  ds_read_b64_tr_b16 v[156:157], v3 offset:0
  v_mfma_f32_16x16x32_bf16 v[44:47], v[132:135], v[116:119], v[44:47]
  ds_read_b64_tr_b16 v[158:159], v3 offset:4096
  v_mfma_f32_16x16x32_bf16 v[68:71], v[132:135], v[120:123], v[68:71]
  ds_read_b64_tr_b16 v[160:161], v4 offset:0
  v_mfma_f32_16x16x32_bf16 v[92:95], v[132:135], v[124:127], v[92:95]
  ds_read_b64_tr_b16 v[162:163], v4 offset:4096
  v_mfma_f32_16x16x32_bf16 v[24:27], v[136:139], v[112:115], v[24:27]
  ds_read_b64_tr_b16 v[164:165], v5 offset:0
  v_mfma_f32_16x16x32_bf16 v[48:51], v[136:139], v[116:119], v[48:51]
  ds_read_b64_tr_b16 v[166:167], v5 offset:4096
  v_mfma_f32_16x16x32_bf16 v[72:75], v[136:139], v[120:123], v[72:75]
  ds_read_b128 v[172:175], v6 offset:1024
  v_mfma_f32_16x16x32_bf16 v[96:99], v[136:139], v[124:127], v[96:99]
  ds_read_b128 v[176:179], v6 offset:2048
  v_mfma_f32_16x16x32_bf16 v[28:31], v[140:143], v[112:115], v[28:31]
  ds_read_b128 v[180:183], v6 offset:3072
  v_mfma_f32_16x16x32_bf16 v[52:55], v[140:143], v[116:119], v[52:55]
  ds_read_b128 v[184:187], v6 offset:4096
  v_mfma_f32_16x16x32_bf16 v[76:79], v[140:143], v[120:123], v[76:79]
  ds_read_b128 v[188:191], v6 offset:5120
  v_mfma_f32_16x16x32_bf16 v[100:103], v[140:143], v[124:127], v[100:103]
  s_add_u32 s69, s60, 20480
  s_cmp_eq_u32 s69, 143360
  v_mfma_f32_16x16x32_bf16 v[32:35], v[144:147], v[112:115], v[32:35]
  s_cselect_b32 s69, 0, s69
  s_sub_u32 s60, s69, s60
  v_mfma_f32_16x16x32_bf16 v[56:59], v[144:147], v[116:119], v[56:59]
  v_add_u32 v2, s60, v2
  v_add_u32 v3, s60, v3
  v_mfma_f32_16x16x32_bf16 v[80:83], v[144:147], v[120:123], v[80:83]
  v_add_u32 v4, s60, v4
  v_add_u32 v5, s60, v5
  v_mfma_f32_16x16x32_bf16 v[104:107], v[144:147], v[124:127], v[104:107]
  v_add_u32 v6, s60, v6
  s_mov_b32 s60, s69
  v_mfma_f32_16x16x32_bf16 v[36:39], v[148:151], v[112:115], v[36:39]
  v_mfma_f32_16x16x32_bf16 v[60:63], v[148:151], v[116:119], v[60:63]
  v_mfma_f32_16x16x32_bf16 v[84:87], v[148:151], v[120:123], v[84:87]
  v_mfma_f32_16x16x32_bf16 v[108:111], v[148:151], v[124:127], v[108:111]
  s_waitcnt lgkmcnt(0)
  v_mfma_f32_16x16x32_bf16 v[16:19], v[168:171], v[152:155], v[16:19]
  s_barrier
  v_mfma_f32_16x16x32_bf16 v[40:43], v[168:171], v[156:159], v[40:43]
  ds_read_b64_tr_b16 v[112:113], v2 offset:0
  v_mfma_f32_16x16x32_bf16 v[64:67], v[168:171], v[160:163], v[64:67]
  ds_read_b64_tr_b16 v[114:115], v2 offset:4096
  v_mfma_f32_16x16x32_bf16 v[88:91], v[168:171], v[164:167], v[88:91]
  ds_read_b128 v[128:131], v6 offset:0
  v_mfma_f32_16x16x32_bf16 v[20:23], v[172:175], v[152:155], v[20:23]
  ds_read_b64_tr_b16 v[116:117], v3 offset:0
  v_mfma_f32_16x16x32_bf16 v[44:47], v[172:175], v[156:159], v[44:47]
  ds_read_b64_tr_b16 v[118:119], v3 offset:4096
  v_mfma_f32_16x16x32_bf16 v[68:71], v[172:175], v[160:163], v[68:71]
  ds_read_b64_tr_b16 v[120:121], v4 offset:0
  v_mfma_f32_16x16x32_bf16 v[92:95], v[172:175], v[164:167], v[92:95]
  ds_read_b64_tr_b16 v[122:123], v4 offset:4096
  v_mfma_f32_16x16x32_bf16 v[24:27], v[176:179], v[152:155], v[24:27]
  ds_read_b64_tr_b16 v[124:125], v5 offset:0
  v_mfma_f32_16x16x32_bf16 v[48:51], v[176:179], v[156:159], v[48:51]
  ds_read_b64_tr_b16 v[126:127], v5 offset:4096
  v_mfma_f32_16x16x32_bf16 v[72:75], v[176:179], v[160:163], v[72:75]
  ds_read_b128 v[132:135], v6 offset:1024
  v_mfma_f32_16x16x32_bf16 v[96:99], v[176:179], v[164:167], v[96:99]
  ds_read_b128 v[136:139], v6 offset:2048
  v_mfma_f32_16x16x32_bf16 v[28:31], v[180:183], v[152:155], v[28:31]
  ds_read_b128 v[140:143], v6 offset:3072
  v_mfma_f32_16x16x32_bf16 v[52:55], v[180:183], v[156:159], v[52:55]
  ds_read_b128 v[144:147], v6 offset:4096
  v_mfma_f32_16x16x32_bf16 v[76:79], v[180:183], v[160:163], v[76:79]
  ds_read_b128 v[148:151], v6 offset:5120
  v_mfma_f32_16x16x32_bf16 v[100:103], v[180:183], v[164:167], v[100:103]
  s_add_u32 s69, s60, 20480
  s_cmp_eq_u32 s69, 143360
  v_mfma_f32_16x16x32_bf16 v[32:35], v[184:187], v[152:155], v[32:35]
  s_cselect_b32 s69, 0, s69
  s_sub_u32 s60, s69, s60
  v_mfma_f32_16x16x32_bf16 v[56:59], v[184:187], v[156:159], v[56:59]
  v_add_u32 v2, s60, v2
  v_add_u32 v3, s60, v3
  v_mfma_f32_16x16x32_bf16 v[80:83], v[184:187], v[160:163], v[80:83]
  v_add_u32 v4, s60, v4
  v_add_u32 v5, s60, v5
  v_mfma_f32_16x16x32_bf16 v[104:107], v[184:187], v[164:167], v[104:107]
  v_add_u32 v6, s60, v6
  s_mov_b32 s60, s69
  v_mfma_f32_16x16x32_bf16 v[36:39], v[188:191], v[152:155], v[36:39]
  v_mfma_f32_16x16x32_bf16 v[60:63], v[188:191], v[156:159], v[60:63]
  v_mfma_f32_16x16x32_bf16 v[84:87], v[188:191], v[160:163], v[84:87]
  s_sub_u32 s61, s61, 1
  s_cmp_lg_u32 s61, 0
  v_mfma_f32_16x16x32_bf16 v[108:111], v[188:191], v[164:167], v[108:111]
  s_cbranch_scc1 L_g2_main
  s_waitcnt lgkmcnt(0)
  v_mfma_f32_16x16x32_bf16 v[16:19], v[128:131], v[112:115], v[16:19]
  s_barrier
  v_mfma_f32_16x16x32_bf16 v[40:43], v[128:131], v[116:119], v[40:43]
  ds_read_b64_tr_b16 v[152:153], v2 offset:0
  v_mfma_f32_16x16x32_bf16 v[64:67], v[128:131], v[120:123], v[64:67]
  ds_read_b64_tr_b16 v[154:155], v2 offset:4096
  v_mfma_f32_16x16x32_bf16 v[88:91], v[128:131], v[124:127], v[88:91]
  ds_read_b128 v[168:171], v6 offset:0
  v_mfma_f32_16x16x32_bf16 v[20:23], v[132:135], v[112:115], v[20:23]
  ds_read_b64_tr_b16 v[156:157], v3 offset:0
  v_mfma_f32_16x16x32_bf16 v[44:47], v[132:135], v[116:119], v[44:47]
  ds_read_b64_tr_b16 v[158:159], v3 offset:4096
  v_mfma_f32_16x16x32_bf16 v[68:71], v[132:135], v[120:123], v[68:71]
  ds_read_b64_tr_b16 v[160:161], v4 offset:0
  v_mfma_f32_16x16x32_bf16 v[92:95], v[132:135], v[124:127], v[92:95]
  ds_read_b64_tr_b16 v[162:163], v4 offset:4096
  v_mfma_f32_16x16x32_bf16 v[24:27], v[136:139], v[112:115], v[24:27]
  ds_read_b64_tr_b16 v[164:165], v5 offset:0
  v_mfma_f32_16x16x32_bf16 v[48:51], v[136:139], v[116:119], v[48:51]
  ds_read_b64_tr_b16 v[166:167], v5 offset:4096
  v_mfma_f32_16x16x32_bf16 v[72:75], v[136:139], v[120:123], v[72:75]
  ds_read_b128 v[172:175], v6 offset:1024
  v_mfma_f32_16x16x32_bf16 v[96:99], v[136:139], v[124:127], v[96:99]
  ds_read_b128 v[176:179], v6 offset:2048
  v_mfma_f32_16x16x32_bf16 v[28:31], v[140:143], v[112:115], v[28:31]
  ds_read_b128 v[180:183], v6 offset:3072
  v_mfma_f32_16x16x32_bf16 v[52:55], v[140:143], v[116:119], v[52:55]
  ds_read_b128 v[184:187], v6 offset:4096
  v_mfma_f32_16x16x32_bf16 v[76:79], v[140:143], v[120:123], v[76:79]
  ds_read_b128 v[188:191], v6 offset:5120
  v_mfma_f32_16x16x32_bf16 v[100:103], v[140:143], v[124:127], v[100:103]
  s_add_u32 s69, s60, 20480
  s_cmp_eq_u32 s69, 143360
  v_mfma_f32_16x16x32_bf16 v[32:35], v[144:147], v[112:115], v[32:35]
  s_cselect_b32 s69, 0, s69
  s_sub_u32 s60, s69, s60
  v_mfma_f32_16x16x32_bf16 v[56:59], v[144:147], v[116:119], v[56:59]
  v_add_u32 v2, s60, v2
  v_add_u32 v3, s60, v3
  v_mfma_f32_16x16x32_bf16 v[80:83], v[144:147], v[120:123], v[80:83]
  v_add_u32 v4, s60, v4
  v_add_u32 v5, s60, v5
  v_mfma_f32_16x16x32_bf16 v[104:107], v[144:147], v[124:127], v[104:107]
  v_add_u32 v6, s60, v6
  s_mov_b32 s60, s69
  v_mfma_f32_16x16x32_bf16 v[36:39], v[148:151], v[112:115], v[36:39]
  v_mfma_f32_16x16x32_bf16 v[60:63], v[148:151], v[116:119], v[60:63]
  v_mfma_f32_16x16x32_bf16 v[84:87], v[148:151], v[120:123], v[84:87]
  v_mfma_f32_16x16x32_bf16 v[108:111], v[148:151], v[124:127], v[108:111]
  s_waitcnt lgkmcnt(0)
  v_mfma_f32_16x16x32_bf16 v[16:19], v[168:171], v[152:155], v[16:19]
  v_mfma_f32_16x16x32_bf16 v[40:43], v[168:171], v[156:159], v[40:43]
  v_mfma_f32_16x16x32_bf16 v[64:67], v[168:171], v[160:163], v[64:67]
  v_mfma_f32_16x16x32_bf16 v[88:91], v[168:171], v[164:167], v[88:91]
  v_mfma_f32_16x16x32_bf16 v[20:23], v[172:175], v[152:155], v[20:23]
  v_mfma_f32_16x16x32_bf16 v[44:47], v[172:175], v[156:159], v[44:47]
  v_mfma_f32_16x16x32_bf16 v[68:71], v[172:175], v[160:163], v[68:71]
  v_mfma_f32_16x16x32_bf16 v[92:95], v[172:175], v[164:167], v[92:95]
  v_mfma_f32_16x16x32_bf16 v[24:27], v[176:179], v[152:155], v[24:27]
  v_mfma_f32_16x16x32_bf16 v[48:51], v[176:179], v[156:159], v[48:51]
  v_mfma_f32_16x16x32_bf16 v[72:75], v[176:179], v[160:163], v[72:75]
  v_mfma_f32_16x16x32_bf16 v[96:99], v[176:179], v[164:167], v[96:99]
  v_mfma_f32_16x16x32_bf16 v[28:31], v[180:183], v[152:155], v[28:31]
  v_mfma_f32_16x16x32_bf16 v[52:55], v[180:183], v[156:159], v[52:55]
  v_mfma_f32_16x16x32_bf16 v[76:79], v[180:183], v[160:163], v[76:79]
  v_mfma_f32_16x16x32_bf16 v[100:103], v[180:183], v[164:167], v[100:103]
  v_mfma_f32_16x16x32_bf16 v[32:35], v[184:187], v[152:155], v[32:35]
  v_mfma_f32_16x16x32_bf16 v[56:59], v[184:187], v[156:159], v[56:59]
  v_mfma_f32_16x16x32_bf16 v[80:83], v[184:187], v[160:163], v[80:83]
  v_mfma_f32_16x16x32_bf16 v[104:107], v[184:187], v[164:167], v[104:107]
  v_mfma_f32_16x16x32_bf16 v[36:39], v[188:191], v[152:155], v[36:39]
  v_mfma_f32_16x16x32_bf16 v[60:63], v[188:191], v[156:159], v[60:63]
  v_mfma_f32_16x16x32_bf16 v[84:87], v[188:191], v[160:163], v[84:87]
  v_mfma_f32_16x16x32_bf16 v[108:111], v[188:191], v[164:167], v[108:111]
  s_and_b32 s78, s2, 0xfc
  s_add_u32 s67, s73, 1
  s_and_b32 s67, s67, 3
  s_add_u32 s67, s67, s78
  s_lshl_b32 s67, s67, 2
  s_add_u32 s67, s67, s3
  s_mul_i32 s67, s67, 12288
  s_add_u32 s79, s67, 33554432
  s_nop 1
  v_cvt_pk_bf16_f32 v112, v40, v41
  v_cvt_pk_bf16_f32 v113, v42, v43
  v_cvt_pk_bf16_f32 v114, v44, v45
  v_cvt_pk_bf16_f32 v115, v46, v47
  buffer_store_dwordx4 v[112:115], v8, s[16:19], s79 offen offset:0 sc1
  v_cvt_pk_bf16_f32 v116, v48, v49
  v_cvt_pk_bf16_f32 v117, v50, v51
  v_cvt_pk_bf16_f32 v118, v52, v53
  v_cvt_pk_bf16_f32 v119, v54, v55
  buffer_store_dwordx4 v[116:119], v8, s[16:19], s79 offen offset:1024 sc1
  v_cvt_pk_bf16_f32 v120, v56, v57
  v_cvt_pk_bf16_f32 v121, v58, v59
  v_cvt_pk_bf16_f32 v122, v60, v61
  v_cvt_pk_bf16_f32 v123, v62, v63
  buffer_store_dwordx4 v[120:123], v8, s[16:19], s79 offen offset:2048 sc1
  s_add_u32 s67, s73, 2
  s_and_b32 s67, s67, 3
  s_add_u32 s67, s67, s78
  s_lshl_b32 s67, s67, 2
  s_add_u32 s67, s67, s3
  s_mul_i32 s67, s67, 12288
  s_add_u32 s79, s67, 33557504
  v_cvt_pk_bf16_f32 v124, v64, v65
  v_cvt_pk_bf16_f32 v125, v66, v67
  v_cvt_pk_bf16_f32 v126, v68, v69
  v_cvt_pk_bf16_f32 v127, v70, v71
  buffer_store_dwordx4 v[124:127], v8, s[16:19], s79 offen offset:0 sc1
  v_cvt_pk_bf16_f32 v128, v72, v73
  v_cvt_pk_bf16_f32 v129, v74, v75
  v_cvt_pk_bf16_f32 v130, v76, v77
  v_cvt_pk_bf16_f32 v131, v78, v79
  buffer_store_dwordx4 v[128:131], v8, s[16:19], s79 offen offset:1024 sc1
  v_cvt_pk_bf16_f32 v132, v80, v81
  v_cvt_pk_bf16_f32 v133, v82, v83
  v_cvt_pk_bf16_f32 v134, v84, v85
  v_cvt_pk_bf16_f32 v135, v86, v87
  buffer_store_dwordx4 v[132:135], v8, s[16:19], s79 offen offset:2048 sc1
  s_add_u32 s67, s73, 3
  s_and_b32 s67, s67, 3
  s_add_u32 s67, s67, s78
  s_lshl_b32 s67, s67, 2
  s_add_u32 s67, s67, s3
  s_mul_i32 s67, s67, 12288
  s_add_u32 s79, s67, 33560576
  v_cvt_pk_bf16_f32 v136, v88, v89
  v_cvt_pk_bf16_f32 v137, v90, v91
  v_cvt_pk_bf16_f32 v138, v92, v93
  v_cvt_pk_bf16_f32 v139, v94, v95
  buffer_store_dwordx4 v[136:139], v8, s[16:19], s79 offen offset:0 sc1
  v_cvt_pk_bf16_f32 v140, v96, v97
  v_cvt_pk_bf16_f32 v141, v98, v99
  v_cvt_pk_bf16_f32 v142, v100, v101
  v_cvt_pk_bf16_f32 v143, v102, v103
  buffer_store_dwordx4 v[140:143], v8, s[16:19], s79 offen offset:1024 sc1
  v_cvt_pk_bf16_f32 v144, v104, v105
  v_cvt_pk_bf16_f32 v145, v106, v107
  v_cvt_pk_bf16_f32 v146, v108, v109
  v_cvt_pk_bf16_f32 v147, v110, v111
  buffer_store_dwordx4 v[144:147], v8, s[16:19], s79 offen offset:2048 sc1
  s_add_u32 s78, s78, s3
  s_lshl_b32 s78, s78, 10
  s_add_u32 s78, s78, 27721728
  s_lshl_b32 s67, s73, 7
  s_add_u32 s79, s78, s67
  v_mov_b32 v10, s54
  s_waitcnt vmcnt(0)
  v_mov_b32 v10, s54
  v_lshlrev_b32 v11, 2, v1
  s_mov_b64 exec, 1
  buffer_store_dword v10, v11, s[16:19], s79 offen sc1
  s_mov_b64 exec, -1
  v_lshlrev_b32 v240, 16, v240
  v_lshlrev_b32 v2, 16, v192
  v_and_b32 v3, 0xffff0000, v192
  v_pk_add_f32 v[16:17], v[16:17], v[2:3]
  v_lshlrev_b32 v4, 16, v193
  v_and_b32 v5, 0xffff0000, v193
  v_pk_add_f32 v[18:19], v[18:19], v[4:5]
  v_lshlrev_b32 v2, 16, v194
  v_and_b32 v3, 0xffff0000, v194
  v_pk_add_f32 v[20:21], v[20:21], v[2:3]
  v_lshlrev_b32 v4, 16, v195
  v_and_b32 v5, 0xffff0000, v195
  v_pk_add_f32 v[22:23], v[22:23], v[4:5]
  v_add_f32 v16, v16, v240
  v_add_f32 v17, v17, v240
  v_add_f32 v18, v18, v240
  v_add_f32 v19, v19, v240
  v_add_f32 v20, v20, v240
  v_add_f32 v21, v21, v240
  v_add_f32 v22, v22, v240
  v_add_f32 v23, v23, v240
  v_lshlrev_b32 v2, 16, v196
  v_and_b32 v3, 0xffff0000, v196
  v_pk_add_f32 v[24:25], v[24:25], v[2:3]
  v_lshlrev_b32 v4, 16, v197
  v_and_b32 v5, 0xffff0000, v197
  v_pk_add_f32 v[26:27], v[26:27], v[4:5]
  v_lshlrev_b32 v2, 16, v198
  v_and_b32 v3, 0xffff0000, v198
  v_pk_add_f32 v[28:29], v[28:29], v[2:3]
  v_lshlrev_b32 v4, 16, v199
  v_and_b32 v5, 0xffff0000, v199
  v_pk_add_f32 v[30:31], v[30:31], v[4:5]
  v_add_f32 v24, v24, v240
  v_add_f32 v25, v25, v240
  v_add_f32 v26, v26, v240
  v_add_f32 v27, v27, v240
  v_add_f32 v28, v28, v240
  v_add_f32 v29, v29, v240
  v_add_f32 v30, v30, v240
  v_add_f32 v31, v31, v240
  v_lshlrev_b32 v2, 16, v200
  v_and_b32 v3, 0xffff0000, v200
  v_pk_add_f32 v[32:33], v[32:33], v[2:3]
  v_lshlrev_b32 v4, 16, v201
  v_and_b32 v5, 0xffff0000, v201
  v_pk_add_f32 v[34:35], v[34:35], v[4:5]
  v_lshlrev_b32 v2, 16, v202
  v_and_b32 v3, 0xffff0000, v202
  v_pk_add_f32 v[36:37], v[36:37], v[2:3]
  v_lshlrev_b32 v4, 16, v203
  v_and_b32 v5, 0xffff0000, v203
  v_pk_add_f32 v[38:39], v[38:39], v[4:5]
  v_add_f32 v32, v32, v240
  v_add_f32 v33, v33, v240
  v_add_f32 v34, v34, v240
  v_add_f32 v35, v35, v240
  v_add_f32 v36, v36, v240
  v_add_f32 v37, v37, v240
  v_add_f32 v38, v38, v240
  v_add_f32 v39, v39, v240
  s_lshl_b32 s82, 1, s73
  s_xor_b32 s82, s82, 31
  s_mov_b32 s83, 0
  v_and_b32 v11, 7, v1
  v_lshlrev_b32 v11, 7, v11
  s_mov_b32 s68, 0x8000
L_g2_pp:
  buffer_load_dword v10, v11, s[16:19], s78 offen sc1
  s_waitcnt vmcnt(0)
  v_xor_b32 v10, s54, v10
  v_cmp_ne_u32 vcc, 0, v10
  s_sub_u32 s68, s68, 1
  s_cmp_eq_u32 s68, 0
  s_cbranch_scc1 L_g2_pp_x
  s_and_b64 vcc, vcc, s[82:83]
  s_cbranch_scc0 L_g2_pp_x
  s_sleep 1
  s_branch L_g2_pp
L_g2_pp_x:
  s_lshl_b32 s67, s2, 2
  s_add_u32 s67, s67, s3
  s_mul_i32 s67, s67, 12288
  s_add_u32 s80, s67, 33554432
  buffer_load_dwordx4 v[112:115], v8, s[16:19], s80 offen offset:0 sc1
  buffer_load_dwordx4 v[116:119], v8, s[16:19], s80 offen offset:1024 sc1
  buffer_load_dwordx4 v[120:123], v8, s[16:19], s80 offen offset:2048 sc1
  s_add_u32 s80, s67, 33557504
  buffer_load_dwordx4 v[124:127], v8, s[16:19], s80 offen offset:0 sc1
  buffer_load_dwordx4 v[128:131], v8, s[16:19], s80 offen offset:1024 sc1
  buffer_load_dwordx4 v[132:135], v8, s[16:19], s80 offen offset:2048 sc1
  s_add_u32 s80, s67, 33560576
  buffer_load_dwordx4 v[136:139], v8, s[16:19], s80 offen offset:0 sc1
  buffer_load_dwordx4 v[140:143], v8, s[16:19], s80 offen offset:1024 sc1
  buffer_load_dwordx4 v[144:147], v8, s[16:19], s80 offen offset:2048 sc1
  s_add_u32 s80, s67, 33563648
  buffer_load_dwordx4 v[148:151], v8, s[16:19], s80 offen offset:0 sc1
  buffer_load_dwordx4 v[152:155], v8, s[16:19], s80 offen offset:1024 sc1
  buffer_load_dwordx4 v[156:159], v8, s[16:19], s80 offen offset:2048 sc1
  s_waitcnt vmcnt(9)
  v_lshlrev_b32 v2, 16, v112
  v_and_b32 v3, 0xffff0000, v112
  v_pk_add_f32 v[16:17], v[16:17], v[2:3]
  v_lshlrev_b32 v4, 16, v113
  v_and_b32 v5, 0xffff0000, v113
  v_pk_add_f32 v[18:19], v[18:19], v[4:5]
  v_lshlrev_b32 v2, 16, v114
  v_and_b32 v3, 0xffff0000, v114
  v_pk_add_f32 v[20:21], v[20:21], v[2:3]
  v_lshlrev_b32 v4, 16, v115
  v_and_b32 v5, 0xffff0000, v115
  v_pk_add_f32 v[22:23], v[22:23], v[4:5]
  v_lshlrev_b32 v2, 16, v116
  v_and_b32 v3, 0xffff0000, v116
  v_pk_add_f32 v[24:25], v[24:25], v[2:3]
  v_lshlrev_b32 v4, 16, v117
  v_and_b32 v5, 0xffff0000, v117
  v_pk_add_f32 v[26:27], v[26:27], v[4:5]
  v_lshlrev_b32 v2, 16, v118
  v_and_b32 v3, 0xffff0000, v118
  v_pk_add_f32 v[28:29], v[28:29], v[2:3]
  v_lshlrev_b32 v4, 16, v119
  v_and_b32 v5, 0xffff0000, v119
  v_pk_add_f32 v[30:31], v[30:31], v[4:5]
  v_lshlrev_b32 v2, 16, v120
  v_and_b32 v3, 0xffff0000, v120
  v_pk_add_f32 v[32:33], v[32:33], v[2:3]
  v_lshlrev_b32 v4, 16, v121
  v_and_b32 v5, 0xffff0000, v121
  v_pk_add_f32 v[34:35], v[34:35], v[4:5]
  v_lshlrev_b32 v2, 16, v122
  v_and_b32 v3, 0xffff0000, v122
  v_pk_add_f32 v[36:37], v[36:37], v[2:3]
  v_lshlrev_b32 v4, 16, v123
  v_and_b32 v5, 0xffff0000, v123
  v_pk_add_f32 v[38:39], v[38:39], v[4:5]
  s_waitcnt vmcnt(6)
  v_lshlrev_b32 v2, 16, v124
  v_and_b32 v3, 0xffff0000, v124
  v_pk_add_f32 v[16:17], v[16:17], v[2:3]
  v_lshlrev_b32 v4, 16, v125
  v_and_b32 v5, 0xffff0000, v125
  v_pk_add_f32 v[18:19], v[18:19], v[4:5]
  v_lshlrev_b32 v2, 16, v126
  v_and_b32 v3, 0xffff0000, v126
  v_pk_add_f32 v[20:21], v[20:21], v[2:3]
  v_lshlrev_b32 v4, 16, v127
  v_and_b32 v5, 0xffff0000, v127
  v_pk_add_f32 v[22:23], v[22:23], v[4:5]
  v_lshlrev_b32 v2, 16, v128
  v_and_b32 v3, 0xffff0000, v128
  v_pk_add_f32 v[24:25], v[24:25], v[2:3]
  v_lshlrev_b32 v4, 16, v129
  v_and_b32 v5, 0xffff0000, v129
  v_pk_add_f32 v[26:27], v[26:27], v[4:5]
  v_lshlrev_b32 v2, 16, v130
  v_and_b32 v3, 0xffff0000, v130
  v_pk_add_f32 v[28:29], v[28:29], v[2:3]
  v_lshlrev_b32 v4, 16, v131
  v_and_b32 v5, 0xffff0000, v131
  v_pk_add_f32 v[30:31], v[30:31], v[4:5]
  v_lshlrev_b32 v2, 16, v132
  v_and_b32 v3, 0xffff0000, v132
  v_pk_add_f32 v[32:33], v[32:33], v[2:3]
  v_lshlrev_b32 v4, 16, v133
  v_and_b32 v5, 0xffff0000, v133
  v_pk_add_f32 v[34:35], v[34:35], v[4:5]
  v_lshlrev_b32 v2, 16, v134
  v_and_b32 v3, 0xffff0000, v134
  v_pk_add_f32 v[36:37], v[36:37], v[2:3]
  v_lshlrev_b32 v4, 16, v135
  v_and_b32 v5, 0xffff0000, v135
  v_pk_add_f32 v[38:39], v[38:39], v[4:5]
  s_waitcnt vmcnt(3)
  v_lshlrev_b32 v2, 16, v136
  v_and_b32 v3, 0xffff0000, v136
  v_pk_add_f32 v[16:17], v[16:17], v[2:3]
  v_lshlrev_b32 v4, 16, v137
  v_and_b32 v5, 0xffff0000, v137
  v_pk_add_f32 v[18:19], v[18:19], v[4:5]
  v_lshlrev_b32 v2, 16, v138
  v_and_b32 v3, 0xffff0000, v138
  v_pk_add_f32 v[20:21], v[20:21], v[2:3]
  v_lshlrev_b32 v4, 16, v139
  v_and_b32 v5, 0xffff0000, v139
  v_pk_add_f32 v[22:23], v[22:23], v[4:5]
  v_lshlrev_b32 v2, 16, v140
  v_and_b32 v3, 0xffff0000, v140
  v_pk_add_f32 v[24:25], v[24:25], v[2:3]
  v_lshlrev_b32 v4, 16, v141
  v_and_b32 v5, 0xffff0000, v141
  v_pk_add_f32 v[26:27], v[26:27], v[4:5]
  v_lshlrev_b32 v2, 16, v142
  v_and_b32 v3, 0xffff0000, v142
  v_pk_add_f32 v[28:29], v[28:29], v[2:3]
  v_lshlrev_b32 v4, 16, v143
  v_and_b32 v5, 0xffff0000, v143
  v_pk_add_f32 v[30:31], v[30:31], v[4:5]
  v_lshlrev_b32 v2, 16, v144
  v_and_b32 v3, 0xffff0000, v144
  v_pk_add_f32 v[32:33], v[32:33], v[2:3]
  v_lshlrev_b32 v4, 16, v145
  v_and_b32 v5, 0xffff0000, v145
  v_pk_add_f32 v[34:35], v[34:35], v[4:5]
  v_lshlrev_b32 v2, 16, v146
  v_and_b32 v3, 0xffff0000, v146
  v_pk_add_f32 v[36:37], v[36:37], v[2:3]
  v_lshlrev_b32 v4, 16, v147
  v_and_b32 v5, 0xffff0000, v147
  v_pk_add_f32 v[38:39], v[38:39], v[4:5]
  s_waitcnt vmcnt(0)
  v_lshlrev_b32 v2, 16, v148
  v_and_b32 v3, 0xffff0000, v148
  v_pk_add_f32 v[16:17], v[16:17], v[2:3]
  v_lshlrev_b32 v4, 16, v149
  v_and_b32 v5, 0xffff0000, v149
  v_pk_add_f32 v[18:19], v[18:19], v[4:5]
  v_lshlrev_b32 v2, 16, v150
  v_and_b32 v3, 0xffff0000, v150
  v_pk_add_f32 v[20:21], v[20:21], v[2:3]
  v_lshlrev_b32 v4, 16, v151
  v_and_b32 v5, 0xffff0000, v151
  v_pk_add_f32 v[22:23], v[22:23], v[4:5]
  v_lshlrev_b32 v2, 16, v152
  v_and_b32 v3, 0xffff0000, v152
  v_pk_add_f32 v[24:25], v[24:25], v[2:3]
  v_lshlrev_b32 v4, 16, v153
  v_and_b32 v5, 0xffff0000, v153
  v_pk_add_f32 v[26:27], v[26:27], v[4:5]
  v_lshlrev_b32 v2, 16, v154
  v_and_b32 v3, 0xffff0000, v154
  v_pk_add_f32 v[28:29], v[28:29], v[2:3]
  v_lshlrev_b32 v4, 16, v155
  v_and_b32 v5, 0xffff0000, v155
  v_pk_add_f32 v[30:31], v[30:31], v[4:5]
  v_lshlrev_b32 v2, 16, v156
  v_and_b32 v3, 0xffff0000, v156
  v_pk_add_f32 v[32:33], v[32:33], v[2:3]
  v_lshlrev_b32 v4, 16, v157
  v_and_b32 v5, 0xffff0000, v157
  v_pk_add_f32 v[34:35], v[34:35], v[4:5]
  v_lshlrev_b32 v2, 16, v158
  v_and_b32 v3, 0xffff0000, v158
  v_pk_add_f32 v[36:37], v[36:37], v[2:3]
  v_lshlrev_b32 v4, 16, v159
  v_and_b32 v5, 0xffff0000, v159
  v_pk_add_f32 v[38:39], v[38:39], v[4:5]
  v_cvt_pk_bf16_f32 v192, v16, v17
  v_cvt_pk_bf16_f32 v193, v18, v19
  v_cvt_pk_bf16_f32 v194, v20, v21
  v_cvt_pk_bf16_f32 v195, v22, v23
  buffer_store_dwordx4 v[192:195], v9, s[48:51], s75 offen offset:0
  v_cvt_pk_bf16_f32 v196, v24, v25
  v_cvt_pk_bf16_f32 v197, v26, v27
  v_cvt_pk_bf16_f32 v198, v28, v29
  v_cvt_pk_bf16_f32 v199, v30, v31
  buffer_store_dwordx4 v[196:199], v9, s[48:51], s75 offen offset:64
  v_cvt_pk_bf16_f32 v200, v32, v33
  v_cvt_pk_bf16_f32 v201, v34, v35
  v_cvt_pk_bf16_f32 v202, v36, v37
  v_cvt_pk_bf16_f32 v203, v38, v39
  buffer_store_dwordx4 v[200:203], v9, s[48:51], s75 offen offset:128
  s_or_b32 s78, s2, s3
  s_cmp_lg_u32 s78, 0
  s_cbranch_scc1 L_fin
  s_mov_b32 s78, 28049408
  v_mov_b32 v10, s54
  s_mov_b64 exec, 1
  buffer_store_dword v10, off, s[16:19], s78
  s_mov_b64 exec, -1
  s_branch L_fin
L_kv_cons:
  v_lshrrev_b32 v5, 4, v1
  v_bfe_u32 v6, v1, 2, 2
  v_and_b32 v7, 3, v1
  v_lshl_add_u32 v8, v5, 3, v6
  v_mul_u32_u24 v8, 576, v8
  v_lshl_add_u32 v8, v7, 3, v8
  v_add_u32 v8, 8192, v8
  v_and_b32 v9, 1, v5
  v_lshlrev_b32 v9, 5, v9
  v_add_u32 v2, v8, v9
  v_sub_u32 v3, v8, v9
  v_lshlrev_b32 v4, 4, v1
  s_lshl_b32 s67, s3, 11
  v_add_u32 v4, s67, v4
  v_mov_b32 v12, 0
  v_mov_b32 v13, 0
  v_mov_b32 v14, 0
  v_mov_b32 v15, 0
  v_mov_b32 v16, 0
  v_mov_b32 v17, 0
  v_mov_b32 v18, 0
  v_mov_b32 v19, 0
  v_mov_b32 v20, 0
  v_mov_b32 v21, 0
  v_mov_b32 v22, 0
  v_mov_b32 v23, 0
  v_mov_b32 v24, 0
  v_mov_b32 v25, 0
  v_mov_b32 v26, 0
  v_mov_b32 v27, 0
  v_mov_b32 v28, 0
  v_mov_b32 v29, 0
  v_mov_b32 v30, 0
  v_mov_b32 v31, 0
  v_mov_b32 v32, 0
  v_mov_b32 v33, 0
  v_mov_b32 v34, 0
  v_mov_b32 v35, 0
  v_mov_b32 v36, 0
  v_mov_b32 v37, 0
  v_mov_b32 v38, 0
  v_mov_b32 v39, 0
  v_mov_b32 v40, 0
  v_mov_b32 v41, 0
  v_mov_b32 v42, 0
  v_mov_b32 v43, 0
  v_mov_b32 v44, 0
  v_mov_b32 v45, 0
  v_mov_b32 v46, 0
  v_mov_b32 v47, 0
  v_mov_b32 v48, 0
  v_mov_b32 v49, 0
  v_mov_b32 v50, 0
  v_mov_b32 v51, 0
  v_mov_b32 v52, 0
  v_mov_b32 v53, 0
  v_mov_b32 v54, 0
  v_mov_b32 v55, 0
  v_mov_b32 v56, 0
  v_mov_b32 v57, 0
  v_mov_b32 v58, 0
  v_mov_b32 v59, 0
  v_mov_b32 v60, 0
  v_mov_b32 v61, 0
  v_mov_b32 v62, 0
  v_mov_b32 v63, 0
  v_mov_b32 v64, 0
  v_mov_b32 v65, 0
  v_mov_b32 v66, 0
  v_mov_b32 v67, 0
  v_mov_b32 v68, 0
  v_mov_b32 v69, 0
  v_mov_b32 v70, 0
  v_mov_b32 v71, 0
  v_mov_b32 v72, 0
  v_mov_b32 v73, 0
  v_mov_b32 v74, 0
  v_mov_b32 v75, 0
  v_mov_b32 v76, 0
  v_mov_b32 v77, 0
  v_mov_b32 v78, 0
  v_mov_b32 v79, 0
  v_mov_b32 v80, 0
  v_mov_b32 v81, 0
  v_mov_b32 v82, 0
  v_mov_b32 v83, 0
  v_mov_b32 v84, 0
  v_mov_b32 v85, 0
  v_mov_b32 v86, 0
  v_mov_b32 v87, 0
  v_mov_b32 v88, 0
  v_mov_b32 v89, 0
  v_mov_b32 v90, 0
  v_mov_b32 v91, 0
  v_mov_b32 v92, 0
  v_mov_b32 v93, 0
  v_mov_b32 v94, 0
  v_mov_b32 v95, 0
  v_mov_b32 v96, 0
  v_mov_b32 v97, 0
  v_mov_b32 v98, 0
  v_mov_b32 v99, 0
  v_mov_b32 v100, 0
  v_mov_b32 v101, 0
  v_mov_b32 v102, 0
  v_mov_b32 v103, 0
  v_mov_b32 v104, 0
  v_mov_b32 v105, 0
  v_mov_b32 v106, 0
  v_mov_b32 v107, 0
  v_mov_b32 v108, 0
  v_mov_b32 v109, 0
  v_mov_b32 v110, 0
  v_mov_b32 v111, 0
  v_mov_b32 v112, 0
  v_mov_b32 v113, 0
  v_mov_b32 v114, 0
  v_mov_b32 v115, 0
  v_mov_b32 v116, 0
  v_mov_b32 v117, 0
  v_mov_b32 v118, 0
  v_mov_b32 v119, 0
  v_mov_b32 v120, 0
  v_mov_b32 v121, 0
  v_mov_b32 v122, 0
  v_mov_b32 v123, 0
  v_mov_b32 v124, 0
  v_mov_b32 v125, 0
  v_mov_b32 v126, 0
  v_mov_b32 v127, 0
  v_mov_b32 v128, 0
  v_mov_b32 v129, 0
  v_mov_b32 v130, 0
  v_mov_b32 v131, 0
  v_mov_b32 v132, 0
  v_mov_b32 v133, 0
  v_mov_b32 v134, 0
  v_mov_b32 v135, 0
  v_mov_b32 v136, 0
  v_mov_b32 v137, 0
  v_mov_b32 v138, 0
  v_mov_b32 v139, 0
  v_mov_b32 v140, 0
  v_mov_b32 v141, 0
  v_mov_b32 v142, 0
  v_mov_b32 v143, 0
  v_mov_b32 v144, 0
  v_mov_b32 v145, 0
  v_mov_b32 v146, 0
  v_mov_b32 v147, 0
  v_mov_b32 v148, 0
  v_mov_b32 v149, 0
  v_mov_b32 v150, 0
  v_mov_b32 v151, 0
  v_mov_b32 v152, 0
  v_mov_b32 v153, 0
  v_mov_b32 v154, 0
  v_mov_b32 v155, 0
  s_mov_b32 s60, 0
  s_barrier
  s_barrier
  ds_read_b128 v[228:231], v4 offset:0
  ds_read_b128 v[232:235], v4 offset:1024
  ds_read_b64_tr_b16 v[156:157], v2 offset:0
  ds_read_b64_tr_b16 v[158:159], v2 offset:2304
  ds_read_b64_tr_b16 v[160:161], v3 offset:32
  ds_read_b64_tr_b16 v[162:163], v3 offset:2336
  ds_read_b64_tr_b16 v[164:165], v2 offset:64
  ds_read_b64_tr_b16 v[166:167], v2 offset:2368
  ds_read_b64_tr_b16 v[168:169], v3 offset:96
  ds_read_b64_tr_b16 v[170:171], v3 offset:2400
  ds_read_b64_tr_b16 v[172:173], v2 offset:128
  ds_read_b64_tr_b16 v[174:175], v2 offset:2432
  ds_read_b64_tr_b16 v[176:177], v3 offset:160
  ds_read_b64_tr_b16 v[178:179], v3 offset:2464
  ds_read_b64_tr_b16 v[180:181], v2 offset:192
  ds_read_b64_tr_b16 v[182:183], v2 offset:2496
  ds_read_b64_tr_b16 v[184:185], v3 offset:224
  ds_read_b64_tr_b16 v[186:187], v3 offset:2528
  ds_read_b64_tr_b16 v[188:189], v2 offset:256
  ds_read_b64_tr_b16 v[190:191], v2 offset:2560
  ds_read_b64_tr_b16 v[192:193], v3 offset:288
  ds_read_b64_tr_b16 v[194:195], v3 offset:2592
  ds_read_b64_tr_b16 v[196:197], v2 offset:320
  ds_read_b64_tr_b16 v[198:199], v2 offset:2624
  ds_read_b64_tr_b16 v[200:201], v3 offset:352
  ds_read_b64_tr_b16 v[202:203], v3 offset:2656
  ds_read_b64_tr_b16 v[204:205], v2 offset:384
  ds_read_b64_tr_b16 v[206:207], v2 offset:2688
  ds_read_b64_tr_b16 v[208:209], v3 offset:416
  ds_read_b64_tr_b16 v[210:211], v3 offset:2720
  ds_read_b64_tr_b16 v[212:213], v2 offset:448
  ds_read_b64_tr_b16 v[214:215], v2 offset:2752
  ds_read_b64_tr_b16 v[216:217], v3 offset:480
  ds_read_b64_tr_b16 v[218:219], v3 offset:2784
  ds_read_b64_tr_b16 v[220:221], v2 offset:512
  ds_read_b64_tr_b16 v[222:223], v2 offset:2816
  ds_read_b64_tr_b16 v[224:225], v3 offset:544
  ds_read_b64_tr_b16 v[226:227], v3 offset:2848
  s_waitcnt lgkmcnt(0)
  s_mov_b32 s61, 8
L_kv_main:
  s_waitcnt lgkmcnt(8)
  v_mfma_f32_16x16x32_bf16 v[12:15], v[228:231], v[156:159], v[12:15]
  s_barrier
  v_mfma_f32_16x16x32_bf16 v[84:87], v[232:235], v[156:159], v[84:87]
  s_add_u32 s69, s60, 26624
  s_cmp_eq_u32 s69, 133120
  v_mfma_f32_16x16x32_bf16 v[16:19], v[228:231], v[160:163], v[16:19]
  s_cselect_b32 s69, 0, s69
  s_sub_u32 s60, s69, s60
  v_mfma_f32_16x16x32_bf16 v[88:91], v[232:235], v[160:163], v[88:91]
  v_add_u32 v2, s60, v2
  v_add_u32 v3, s60, v3
  v_mfma_f32_16x16x32_bf16 v[20:23], v[228:231], v[164:167], v[20:23]
  v_add_u32 v4, s60, v4
  s_mov_b32 s60, s69
  v_mfma_f32_16x16x32_bf16 v[92:95], v[232:235], v[164:167], v[92:95]
  ds_read_b128 v[236:239], v4 offset:0
  v_mfma_f32_16x16x32_bf16 v[24:27], v[228:231], v[168:171], v[24:27]
  ds_read_b128 v[240:243], v4 offset:1024
  ds_read_b64_tr_b16 v[156:157], v2 offset:0
  v_mfma_f32_16x16x32_bf16 v[96:99], v[232:235], v[168:171], v[96:99]
  ds_read_b64_tr_b16 v[158:159], v2 offset:2304
  ds_read_b64_tr_b16 v[160:161], v3 offset:32
  v_mfma_f32_16x16x32_bf16 v[28:31], v[228:231], v[172:175], v[28:31]
  ds_read_b64_tr_b16 v[162:163], v3 offset:2336
  ds_read_b64_tr_b16 v[164:165], v2 offset:64
  v_mfma_f32_16x16x32_bf16 v[100:103], v[232:235], v[172:175], v[100:103]
  ds_read_b64_tr_b16 v[166:167], v2 offset:2368
  ds_read_b64_tr_b16 v[168:169], v3 offset:96
  v_mfma_f32_16x16x32_bf16 v[32:35], v[228:231], v[176:179], v[32:35]
  ds_read_b64_tr_b16 v[170:171], v3 offset:2400
  ds_read_b64_tr_b16 v[172:173], v2 offset:128
  v_mfma_f32_16x16x32_bf16 v[104:107], v[232:235], v[176:179], v[104:107]
  ds_read_b64_tr_b16 v[174:175], v2 offset:2432
  ds_read_b64_tr_b16 v[176:177], v3 offset:160
  v_mfma_f32_16x16x32_bf16 v[36:39], v[228:231], v[180:183], v[36:39]
  ds_read_b64_tr_b16 v[178:179], v3 offset:2464
  v_mfma_f32_16x16x32_bf16 v[108:111], v[232:235], v[180:183], v[108:111]
  ds_read_b64_tr_b16 v[180:181], v2 offset:192
  v_mfma_f32_16x16x32_bf16 v[40:43], v[228:231], v[184:187], v[40:43]
  ds_read_b64_tr_b16 v[182:183], v2 offset:2496
  v_mfma_f32_16x16x32_bf16 v[112:115], v[232:235], v[184:187], v[112:115]
  ds_read_b64_tr_b16 v[184:185], v3 offset:224
  v_mfma_f32_16x16x32_bf16 v[44:47], v[228:231], v[188:191], v[44:47]
  ds_read_b64_tr_b16 v[186:187], v3 offset:2528
  v_mfma_f32_16x16x32_bf16 v[116:119], v[232:235], v[188:191], v[116:119]
  ds_read_b64_tr_b16 v[188:189], v2 offset:256
  v_mfma_f32_16x16x32_bf16 v[48:51], v[228:231], v[192:195], v[48:51]
  ds_read_b64_tr_b16 v[190:191], v2 offset:2560
  v_mfma_f32_16x16x32_bf16 v[120:123], v[232:235], v[192:195], v[120:123]
  ds_read_b64_tr_b16 v[192:193], v3 offset:288
  v_mfma_f32_16x16x32_bf16 v[52:55], v[228:231], v[196:199], v[52:55]
  ds_read_b64_tr_b16 v[194:195], v3 offset:2592
  v_mfma_f32_16x16x32_bf16 v[124:127], v[232:235], v[196:199], v[124:127]
  ds_read_b64_tr_b16 v[196:197], v2 offset:320
  v_mfma_f32_16x16x32_bf16 v[56:59], v[228:231], v[200:203], v[56:59]
  ds_read_b64_tr_b16 v[198:199], v2 offset:2624
  v_mfma_f32_16x16x32_bf16 v[128:131], v[232:235], v[200:203], v[128:131]
  ds_read_b64_tr_b16 v[200:201], v3 offset:352
  v_mfma_f32_16x16x32_bf16 v[60:63], v[228:231], v[204:207], v[60:63]
  ds_read_b64_tr_b16 v[202:203], v3 offset:2656
  v_mfma_f32_16x16x32_bf16 v[132:135], v[232:235], v[204:207], v[132:135]
  ds_read_b64_tr_b16 v[204:205], v2 offset:384
  v_mfma_f32_16x16x32_bf16 v[64:67], v[228:231], v[208:211], v[64:67]
  ds_read_b64_tr_b16 v[206:207], v2 offset:2688
  v_mfma_f32_16x16x32_bf16 v[136:139], v[232:235], v[208:211], v[136:139]
  ds_read_b64_tr_b16 v[208:209], v3 offset:416
  s_waitcnt lgkmcnt(8)
  v_mfma_f32_16x16x32_bf16 v[68:71], v[228:231], v[212:215], v[68:71]
  ds_read_b64_tr_b16 v[210:211], v3 offset:2720
  v_mfma_f32_16x16x32_bf16 v[140:143], v[232:235], v[212:215], v[140:143]
  ds_read_b64_tr_b16 v[212:213], v2 offset:448
  v_mfma_f32_16x16x32_bf16 v[72:75], v[228:231], v[216:219], v[72:75]
  ds_read_b64_tr_b16 v[214:215], v2 offset:2752
  v_mfma_f32_16x16x32_bf16 v[144:147], v[232:235], v[216:219], v[144:147]
  ds_read_b64_tr_b16 v[216:217], v3 offset:480
  v_mfma_f32_16x16x32_bf16 v[76:79], v[228:231], v[220:223], v[76:79]
  ds_read_b64_tr_b16 v[218:219], v3 offset:2784
  v_mfma_f32_16x16x32_bf16 v[148:151], v[232:235], v[220:223], v[148:151]
  ds_read_b64_tr_b16 v[220:221], v2 offset:512
  v_mfma_f32_16x16x32_bf16 v[80:83], v[228:231], v[224:227], v[80:83]
  ds_read_b64_tr_b16 v[222:223], v2 offset:2816
  v_mfma_f32_16x16x32_bf16 v[152:155], v[232:235], v[224:227], v[152:155]
  ds_read_b64_tr_b16 v[224:225], v3 offset:544
  ds_read_b64_tr_b16 v[226:227], v3 offset:2848
  s_waitcnt lgkmcnt(8)
  v_mfma_f32_16x16x32_bf16 v[12:15], v[236:239], v[156:159], v[12:15]
  s_barrier
  v_mfma_f32_16x16x32_bf16 v[84:87], v[240:243], v[156:159], v[84:87]
  s_add_u32 s69, s60, 26624
  s_cmp_eq_u32 s69, 133120
  v_mfma_f32_16x16x32_bf16 v[16:19], v[236:239], v[160:163], v[16:19]
  s_cselect_b32 s69, 0, s69
  s_sub_u32 s60, s69, s60
  v_mfma_f32_16x16x32_bf16 v[88:91], v[240:243], v[160:163], v[88:91]
  v_add_u32 v2, s60, v2
  v_add_u32 v3, s60, v3
  v_mfma_f32_16x16x32_bf16 v[20:23], v[236:239], v[164:167], v[20:23]
  v_add_u32 v4, s60, v4
  s_mov_b32 s60, s69
  v_mfma_f32_16x16x32_bf16 v[92:95], v[240:243], v[164:167], v[92:95]
  ds_read_b128 v[228:231], v4 offset:0
  v_mfma_f32_16x16x32_bf16 v[24:27], v[236:239], v[168:171], v[24:27]
  ds_read_b128 v[232:235], v4 offset:1024
  ds_read_b64_tr_b16 v[156:157], v2 offset:0
  v_mfma_f32_16x16x32_bf16 v[96:99], v[240:243], v[168:171], v[96:99]
  ds_read_b64_tr_b16 v[158:159], v2 offset:2304
  ds_read_b64_tr_b16 v[160:161], v3 offset:32
  v_mfma_f32_16x16x32_bf16 v[28:31], v[236:239], v[172:175], v[28:31]
  ds_read_b64_tr_b16 v[162:163], v3 offset:2336
  ds_read_b64_tr_b16 v[164:165], v2 offset:64
  v_mfma_f32_16x16x32_bf16 v[100:103], v[240:243], v[172:175], v[100:103]
  ds_read_b64_tr_b16 v[166:167], v2 offset:2368
  ds_read_b64_tr_b16 v[168:169], v3 offset:96
  v_mfma_f32_16x16x32_bf16 v[32:35], v[236:239], v[176:179], v[32:35]
  ds_read_b64_tr_b16 v[170:171], v3 offset:2400
  ds_read_b64_tr_b16 v[172:173], v2 offset:128
  v_mfma_f32_16x16x32_bf16 v[104:107], v[240:243], v[176:179], v[104:107]
  ds_read_b64_tr_b16 v[174:175], v2 offset:2432
  ds_read_b64_tr_b16 v[176:177], v3 offset:160
  v_mfma_f32_16x16x32_bf16 v[36:39], v[236:239], v[180:183], v[36:39]
  ds_read_b64_tr_b16 v[178:179], v3 offset:2464
  v_mfma_f32_16x16x32_bf16 v[108:111], v[240:243], v[180:183], v[108:111]
  ds_read_b64_tr_b16 v[180:181], v2 offset:192
  v_mfma_f32_16x16x32_bf16 v[40:43], v[236:239], v[184:187], v[40:43]
  ds_read_b64_tr_b16 v[182:183], v2 offset:2496
  v_mfma_f32_16x16x32_bf16 v[112:115], v[240:243], v[184:187], v[112:115]
  ds_read_b64_tr_b16 v[184:185], v3 offset:224
  v_mfma_f32_16x16x32_bf16 v[44:47], v[236:239], v[188:191], v[44:47]
  ds_read_b64_tr_b16 v[186:187], v3 offset:2528
  v_mfma_f32_16x16x32_bf16 v[116:119], v[240:243], v[188:191], v[116:119]
  ds_read_b64_tr_b16 v[188:189], v2 offset:256
  v_mfma_f32_16x16x32_bf16 v[48:51], v[236:239], v[192:195], v[48:51]
  ds_read_b64_tr_b16 v[190:191], v2 offset:2560
  v_mfma_f32_16x16x32_bf16 v[120:123], v[240:243], v[192:195], v[120:123]
  ds_read_b64_tr_b16 v[192:193], v3 offset:288
  v_mfma_f32_16x16x32_bf16 v[52:55], v[236:239], v[196:199], v[52:55]
  ds_read_b64_tr_b16 v[194:195], v3 offset:2592
  v_mfma_f32_16x16x32_bf16 v[124:127], v[240:243], v[196:199], v[124:127]
  ds_read_b64_tr_b16 v[196:197], v2 offset:320
  v_mfma_f32_16x16x32_bf16 v[56:59], v[236:239], v[200:203], v[56:59]
  ds_read_b64_tr_b16 v[198:199], v2 offset:2624
  v_mfma_f32_16x16x32_bf16 v[128:131], v[240:243], v[200:203], v[128:131]
  ds_read_b64_tr_b16 v[200:201], v3 offset:352
  v_mfma_f32_16x16x32_bf16 v[60:63], v[236:239], v[204:207], v[60:63]
  ds_read_b64_tr_b16 v[202:203], v3 offset:2656
  v_mfma_f32_16x16x32_bf16 v[132:135], v[240:243], v[204:207], v[132:135]
  ds_read_b64_tr_b16 v[204:205], v2 offset:384
  v_mfma_f32_16x16x32_bf16 v[64:67], v[236:239], v[208:211], v[64:67]
  ds_read_b64_tr_b16 v[206:207], v2 offset:2688
  v_mfma_f32_16x16x32_bf16 v[136:139], v[240:243], v[208:211], v[136:139]
  ds_read_b64_tr_b16 v[208:209], v3 offset:416
  s_waitcnt lgkmcnt(8)
  v_mfma_f32_16x16x32_bf16 v[68:71], v[236:239], v[212:215], v[68:71]
  ds_read_b64_tr_b16 v[210:211], v3 offset:2720
  v_mfma_f32_16x16x32_bf16 v[140:143], v[240:243], v[212:215], v[140:143]
  ds_read_b64_tr_b16 v[212:213], v2 offset:448
  v_mfma_f32_16x16x32_bf16 v[72:75], v[236:239], v[216:219], v[72:75]
  ds_read_b64_tr_b16 v[214:215], v2 offset:2752
  v_mfma_f32_16x16x32_bf16 v[144:147], v[240:243], v[216:219], v[144:147]
  ds_read_b64_tr_b16 v[216:217], v3 offset:480
  v_mfma_f32_16x16x32_bf16 v[76:79], v[236:239], v[220:223], v[76:79]
  ds_read_b64_tr_b16 v[218:219], v3 offset:2784
  v_mfma_f32_16x16x32_bf16 v[148:151], v[240:243], v[220:223], v[148:151]
  ds_read_b64_tr_b16 v[220:221], v2 offset:512
  s_sub_u32 s61, s61, 1
  s_cmp_lg_u32 s61, 0
  v_mfma_f32_16x16x32_bf16 v[80:83], v[236:239], v[224:227], v[80:83]
  ds_read_b64_tr_b16 v[222:223], v2 offset:2816
  v_mfma_f32_16x16x32_bf16 v[152:155], v[240:243], v[224:227], v[152:155]
  ds_read_b64_tr_b16 v[224:225], v3 offset:544
  ds_read_b64_tr_b16 v[226:227], v3 offset:2848
  s_cbranch_scc1 L_kv_main
  s_waitcnt lgkmcnt(8)
  v_mfma_f32_16x16x32_bf16 v[12:15], v[228:231], v[156:159], v[12:15]
  s_barrier
  v_mfma_f32_16x16x32_bf16 v[84:87], v[232:235], v[156:159], v[84:87]
  s_add_u32 s69, s60, 26624
  s_cmp_eq_u32 s69, 133120
  v_mfma_f32_16x16x32_bf16 v[16:19], v[228:231], v[160:163], v[16:19]
  s_cselect_b32 s69, 0, s69
  s_sub_u32 s60, s69, s60
  v_mfma_f32_16x16x32_bf16 v[88:91], v[232:235], v[160:163], v[88:91]
  v_add_u32 v2, s60, v2
  v_add_u32 v3, s60, v3
  v_mfma_f32_16x16x32_bf16 v[20:23], v[228:231], v[164:167], v[20:23]
  v_add_u32 v4, s60, v4
  s_mov_b32 s60, s69
  v_mfma_f32_16x16x32_bf16 v[92:95], v[232:235], v[164:167], v[92:95]
  ds_read_b128 v[236:239], v4 offset:0
  v_mfma_f32_16x16x32_bf16 v[24:27], v[228:231], v[168:171], v[24:27]
  ds_read_b128 v[240:243], v4 offset:1024
  ds_read_b64_tr_b16 v[156:157], v2 offset:0
  v_mfma_f32_16x16x32_bf16 v[96:99], v[232:235], v[168:171], v[96:99]
  ds_read_b64_tr_b16 v[158:159], v2 offset:2304
  ds_read_b64_tr_b16 v[160:161], v3 offset:32
  v_mfma_f32_16x16x32_bf16 v[28:31], v[228:231], v[172:175], v[28:31]
  ds_read_b64_tr_b16 v[162:163], v3 offset:2336
  ds_read_b64_tr_b16 v[164:165], v2 offset:64
  v_mfma_f32_16x16x32_bf16 v[100:103], v[232:235], v[172:175], v[100:103]
  ds_read_b64_tr_b16 v[166:167], v2 offset:2368
  ds_read_b64_tr_b16 v[168:169], v3 offset:96
  v_mfma_f32_16x16x32_bf16 v[32:35], v[228:231], v[176:179], v[32:35]
  ds_read_b64_tr_b16 v[170:171], v3 offset:2400
  ds_read_b64_tr_b16 v[172:173], v2 offset:128
  v_mfma_f32_16x16x32_bf16 v[104:107], v[232:235], v[176:179], v[104:107]
  ds_read_b64_tr_b16 v[174:175], v2 offset:2432
  ds_read_b64_tr_b16 v[176:177], v3 offset:160
  v_mfma_f32_16x16x32_bf16 v[36:39], v[228:231], v[180:183], v[36:39]
  ds_read_b64_tr_b16 v[178:179], v3 offset:2464
  v_mfma_f32_16x16x32_bf16 v[108:111], v[232:235], v[180:183], v[108:111]
  ds_read_b64_tr_b16 v[180:181], v2 offset:192
  v_mfma_f32_16x16x32_bf16 v[40:43], v[228:231], v[184:187], v[40:43]
  ds_read_b64_tr_b16 v[182:183], v2 offset:2496
  v_mfma_f32_16x16x32_bf16 v[112:115], v[232:235], v[184:187], v[112:115]
  ds_read_b64_tr_b16 v[184:185], v3 offset:224
  v_mfma_f32_16x16x32_bf16 v[44:47], v[228:231], v[188:191], v[44:47]
  ds_read_b64_tr_b16 v[186:187], v3 offset:2528
  v_mfma_f32_16x16x32_bf16 v[116:119], v[232:235], v[188:191], v[116:119]
  ds_read_b64_tr_b16 v[188:189], v2 offset:256
  v_mfma_f32_16x16x32_bf16 v[48:51], v[228:231], v[192:195], v[48:51]
  ds_read_b64_tr_b16 v[190:191], v2 offset:2560
  v_mfma_f32_16x16x32_bf16 v[120:123], v[232:235], v[192:195], v[120:123]
  ds_read_b64_tr_b16 v[192:193], v3 offset:288
  v_mfma_f32_16x16x32_bf16 v[52:55], v[228:231], v[196:199], v[52:55]
  ds_read_b64_tr_b16 v[194:195], v3 offset:2592
  v_mfma_f32_16x16x32_bf16 v[124:127], v[232:235], v[196:199], v[124:127]
  ds_read_b64_tr_b16 v[196:197], v2 offset:320
  v_mfma_f32_16x16x32_bf16 v[56:59], v[228:231], v[200:203], v[56:59]
  ds_read_b64_tr_b16 v[198:199], v2 offset:2624
  v_mfma_f32_16x16x32_bf16 v[128:131], v[232:235], v[200:203], v[128:131]
  ds_read_b64_tr_b16 v[200:201], v3 offset:352
  v_mfma_f32_16x16x32_bf16 v[60:63], v[228:231], v[204:207], v[60:63]
  ds_read_b64_tr_b16 v[202:203], v3 offset:2656
  v_mfma_f32_16x16x32_bf16 v[132:135], v[232:235], v[204:207], v[132:135]
  ds_read_b64_tr_b16 v[204:205], v2 offset:384
  v_mfma_f32_16x16x32_bf16 v[64:67], v[228:231], v[208:211], v[64:67]
  ds_read_b64_tr_b16 v[206:207], v2 offset:2688
  v_mfma_f32_16x16x32_bf16 v[136:139], v[232:235], v[208:211], v[136:139]
  ds_read_b64_tr_b16 v[208:209], v3 offset:416
  s_waitcnt lgkmcnt(8)
  v_mfma_f32_16x16x32_bf16 v[68:71], v[228:231], v[212:215], v[68:71]
  ds_read_b64_tr_b16 v[210:211], v3 offset:2720
  v_mfma_f32_16x16x32_bf16 v[140:143], v[232:235], v[212:215], v[140:143]
  ds_read_b64_tr_b16 v[212:213], v2 offset:448
  v_mfma_f32_16x16x32_bf16 v[72:75], v[228:231], v[216:219], v[72:75]
  ds_read_b64_tr_b16 v[214:215], v2 offset:2752
  v_mfma_f32_16x16x32_bf16 v[144:147], v[232:235], v[216:219], v[144:147]
  ds_read_b64_tr_b16 v[216:217], v3 offset:480
  v_mfma_f32_16x16x32_bf16 v[76:79], v[228:231], v[220:223], v[76:79]
  ds_read_b64_tr_b16 v[218:219], v3 offset:2784
  v_mfma_f32_16x16x32_bf16 v[148:151], v[232:235], v[220:223], v[148:151]
  ds_read_b64_tr_b16 v[220:221], v2 offset:512
  v_mfma_f32_16x16x32_bf16 v[80:83], v[228:231], v[224:227], v[80:83]
  ds_read_b64_tr_b16 v[222:223], v2 offset:2816
  v_mfma_f32_16x16x32_bf16 v[152:155], v[232:235], v[224:227], v[152:155]
  ds_read_b64_tr_b16 v[224:225], v3 offset:544
  ds_read_b64_tr_b16 v[226:227], v3 offset:2848
  s_waitcnt lgkmcnt(8)
  v_mfma_f32_16x16x32_bf16 v[12:15], v[236:239], v[156:159], v[12:15]
  v_mfma_f32_16x16x32_bf16 v[84:87], v[240:243], v[156:159], v[84:87]
  v_mfma_f32_16x16x32_bf16 v[16:19], v[236:239], v[160:163], v[16:19]
  v_mfma_f32_16x16x32_bf16 v[88:91], v[240:243], v[160:163], v[88:91]
  v_mfma_f32_16x16x32_bf16 v[20:23], v[236:239], v[164:167], v[20:23]
  v_mfma_f32_16x16x32_bf16 v[92:95], v[240:243], v[164:167], v[92:95]
  v_mfma_f32_16x16x32_bf16 v[24:27], v[236:239], v[168:171], v[24:27]
  v_mfma_f32_16x16x32_bf16 v[96:99], v[240:243], v[168:171], v[96:99]
  v_mfma_f32_16x16x32_bf16 v[28:31], v[236:239], v[172:175], v[28:31]
  v_mfma_f32_16x16x32_bf16 v[100:103], v[240:243], v[172:175], v[100:103]
  v_mfma_f32_16x16x32_bf16 v[32:35], v[236:239], v[176:179], v[32:35]
  v_mfma_f32_16x16x32_bf16 v[104:107], v[240:243], v[176:179], v[104:107]
  v_mfma_f32_16x16x32_bf16 v[36:39], v[236:239], v[180:183], v[36:39]
  v_mfma_f32_16x16x32_bf16 v[108:111], v[240:243], v[180:183], v[108:111]
  v_mfma_f32_16x16x32_bf16 v[40:43], v[236:239], v[184:187], v[40:43]
  v_mfma_f32_16x16x32_bf16 v[112:115], v[240:243], v[184:187], v[112:115]
  v_mfma_f32_16x16x32_bf16 v[44:47], v[236:239], v[188:191], v[44:47]
  v_mfma_f32_16x16x32_bf16 v[116:119], v[240:243], v[188:191], v[116:119]
  v_mfma_f32_16x16x32_bf16 v[48:51], v[236:239], v[192:195], v[48:51]
  v_mfma_f32_16x16x32_bf16 v[120:123], v[240:243], v[192:195], v[120:123]
  v_mfma_f32_16x16x32_bf16 v[52:55], v[236:239], v[196:199], v[52:55]
  v_mfma_f32_16x16x32_bf16 v[124:127], v[240:243], v[196:199], v[124:127]
  v_mfma_f32_16x16x32_bf16 v[56:59], v[236:239], v[200:203], v[56:59]
  v_mfma_f32_16x16x32_bf16 v[128:131], v[240:243], v[200:203], v[128:131]
  v_mfma_f32_16x16x32_bf16 v[60:63], v[236:239], v[204:207], v[60:63]
  v_mfma_f32_16x16x32_bf16 v[132:135], v[240:243], v[204:207], v[132:135]
  v_mfma_f32_16x16x32_bf16 v[64:67], v[236:239], v[208:211], v[64:67]
  v_mfma_f32_16x16x32_bf16 v[136:139], v[240:243], v[208:211], v[136:139]
  s_waitcnt lgkmcnt(6)
  v_mfma_f32_16x16x32_bf16 v[68:71], v[236:239], v[212:215], v[68:71]
  v_mfma_f32_16x16x32_bf16 v[140:143], v[240:243], v[212:215], v[140:143]
  s_waitcnt lgkmcnt(4)
  v_mfma_f32_16x16x32_bf16 v[72:75], v[236:239], v[216:219], v[72:75]
  v_mfma_f32_16x16x32_bf16 v[144:147], v[240:243], v[216:219], v[144:147]
  s_waitcnt lgkmcnt(2)
  v_mfma_f32_16x16x32_bf16 v[76:79], v[236:239], v[220:223], v[76:79]
  v_mfma_f32_16x16x32_bf16 v[148:151], v[240:243], v[220:223], v[148:151]
  s_waitcnt lgkmcnt(0)
  v_mfma_f32_16x16x32_bf16 v[80:83], v[236:239], v[224:227], v[80:83]
  v_mfma_f32_16x16x32_bf16 v[152:155], v[240:243], v[224:227], v[152:155]
  s_barrier
  v_lshlrev_b32 v2, 4, v1
  s_mul_i32 s67, s3, 25600
  v_add_u32 v2, s67, v2
  v_lshlrev_b32 v3, 2, v1
  s_mul_i32 s67, s3, 576
  s_add_u32 s67, s67, 102400
  v_add_u32 v3, s67, v3
  s_mov_b32 s80, 0x3fb8aa3b
  s_mov_b32 s81, 0x3fb8aa3b
  s_mov_b32 s82, 0x358637bd
  s_mov_b32 s83, 0x358637bd
  s_nop 5
  v_cvt_pk_bf16_f32 v192, v48, v49
  v_cvt_pk_bf16_f32 v193, v50, v51
  v_cvt_pk_bf16_f32 v194, v120, v121
  v_cvt_pk_bf16_f32 v195, v122, v123
  v_cvt_pk_bf16_f32 v196, v52, v53
  v_cvt_pk_bf16_f32 v197, v54, v55
  v_cvt_pk_bf16_f32 v198, v124, v125
  v_cvt_pk_bf16_f32 v199, v126, v127
  v_cvt_pk_bf16_f32 v200, v56, v57
  v_cvt_pk_bf16_f32 v201, v58, v59
  v_cvt_pk_bf16_f32 v202, v128, v129
  v_cvt_pk_bf16_f32 v203, v130, v131
  v_cvt_pk_bf16_f32 v204, v60, v61
  v_cvt_pk_bf16_f32 v205, v62, v63
  v_cvt_pk_bf16_f32 v206, v132, v133
  v_cvt_pk_bf16_f32 v207, v134, v135
  v_cvt_pk_bf16_f32 v208, v64, v65
  v_cvt_pk_bf16_f32 v209, v66, v67
  v_cvt_pk_bf16_f32 v210, v136, v137
  v_cvt_pk_bf16_f32 v211, v138, v139
  v_cvt_pk_bf16_f32 v212, v68, v69
  v_cvt_pk_bf16_f32 v213, v70, v71
  v_cvt_pk_bf16_f32 v214, v140, v141
  v_cvt_pk_bf16_f32 v215, v142, v143
  v_cvt_pk_bf16_f32 v216, v72, v73
  v_cvt_pk_bf16_f32 v217, v74, v75
  v_cvt_pk_bf16_f32 v218, v144, v145
  v_cvt_pk_bf16_f32 v219, v146, v147
  v_cvt_pk_bf16_f32 v220, v76, v77
  v_cvt_pk_bf16_f32 v221, v78, v79
  v_cvt_pk_bf16_f32 v222, v148, v149
  v_cvt_pk_bf16_f32 v223, v150, v151
  v_cvt_pk_bf16_f32 v224, v80, v81
  v_cvt_pk_bf16_f32 v225, v82, v83
  v_cvt_pk_bf16_f32 v226, v152, v153
  v_cvt_pk_bf16_f32 v227, v154, v155
  v_pk_mul_f32 v[8:9], v[12:13], s[80:81]
  v_pk_mul_f32 v[10:11], v[14:15], s[80:81]
  v_exp_f32_e64 v8, v8 clamp
  v_exp_f32_e64 v9, v9 clamp
  v_exp_f32_e64 v10, v10 clamp
  v_exp_f32_e64 v11, v11 clamp
  v_max_f32 v12, 0, v12
  v_max_f32 v13, 0, v13
  v_max_f32 v14, 0, v14
  v_max_f32 v15, 0, v15
  v_pk_add_f32 v[12:13], v[12:13], v[8:9]
  v_pk_add_f32 v[14:15], v[14:15], v[10:11]
  v_pk_add_f32 v[12:13], v[12:13], s[82:83]
  v_pk_add_f32 v[14:15], v[14:15], s[82:83]
  v_pk_mul_f32 v[8:9], v[84:85], s[80:81]
  v_pk_mul_f32 v[10:11], v[86:87], s[80:81]
  v_exp_f32_e64 v8, v8 clamp
  v_exp_f32_e64 v9, v9 clamp
  v_exp_f32_e64 v10, v10 clamp
  v_exp_f32_e64 v11, v11 clamp
  v_max_f32 v84, 0, v84
  v_max_f32 v85, 0, v85
  v_max_f32 v86, 0, v86
  v_max_f32 v87, 0, v87
  v_pk_add_f32 v[84:85], v[84:85], v[8:9]
  v_pk_add_f32 v[86:87], v[86:87], v[10:11]
  v_pk_add_f32 v[84:85], v[84:85], s[82:83]
  v_pk_add_f32 v[86:87], v[86:87], s[82:83]
  v_cvt_pk_bf16_f32 v156, v12, v13
  v_cvt_pk_bf16_f32 v157, v14, v15
  v_cvt_pk_bf16_f32 v158, v84, v85
  v_cvt_pk_bf16_f32 v159, v86, v87
  v_pk_mul_f32 v[8:9], v[16:17], s[80:81]
  v_pk_mul_f32 v[10:11], v[18:19], s[80:81]
  v_exp_f32_e64 v8, v8 clamp
  v_exp_f32_e64 v9, v9 clamp
  v_exp_f32_e64 v10, v10 clamp
  v_exp_f32_e64 v11, v11 clamp
  v_max_f32 v16, 0, v16
  v_max_f32 v17, 0, v17
  v_max_f32 v18, 0, v18
  v_max_f32 v19, 0, v19
  v_pk_add_f32 v[16:17], v[16:17], v[8:9]
  v_pk_add_f32 v[18:19], v[18:19], v[10:11]
  v_pk_add_f32 v[16:17], v[16:17], s[82:83]
  v_pk_add_f32 v[18:19], v[18:19], s[82:83]
  v_pk_mul_f32 v[8:9], v[88:89], s[80:81]
  v_pk_mul_f32 v[10:11], v[90:91], s[80:81]
  v_exp_f32_e64 v8, v8 clamp
  v_exp_f32_e64 v9, v9 clamp
  v_exp_f32_e64 v10, v10 clamp
  v_exp_f32_e64 v11, v11 clamp
  v_max_f32 v88, 0, v88
  v_max_f32 v89, 0, v89
  v_max_f32 v90, 0, v90
  v_max_f32 v91, 0, v91
  v_pk_add_f32 v[88:89], v[88:89], v[8:9]
  v_pk_add_f32 v[90:91], v[90:91], v[10:11]
  v_pk_add_f32 v[88:89], v[88:89], s[82:83]
  v_pk_add_f32 v[90:91], v[90:91], s[82:83]
  v_cvt_pk_bf16_f32 v160, v16, v17
  v_cvt_pk_bf16_f32 v161, v18, v19
  v_cvt_pk_bf16_f32 v162, v88, v89
  v_cvt_pk_bf16_f32 v163, v90, v91
  v_pk_mul_f32 v[8:9], v[20:21], s[80:81]
  v_pk_mul_f32 v[10:11], v[22:23], s[80:81]
  v_exp_f32_e64 v8, v8 clamp
  v_exp_f32_e64 v9, v9 clamp
  v_exp_f32_e64 v10, v10 clamp
  v_exp_f32_e64 v11, v11 clamp
  v_max_f32 v20, 0, v20
  v_max_f32 v21, 0, v21
  v_max_f32 v22, 0, v22
  v_max_f32 v23, 0, v23
  v_pk_add_f32 v[20:21], v[20:21], v[8:9]
  v_pk_add_f32 v[22:23], v[22:23], v[10:11]
  v_pk_add_f32 v[20:21], v[20:21], s[82:83]
  v_pk_add_f32 v[22:23], v[22:23], s[82:83]
  v_pk_mul_f32 v[8:9], v[92:93], s[80:81]
  v_pk_mul_f32 v[10:11], v[94:95], s[80:81]
  v_exp_f32_e64 v8, v8 clamp
  v_exp_f32_e64 v9, v9 clamp
  v_exp_f32_e64 v10, v10 clamp
  v_exp_f32_e64 v11, v11 clamp
  v_max_f32 v92, 0, v92
  v_max_f32 v93, 0, v93
  v_max_f32 v94, 0, v94
  v_max_f32 v95, 0, v95
  v_pk_add_f32 v[92:93], v[92:93], v[8:9]
  v_pk_add_f32 v[94:95], v[94:95], v[10:11]
  v_pk_add_f32 v[92:93], v[92:93], s[82:83]
  v_pk_add_f32 v[94:95], v[94:95], s[82:83]
  v_cvt_pk_bf16_f32 v164, v20, v21
  v_cvt_pk_bf16_f32 v165, v22, v23
  v_cvt_pk_bf16_f32 v166, v92, v93
  v_cvt_pk_bf16_f32 v167, v94, v95
  v_pk_mul_f32 v[8:9], v[24:25], s[80:81]
  v_pk_mul_f32 v[10:11], v[26:27], s[80:81]
  v_exp_f32_e64 v8, v8 clamp
  v_exp_f32_e64 v9, v9 clamp
  v_exp_f32_e64 v10, v10 clamp
  v_exp_f32_e64 v11, v11 clamp
  v_max_f32 v24, 0, v24
  v_max_f32 v25, 0, v25
  v_max_f32 v26, 0, v26
  v_max_f32 v27, 0, v27
  v_pk_add_f32 v[24:25], v[24:25], v[8:9]
  v_pk_add_f32 v[26:27], v[26:27], v[10:11]
  v_pk_add_f32 v[24:25], v[24:25], s[82:83]
  v_pk_add_f32 v[26:27], v[26:27], s[82:83]
  v_pk_mul_f32 v[8:9], v[96:97], s[80:81]
  v_pk_mul_f32 v[10:11], v[98:99], s[80:81]
  v_exp_f32_e64 v8, v8 clamp
  v_exp_f32_e64 v9, v9 clamp
  v_exp_f32_e64 v10, v10 clamp
  v_exp_f32_e64 v11, v11 clamp
  v_max_f32 v96, 0, v96
  v_max_f32 v97, 0, v97
  v_max_f32 v98, 0, v98
  v_max_f32 v99, 0, v99
  v_pk_add_f32 v[96:97], v[96:97], v[8:9]
  v_pk_add_f32 v[98:99], v[98:99], v[10:11]
  v_pk_add_f32 v[96:97], v[96:97], s[82:83]
  v_pk_add_f32 v[98:99], v[98:99], s[82:83]
  v_cvt_pk_bf16_f32 v168, v24, v25
  v_cvt_pk_bf16_f32 v169, v26, v27
  v_cvt_pk_bf16_f32 v170, v96, v97
  v_cvt_pk_bf16_f32 v171, v98, v99
  v_pk_mul_f32 v[8:9], v[28:29], s[80:81]
  v_pk_mul_f32 v[10:11], v[30:31], s[80:81]
  v_exp_f32_e64 v8, v8 clamp
  v_exp_f32_e64 v9, v9 clamp
  v_exp_f32_e64 v10, v10 clamp
  v_exp_f32_e64 v11, v11 clamp
  v_max_f32 v28, 0, v28
  v_max_f32 v29, 0, v29
  v_max_f32 v30, 0, v30
  v_max_f32 v31, 0, v31
  v_pk_add_f32 v[28:29], v[28:29], v[8:9]
  v_pk_add_f32 v[30:31], v[30:31], v[10:11]
  v_pk_add_f32 v[28:29], v[28:29], s[82:83]
  v_pk_add_f32 v[30:31], v[30:31], s[82:83]
  v_pk_mul_f32 v[8:9], v[100:101], s[80:81]
  v_pk_mul_f32 v[10:11], v[102:103], s[80:81]
  v_exp_f32_e64 v8, v8 clamp
  v_exp_f32_e64 v9, v9 clamp
  v_exp_f32_e64 v10, v10 clamp
  v_exp_f32_e64 v11, v11 clamp
  v_max_f32 v100, 0, v100
  v_max_f32 v101, 0, v101
  v_max_f32 v102, 0, v102
  v_max_f32 v103, 0, v103
  v_pk_add_f32 v[100:101], v[100:101], v[8:9]
  v_pk_add_f32 v[102:103], v[102:103], v[10:11]
  v_pk_add_f32 v[100:101], v[100:101], s[82:83]
  v_pk_add_f32 v[102:103], v[102:103], s[82:83]
  v_cvt_pk_bf16_f32 v172, v28, v29
  v_cvt_pk_bf16_f32 v173, v30, v31
  v_cvt_pk_bf16_f32 v174, v100, v101
  v_cvt_pk_bf16_f32 v175, v102, v103
  v_pk_mul_f32 v[8:9], v[32:33], s[80:81]
  v_pk_mul_f32 v[10:11], v[34:35], s[80:81]
  v_exp_f32_e64 v8, v8 clamp
  v_exp_f32_e64 v9, v9 clamp
  v_exp_f32_e64 v10, v10 clamp
  v_exp_f32_e64 v11, v11 clamp
  v_max_f32 v32, 0, v32
  v_max_f32 v33, 0, v33
  v_max_f32 v34, 0, v34
  v_max_f32 v35, 0, v35
  v_pk_add_f32 v[32:33], v[32:33], v[8:9]
  v_pk_add_f32 v[34:35], v[34:35], v[10:11]
  v_pk_add_f32 v[32:33], v[32:33], s[82:83]
  v_pk_add_f32 v[34:35], v[34:35], s[82:83]
  v_pk_mul_f32 v[8:9], v[104:105], s[80:81]
  v_pk_mul_f32 v[10:11], v[106:107], s[80:81]
  v_exp_f32_e64 v8, v8 clamp
  v_exp_f32_e64 v9, v9 clamp
  v_exp_f32_e64 v10, v10 clamp
  v_exp_f32_e64 v11, v11 clamp
  v_max_f32 v104, 0, v104
  v_max_f32 v105, 0, v105
  v_max_f32 v106, 0, v106
  v_max_f32 v107, 0, v107
  v_pk_add_f32 v[104:105], v[104:105], v[8:9]
  v_pk_add_f32 v[106:107], v[106:107], v[10:11]
  v_pk_add_f32 v[104:105], v[104:105], s[82:83]
  v_pk_add_f32 v[106:107], v[106:107], s[82:83]
  v_cvt_pk_bf16_f32 v176, v32, v33
  v_cvt_pk_bf16_f32 v177, v34, v35
  v_cvt_pk_bf16_f32 v178, v104, v105
  v_cvt_pk_bf16_f32 v179, v106, v107
  v_pk_mul_f32 v[8:9], v[36:37], s[80:81]
  v_pk_mul_f32 v[10:11], v[38:39], s[80:81]
  v_exp_f32_e64 v8, v8 clamp
  v_exp_f32_e64 v9, v9 clamp
  v_exp_f32_e64 v10, v10 clamp
  v_exp_f32_e64 v11, v11 clamp
  v_max_f32 v36, 0, v36
  v_max_f32 v37, 0, v37
  v_max_f32 v38, 0, v38
  v_max_f32 v39, 0, v39
  v_pk_add_f32 v[36:37], v[36:37], v[8:9]
  v_pk_add_f32 v[38:39], v[38:39], v[10:11]
  v_pk_add_f32 v[36:37], v[36:37], s[82:83]
  v_pk_add_f32 v[38:39], v[38:39], s[82:83]
  v_pk_mul_f32 v[8:9], v[108:109], s[80:81]
  v_pk_mul_f32 v[10:11], v[110:111], s[80:81]
  v_exp_f32_e64 v8, v8 clamp
  v_exp_f32_e64 v9, v9 clamp
  v_exp_f32_e64 v10, v10 clamp
  v_exp_f32_e64 v11, v11 clamp
  v_max_f32 v108, 0, v108
  v_max_f32 v109, 0, v109
  v_max_f32 v110, 0, v110
  v_max_f32 v111, 0, v111
  v_pk_add_f32 v[108:109], v[108:109], v[8:9]
  v_pk_add_f32 v[110:111], v[110:111], v[10:11]
  v_pk_add_f32 v[108:109], v[108:109], s[82:83]
  v_pk_add_f32 v[110:111], v[110:111], s[82:83]
  v_cvt_pk_bf16_f32 v180, v36, v37
  v_cvt_pk_bf16_f32 v181, v38, v39
  v_cvt_pk_bf16_f32 v182, v108, v109
  v_cvt_pk_bf16_f32 v183, v110, v111
  v_pk_mul_f32 v[8:9], v[40:41], s[80:81]
  v_pk_mul_f32 v[10:11], v[42:43], s[80:81]
  v_exp_f32_e64 v8, v8 clamp
  v_exp_f32_e64 v9, v9 clamp
  v_exp_f32_e64 v10, v10 clamp
  v_exp_f32_e64 v11, v11 clamp
  v_max_f32 v40, 0, v40
  v_max_f32 v41, 0, v41
  v_max_f32 v42, 0, v42
  v_max_f32 v43, 0, v43
  v_pk_add_f32 v[40:41], v[40:41], v[8:9]
  v_pk_add_f32 v[42:43], v[42:43], v[10:11]
  v_pk_add_f32 v[40:41], v[40:41], s[82:83]
  v_pk_add_f32 v[42:43], v[42:43], s[82:83]
  v_pk_mul_f32 v[8:9], v[112:113], s[80:81]
  v_pk_mul_f32 v[10:11], v[114:115], s[80:81]
  v_exp_f32_e64 v8, v8 clamp
  v_exp_f32_e64 v9, v9 clamp
  v_exp_f32_e64 v10, v10 clamp
  v_exp_f32_e64 v11, v11 clamp
  v_max_f32 v112, 0, v112
  v_max_f32 v113, 0, v113
  v_max_f32 v114, 0, v114
  v_max_f32 v115, 0, v115
  v_pk_add_f32 v[112:113], v[112:113], v[8:9]
  v_pk_add_f32 v[114:115], v[114:115], v[10:11]
  v_pk_add_f32 v[112:113], v[112:113], s[82:83]
  v_pk_add_f32 v[114:115], v[114:115], s[82:83]
  v_cvt_pk_bf16_f32 v184, v40, v41
  v_cvt_pk_bf16_f32 v185, v42, v43
  v_cvt_pk_bf16_f32 v186, v112, v113
  v_cvt_pk_bf16_f32 v187, v114, v115
  v_pk_mul_f32 v[8:9], v[44:45], s[80:81]
  v_pk_mul_f32 v[10:11], v[46:47], s[80:81]
  v_exp_f32_e64 v8, v8 clamp
  v_exp_f32_e64 v9, v9 clamp
  v_exp_f32_e64 v10, v10 clamp
  v_exp_f32_e64 v11, v11 clamp
  v_max_f32 v44, 0, v44
  v_max_f32 v45, 0, v45
  v_max_f32 v46, 0, v46
  v_max_f32 v47, 0, v47
  v_pk_add_f32 v[44:45], v[44:45], v[8:9]
  v_pk_add_f32 v[46:47], v[46:47], v[10:11]
  v_pk_add_f32 v[44:45], v[44:45], s[82:83]
  v_pk_add_f32 v[46:47], v[46:47], s[82:83]
  v_pk_mul_f32 v[8:9], v[116:117], s[80:81]
  v_pk_mul_f32 v[10:11], v[118:119], s[80:81]
  v_exp_f32_e64 v8, v8 clamp
  v_exp_f32_e64 v9, v9 clamp
  v_exp_f32_e64 v10, v10 clamp
  v_exp_f32_e64 v11, v11 clamp
  v_max_f32 v116, 0, v116
  v_max_f32 v117, 0, v117
  v_max_f32 v118, 0, v118
  v_max_f32 v119, 0, v119
  v_pk_add_f32 v[116:117], v[116:117], v[8:9]
  v_pk_add_f32 v[118:119], v[118:119], v[10:11]
  v_pk_add_f32 v[116:117], v[116:117], s[82:83]
  v_pk_add_f32 v[118:119], v[118:119], s[82:83]
  v_cvt_pk_bf16_f32 v188, v44, v45
  v_cvt_pk_bf16_f32 v189, v46, v47
  v_cvt_pk_bf16_f32 v190, v116, v117
  v_cvt_pk_bf16_f32 v191, v118, v119
  v_mov_b32 v228, 0x3f803f80
  v_mov_b32 v229, 0x3f803f80
  v_mov_b32 v230, 0x3f803f80
  v_mov_b32 v231, 0x3f803f80
  s_nop 1
  v_mfma_f32_16x16x32_bf16 v[112:115], v[228:231], v[156:159], 0
  v_mfma_f32_16x16x32_bf16 v[116:119], v[228:231], v[160:163], 0
  v_mfma_f32_16x16x32_bf16 v[120:123], v[228:231], v[164:167], 0
  v_mfma_f32_16x16x32_bf16 v[124:127], v[228:231], v[168:171], 0
  v_mfma_f32_16x16x32_bf16 v[128:131], v[228:231], v[172:175], 0
  v_mfma_f32_16x16x32_bf16 v[132:135], v[228:231], v[176:179], 0
  v_mfma_f32_16x16x32_bf16 v[136:139], v[228:231], v[180:183], 0
  v_mfma_f32_16x16x32_bf16 v[140:143], v[228:231], v[184:187], 0
  v_mfma_f32_16x16x32_bf16 v[144:147], v[228:231], v[188:191], 0
  v_mfma_f32_16x16x32_bf16 v[12:15], v[156:159], v[192:195], 0
  v_mfma_f32_16x16x32_bf16 v[16:19], v[156:159], v[196:199], 0
  v_mfma_f32_16x16x32_bf16 v[20:23], v[160:163], v[192:195], 0
  v_mfma_f32_16x16x32_bf16 v[24:27], v[160:163], v[196:199], 0
  v_mfma_f32_16x16x32_bf16 v[28:31], v[160:163], v[200:203], 0
  v_mfma_f32_16x16x32_bf16 v[32:35], v[164:167], v[196:199], 0
  v_mfma_f32_16x16x32_bf16 v[36:39], v[164:167], v[200:203], 0
  v_mfma_f32_16x16x32_bf16 v[40:43], v[164:167], v[204:207], 0
  v_mfma_f32_16x16x32_bf16 v[44:47], v[168:171], v[200:203], 0
  ds_write_b128 v2, v[12:15] offset:0
  v_mfma_f32_16x16x32_bf16 v[48:51], v[168:171], v[204:207], 0
  ds_write_b128 v2, v[16:19] offset:1024
  v_mfma_f32_16x16x32_bf16 v[52:55], v[168:171], v[208:211], 0
  ds_write_b128 v2, v[20:23] offset:2048
  v_mfma_f32_16x16x32_bf16 v[56:59], v[172:175], v[204:207], 0
  ds_write_b128 v2, v[24:27] offset:3072
  v_mfma_f32_16x16x32_bf16 v[60:63], v[172:175], v[208:211], 0
  ds_write_b128 v2, v[28:31] offset:4096
  v_mfma_f32_16x16x32_bf16 v[64:67], v[172:175], v[212:215], 0
  ds_write_b128 v2, v[32:35] offset:5120
  v_mfma_f32_16x16x32_bf16 v[68:71], v[176:179], v[208:211], 0
  ds_write_b128 v2, v[36:39] offset:6144
  v_mfma_f32_16x16x32_bf16 v[72:75], v[176:179], v[212:215], 0
  ds_write_b128 v2, v[40:43] offset:7168
  v_mfma_f32_16x16x32_bf16 v[76:79], v[176:179], v[216:219], 0
  ds_write_b128 v2, v[44:47] offset:8192
  v_mfma_f32_16x16x32_bf16 v[80:83], v[180:183], v[212:215], 0
  ds_write_b128 v2, v[48:51] offset:9216
  v_mfma_f32_16x16x32_bf16 v[84:87], v[180:183], v[216:219], 0
  ds_write_b128 v2, v[52:55] offset:10240
  v_mfma_f32_16x16x32_bf16 v[88:91], v[180:183], v[220:223], 0
  ds_write_b128 v2, v[56:59] offset:11264
  v_mfma_f32_16x16x32_bf16 v[92:95], v[184:187], v[216:219], 0
  ds_write_b128 v2, v[60:63] offset:12288
  v_mfma_f32_16x16x32_bf16 v[96:99], v[184:187], v[220:223], 0
  ds_write_b128 v2, v[64:67] offset:13312
  v_mfma_f32_16x16x32_bf16 v[100:103], v[184:187], v[224:227], 0
  ds_write_b128 v2, v[68:71] offset:14336
  v_mfma_f32_16x16x32_bf16 v[104:107], v[188:191], v[220:223], 0
  ds_write_b128 v2, v[72:75] offset:15360
  v_mfma_f32_16x16x32_bf16 v[108:111], v[188:191], v[224:227], 0
  ds_write_b128 v2, v[76:79] offset:16384
  s_nop 0
  ds_write_b128 v2, v[80:83] offset:17408
  s_nop 0
  ds_write_b128 v2, v[84:87] offset:18432
  s_nop 0
  ds_write_b128 v2, v[88:91] offset:19456
  s_nop 0
  ds_write_b128 v2, v[92:95] offset:20480
  s_nop 0
  ds_write_b128 v2, v[96:99] offset:21504
  s_nop 0
  ds_write_b128 v2, v[100:103] offset:22528
  s_nop 0
  ds_write_b128 v2, v[104:107] offset:23552
  s_nop 0
  ds_write_b128 v2, v[108:111] offset:24576
  s_mov_b64 exec, 0xffff
  ds_write_b32 v3, v112 offset:0
  ds_write_b32 v3, v116 offset:64
  ds_write_b32 v3, v120 offset:128
  ds_write_b32 v3, v124 offset:192
  ds_write_b32 v3, v128 offset:256
  ds_write_b32 v3, v132 offset:320
  ds_write_b32 v3, v136 offset:384
  ds_write_b32 v3, v140 offset:448
  ds_write_b32 v3, v144 offset:512
  s_mov_b64 exec, -1
  s_waitcnt lgkmcnt(0)
  s_barrier
  s_barrier
  s_and_b32 s72, s52, 3
  s_lshr_b32 s71, s52, 2
  s_lshl_b32 s71, s71, 3
  s_add_u32 s71, s71, s53
  s_sub_u32 s71, s71, 24
  v_lshrrev_b32 v5, 4, v1
  v_bfe_u32 v6, v1, 2, 2
  v_and_b32 v7, 3, v1
  v_lshlrev_b32 v3, 4, v1
  v_mul_u32_u24 v2, 2432, v5
  v_mul_u32_u24 v9, 288, v6
  v_add3_u32 v2, v2, v9, 0
  v_lshl_add_u32 v2, v7, 3, v2
  v_add_u32 v2, 8192, v2
  s_lshl_b32 s67, s3, 11
  v_add_u32 v4, s67, v3
  v_mov_b32 v12, 0
  v_mov_b32 v13, 0
  v_mov_b32 v14, 0
  v_mov_b32 v15, 0
  v_mov_b32 v16, 0
  v_mov_b32 v17, 0
  v_mov_b32 v18, 0
  v_mov_b32 v19, 0
  v_mov_b32 v20, 0
  v_mov_b32 v21, 0
  v_mov_b32 v22, 0
  v_mov_b32 v23, 0
  v_mov_b32 v24, 0
  v_mov_b32 v25, 0
  v_mov_b32 v26, 0
  v_mov_b32 v27, 0
  v_mov_b32 v28, 0
  v_mov_b32 v29, 0
  v_mov_b32 v30, 0
  v_mov_b32 v31, 0
  v_mov_b32 v32, 0
  v_mov_b32 v33, 0
  v_mov_b32 v34, 0
  v_mov_b32 v35, 0
  v_mov_b32 v36, 0
  v_mov_b32 v37, 0
  v_mov_b32 v38, 0
  v_mov_b32 v39, 0
  v_mov_b32 v40, 0
  v_mov_b32 v41, 0
  v_mov_b32 v42, 0
  v_mov_b32 v43, 0
  v_mov_b32 v44, 0
  v_mov_b32 v45, 0
  v_mov_b32 v46, 0
  v_mov_b32 v47, 0
  v_mov_b32 v48, 0
  v_mov_b32 v49, 0
  v_mov_b32 v50, 0
  v_mov_b32 v51, 0
  v_mov_b32 v52, 0
  v_mov_b32 v53, 0
  v_mov_b32 v54, 0
  v_mov_b32 v55, 0
  v_mov_b32 v56, 0
  v_mov_b32 v57, 0
  v_mov_b32 v58, 0
  v_mov_b32 v59, 0
  v_mov_b32 v60, 0
  v_mov_b32 v61, 0
  v_mov_b32 v62, 0
  v_mov_b32 v63, 0
  v_mov_b32 v64, 0
  v_mov_b32 v65, 0
  v_mov_b32 v66, 0
  v_mov_b32 v67, 0
  v_mov_b32 v68, 0
  v_mov_b32 v69, 0
  v_mov_b32 v70, 0
  v_mov_b32 v71, 0
  v_mov_b32 v72, 0
  v_mov_b32 v73, 0
  v_mov_b32 v74, 0
  v_mov_b32 v75, 0
  v_mov_b32 v76, 0
  v_mov_b32 v77, 0
  v_mov_b32 v78, 0
  v_mov_b32 v79, 0
  v_mov_b32 v80, 0
  v_mov_b32 v81, 0
  v_mov_b32 v82, 0
  v_mov_b32 v83, 0
  s_mov_b32 s60, 0
  s_barrier
  ds_read_b128 v[220:223], v4 offset:0
  ds_read_b128 v[224:227], v4 offset:1024
  ds_read_b64_tr_b16 v[184:185], v2 offset:0
  ds_read_b64_tr_b16 v[186:187], v2 offset:1152
  ds_read_b64_tr_b16 v[188:189], v2 offset:32
  ds_read_b64_tr_b16 v[190:191], v2 offset:1184
  ds_read_b64_tr_b16 v[192:193], v2 offset:64
  ds_read_b64_tr_b16 v[194:195], v2 offset:1216
  ds_read_b64_tr_b16 v[196:197], v2 offset:96
  ds_read_b64_tr_b16 v[198:199], v2 offset:1248
  ds_read_b64_tr_b16 v[200:201], v2 offset:128
  ds_read_b64_tr_b16 v[202:203], v2 offset:1280
  ds_read_b64_tr_b16 v[204:205], v2 offset:160
  ds_read_b64_tr_b16 v[206:207], v2 offset:1312
  ds_read_b64_tr_b16 v[208:209], v2 offset:192
  ds_read_b64_tr_b16 v[210:211], v2 offset:1344
  ds_read_b64_tr_b16 v[212:213], v2 offset:224
  ds_read_b64_tr_b16 v[214:215], v2 offset:1376
  ds_read_b64_tr_b16 v[216:217], v2 offset:256
  ds_read_b64_tr_b16 v[218:219], v2 offset:1408
  s_waitcnt lgkmcnt(0)
  s_mov_b32 s61, 8
L_a1_main:
  s_waitcnt lgkmcnt(8)
  v_mfma_f32_16x16x32_bf16 v[12:15], v[184:187], v[220:223], v[12:15]
  s_barrier
  v_mfma_f32_16x16x32_bf16 v[48:51], v[184:187], v[224:227], v[48:51]
  s_add_u32 s69, s60, 18432
  s_cmp_eq_u32 s69, 92160
  v_mfma_f32_16x16x32_bf16 v[16:19], v[188:191], v[220:223], v[16:19]
  s_cselect_b32 s69, 0, s69
  s_sub_u32 s60, s69, s60
  v_mfma_f32_16x16x32_bf16 v[52:55], v[188:191], v[224:227], v[52:55]
  v_add_u32 v2, s60, v2
  v_add_u32 v4, s60, v4
  v_mfma_f32_16x16x32_bf16 v[20:23], v[192:195], v[220:223], v[20:23]
  s_mov_b32 s60, s69
  v_mfma_f32_16x16x32_bf16 v[56:59], v[192:195], v[224:227], v[56:59]
  ds_read_b128 v[228:231], v4 offset:0
  v_mfma_f32_16x16x32_bf16 v[24:27], v[196:199], v[220:223], v[24:27]
  ds_read_b128 v[232:235], v4 offset:1024
  ds_read_b64_tr_b16 v[184:185], v2 offset:0
  v_mfma_f32_16x16x32_bf16 v[60:63], v[196:199], v[224:227], v[60:63]
  ds_read_b64_tr_b16 v[186:187], v2 offset:1152
  ds_read_b64_tr_b16 v[188:189], v2 offset:32
  v_mfma_f32_16x16x32_bf16 v[28:31], v[200:203], v[220:223], v[28:31]
  ds_read_b64_tr_b16 v[190:191], v2 offset:1184
  ds_read_b64_tr_b16 v[192:193], v2 offset:64
  v_mfma_f32_16x16x32_bf16 v[64:67], v[200:203], v[224:227], v[64:67]
  ds_read_b64_tr_b16 v[194:195], v2 offset:1216
  ds_read_b64_tr_b16 v[196:197], v2 offset:96
  s_waitcnt lgkmcnt(8)
  v_mfma_f32_16x16x32_bf16 v[32:35], v[204:207], v[220:223], v[32:35]
  ds_read_b64_tr_b16 v[198:199], v2 offset:1248
  ds_read_b64_tr_b16 v[200:201], v2 offset:128
  v_mfma_f32_16x16x32_bf16 v[68:71], v[204:207], v[224:227], v[68:71]
  ds_read_b64_tr_b16 v[202:203], v2 offset:1280
  ds_read_b64_tr_b16 v[204:205], v2 offset:160
  v_mfma_f32_16x16x32_bf16 v[36:39], v[208:211], v[220:223], v[36:39]
  ds_read_b64_tr_b16 v[206:207], v2 offset:1312
  v_mfma_f32_16x16x32_bf16 v[72:75], v[208:211], v[224:227], v[72:75]
  ds_read_b64_tr_b16 v[208:209], v2 offset:192
  v_mfma_f32_16x16x32_bf16 v[40:43], v[212:215], v[220:223], v[40:43]
  ds_read_b64_tr_b16 v[210:211], v2 offset:1344
  v_mfma_f32_16x16x32_bf16 v[76:79], v[212:215], v[224:227], v[76:79]
  ds_read_b64_tr_b16 v[212:213], v2 offset:224
  v_mfma_f32_16x16x32_bf16 v[44:47], v[216:219], v[220:223], v[44:47]
  ds_read_b64_tr_b16 v[214:215], v2 offset:1376
  v_mfma_f32_16x16x32_bf16 v[80:83], v[216:219], v[224:227], v[80:83]
  ds_read_b64_tr_b16 v[216:217], v2 offset:256
  ds_read_b64_tr_b16 v[218:219], v2 offset:1408
  s_waitcnt lgkmcnt(8)
  v_mfma_f32_16x16x32_bf16 v[12:15], v[184:187], v[228:231], v[12:15]
  s_barrier
  v_mfma_f32_16x16x32_bf16 v[48:51], v[184:187], v[232:235], v[48:51]
  s_add_u32 s69, s60, 18432
  s_cmp_eq_u32 s69, 92160
  v_mfma_f32_16x16x32_bf16 v[16:19], v[188:191], v[228:231], v[16:19]
  s_cselect_b32 s69, 0, s69
  s_sub_u32 s60, s69, s60
  v_mfma_f32_16x16x32_bf16 v[52:55], v[188:191], v[232:235], v[52:55]
  v_add_u32 v2, s60, v2
  v_add_u32 v4, s60, v4
  v_mfma_f32_16x16x32_bf16 v[20:23], v[192:195], v[228:231], v[20:23]
  s_mov_b32 s60, s69
  v_mfma_f32_16x16x32_bf16 v[56:59], v[192:195], v[232:235], v[56:59]
  ds_read_b128 v[220:223], v4 offset:0
  v_mfma_f32_16x16x32_bf16 v[24:27], v[196:199], v[228:231], v[24:27]
  ds_read_b128 v[224:227], v4 offset:1024
  ds_read_b64_tr_b16 v[184:185], v2 offset:0
  v_mfma_f32_16x16x32_bf16 v[60:63], v[196:199], v[232:235], v[60:63]
  ds_read_b64_tr_b16 v[186:187], v2 offset:1152
  ds_read_b64_tr_b16 v[188:189], v2 offset:32
  v_mfma_f32_16x16x32_bf16 v[28:31], v[200:203], v[228:231], v[28:31]
  ds_read_b64_tr_b16 v[190:191], v2 offset:1184
  ds_read_b64_tr_b16 v[192:193], v2 offset:64
  v_mfma_f32_16x16x32_bf16 v[64:67], v[200:203], v[232:235], v[64:67]
  ds_read_b64_tr_b16 v[194:195], v2 offset:1216
  ds_read_b64_tr_b16 v[196:197], v2 offset:96
  s_waitcnt lgkmcnt(8)
  v_mfma_f32_16x16x32_bf16 v[32:35], v[204:207], v[228:231], v[32:35]
  ds_read_b64_tr_b16 v[198:199], v2 offset:1248
  ds_read_b64_tr_b16 v[200:201], v2 offset:128
  v_mfma_f32_16x16x32_bf16 v[68:71], v[204:207], v[232:235], v[68:71]
  ds_read_b64_tr_b16 v[202:203], v2 offset:1280
  ds_read_b64_tr_b16 v[204:205], v2 offset:160
  v_mfma_f32_16x16x32_bf16 v[36:39], v[208:211], v[228:231], v[36:39]
  ds_read_b64_tr_b16 v[206:207], v2 offset:1312
  v_mfma_f32_16x16x32_bf16 v[72:75], v[208:211], v[232:235], v[72:75]
  ds_read_b64_tr_b16 v[208:209], v2 offset:192
  v_mfma_f32_16x16x32_bf16 v[40:43], v[212:215], v[228:231], v[40:43]
  ds_read_b64_tr_b16 v[210:211], v2 offset:1344
  v_mfma_f32_16x16x32_bf16 v[76:79], v[212:215], v[232:235], v[76:79]
  ds_read_b64_tr_b16 v[212:213], v2 offset:224
  s_sub_u32 s61, s61, 1
  s_cmp_lg_u32 s61, 0
  v_mfma_f32_16x16x32_bf16 v[44:47], v[216:219], v[228:231], v[44:47]
  ds_read_b64_tr_b16 v[214:215], v2 offset:1376
  v_mfma_f32_16x16x32_bf16 v[80:83], v[216:219], v[232:235], v[80:83]
  ds_read_b64_tr_b16 v[216:217], v2 offset:256
  ds_read_b64_tr_b16 v[218:219], v2 offset:1408
  s_cbranch_scc1 L_a1_main
  s_waitcnt lgkmcnt(8)
  v_mfma_f32_16x16x32_bf16 v[12:15], v[184:187], v[220:223], v[12:15]
  s_barrier
  v_mfma_f32_16x16x32_bf16 v[48:51], v[184:187], v[224:227], v[48:51]
  s_add_u32 s69, s60, 18432
  s_cmp_eq_u32 s69, 92160
  v_mfma_f32_16x16x32_bf16 v[16:19], v[188:191], v[220:223], v[16:19]
  s_cselect_b32 s69, 0, s69
  s_sub_u32 s60, s69, s60
  v_mfma_f32_16x16x32_bf16 v[52:55], v[188:191], v[224:227], v[52:55]
  v_add_u32 v2, s60, v2
  v_add_u32 v4, s60, v4
  v_mfma_f32_16x16x32_bf16 v[20:23], v[192:195], v[220:223], v[20:23]
  s_mov_b32 s60, s69
  v_mfma_f32_16x16x32_bf16 v[56:59], v[192:195], v[224:227], v[56:59]
  ds_read_b128 v[228:231], v4 offset:0
  v_mfma_f32_16x16x32_bf16 v[24:27], v[196:199], v[220:223], v[24:27]
  ds_read_b128 v[232:235], v4 offset:1024
  ds_read_b64_tr_b16 v[184:185], v2 offset:0
  v_mfma_f32_16x16x32_bf16 v[60:63], v[196:199], v[224:227], v[60:63]
  ds_read_b64_tr_b16 v[186:187], v2 offset:1152
  ds_read_b64_tr_b16 v[188:189], v2 offset:32
  v_mfma_f32_16x16x32_bf16 v[28:31], v[200:203], v[220:223], v[28:31]
  ds_read_b64_tr_b16 v[190:191], v2 offset:1184
  ds_read_b64_tr_b16 v[192:193], v2 offset:64
  v_mfma_f32_16x16x32_bf16 v[64:67], v[200:203], v[224:227], v[64:67]
  ds_read_b64_tr_b16 v[194:195], v2 offset:1216
  ds_read_b64_tr_b16 v[196:197], v2 offset:96
  s_waitcnt lgkmcnt(8)
  v_mfma_f32_16x16x32_bf16 v[32:35], v[204:207], v[220:223], v[32:35]
  ds_read_b64_tr_b16 v[198:199], v2 offset:1248
  ds_read_b64_tr_b16 v[200:201], v2 offset:128
  v_mfma_f32_16x16x32_bf16 v[68:71], v[204:207], v[224:227], v[68:71]
  ds_read_b64_tr_b16 v[202:203], v2 offset:1280
  ds_read_b64_tr_b16 v[204:205], v2 offset:160
  v_mfma_f32_16x16x32_bf16 v[36:39], v[208:211], v[220:223], v[36:39]
  ds_read_b64_tr_b16 v[206:207], v2 offset:1312
  v_mfma_f32_16x16x32_bf16 v[72:75], v[208:211], v[224:227], v[72:75]
  ds_read_b64_tr_b16 v[208:209], v2 offset:192
  v_mfma_f32_16x16x32_bf16 v[40:43], v[212:215], v[220:223], v[40:43]
  ds_read_b64_tr_b16 v[210:211], v2 offset:1344
  v_mfma_f32_16x16x32_bf16 v[76:79], v[212:215], v[224:227], v[76:79]
  ds_read_b64_tr_b16 v[212:213], v2 offset:224
  v_mfma_f32_16x16x32_bf16 v[44:47], v[216:219], v[220:223], v[44:47]
  ds_read_b64_tr_b16 v[214:215], v2 offset:1376
  v_mfma_f32_16x16x32_bf16 v[80:83], v[216:219], v[224:227], v[80:83]
  ds_read_b64_tr_b16 v[216:217], v2 offset:256
  ds_read_b64_tr_b16 v[218:219], v2 offset:1408
  s_waitcnt lgkmcnt(8)
  v_mfma_f32_16x16x32_bf16 v[12:15], v[184:187], v[228:231], v[12:15]
  v_mfma_f32_16x16x32_bf16 v[48:51], v[184:187], v[232:235], v[48:51]
  v_mfma_f32_16x16x32_bf16 v[16:19], v[188:191], v[228:231], v[16:19]
  v_mfma_f32_16x16x32_bf16 v[52:55], v[188:191], v[232:235], v[52:55]
  v_mfma_f32_16x16x32_bf16 v[20:23], v[192:195], v[228:231], v[20:23]
  v_mfma_f32_16x16x32_bf16 v[56:59], v[192:195], v[232:235], v[56:59]
  v_mfma_f32_16x16x32_bf16 v[24:27], v[196:199], v[228:231], v[24:27]
  v_mfma_f32_16x16x32_bf16 v[60:63], v[196:199], v[232:235], v[60:63]
  v_mfma_f32_16x16x32_bf16 v[28:31], v[200:203], v[228:231], v[28:31]
  v_mfma_f32_16x16x32_bf16 v[64:67], v[200:203], v[232:235], v[64:67]
  s_waitcnt lgkmcnt(6)
  v_mfma_f32_16x16x32_bf16 v[32:35], v[204:207], v[228:231], v[32:35]
  v_mfma_f32_16x16x32_bf16 v[68:71], v[204:207], v[232:235], v[68:71]
  s_waitcnt lgkmcnt(4)
  v_mfma_f32_16x16x32_bf16 v[36:39], v[208:211], v[228:231], v[36:39]
  v_mfma_f32_16x16x32_bf16 v[72:75], v[208:211], v[232:235], v[72:75]
  s_waitcnt lgkmcnt(2)
  v_mfma_f32_16x16x32_bf16 v[40:43], v[212:215], v[228:231], v[40:43]
  v_mfma_f32_16x16x32_bf16 v[76:79], v[212:215], v[232:235], v[76:79]
  s_waitcnt lgkmcnt(0)
  v_mfma_f32_16x16x32_bf16 v[44:47], v[216:219], v[228:231], v[44:47]
  v_mfma_f32_16x16x32_bf16 v[80:83], v[216:219], v[232:235], v[80:83]
  s_mov_b32 s84, 0x3fb8aa3b
  s_mov_b32 s85, 0x3fb8aa3b
  s_mov_b32 s76, 0x358637bd
  s_mov_b32 s77, 0x358637bd
  s_mul_i32 s74, s72, 640
  s_lshl_b32 s67, s71, 3
  s_add_u32 s74, s74, s67
  s_lshl_b32 s67, s3, 1
  s_add_u32 s74, s74, s67
  s_lshl_b32 s74, s74, 10
  s_add_u32 s74, s74, 10027008
  v_add_u32 v2, 94208, v3
  v_pk_mul_f32 v[8:9], v[12:13], s[84:85]
  v_pk_mul_f32 v[10:11], v[14:15], s[84:85]
  v_exp_f32_e64 v8, v8 clamp
  v_exp_f32_e64 v9, v9 clamp
  v_exp_f32_e64 v10, v10 clamp
  v_exp_f32_e64 v11, v11 clamp
  v_max_f32 v12, 0, v12
  v_max_f32 v13, 0, v13
  v_max_f32 v14, 0, v14
  v_max_f32 v15, 0, v15
  v_pk_add_f32 v[12:13], v[12:13], v[8:9]
  v_pk_add_f32 v[14:15], v[14:15], v[10:11]
  v_pk_add_f32 v[12:13], v[12:13], s[76:77]
  v_pk_add_f32 v[14:15], v[14:15], s[76:77]
  v_pk_mul_f32 v[8:9], v[16:17], s[84:85]
  v_pk_mul_f32 v[10:11], v[18:19], s[84:85]
  v_exp_f32_e64 v8, v8 clamp
  v_exp_f32_e64 v9, v9 clamp
  v_exp_f32_e64 v10, v10 clamp
  v_exp_f32_e64 v11, v11 clamp
  v_max_f32 v16, 0, v16
  v_max_f32 v17, 0, v17
  v_max_f32 v18, 0, v18
  v_max_f32 v19, 0, v19
  v_pk_add_f32 v[16:17], v[16:17], v[8:9]
  v_pk_add_f32 v[18:19], v[18:19], v[10:11]
  v_pk_add_f32 v[16:17], v[16:17], s[76:77]
  v_pk_add_f32 v[18:19], v[18:19], s[76:77]
  v_cvt_pk_bf16_f32 v12, v12, v13
  v_cvt_pk_bf16_f32 v13, v14, v15
  v_cvt_pk_bf16_f32 v14, v16, v17
  v_cvt_pk_bf16_f32 v15, v18, v19
  v_pk_mul_f32 v[8:9], v[20:21], s[84:85]
  v_pk_mul_f32 v[10:11], v[22:23], s[84:85]
  v_exp_f32_e64 v8, v8 clamp
  v_exp_f32_e64 v9, v9 clamp
  v_exp_f32_e64 v10, v10 clamp
  v_exp_f32_e64 v11, v11 clamp
  v_max_f32 v20, 0, v20
  v_max_f32 v21, 0, v21
  v_max_f32 v22, 0, v22
  v_max_f32 v23, 0, v23
  v_pk_add_f32 v[20:21], v[20:21], v[8:9]
  v_pk_add_f32 v[22:23], v[22:23], v[10:11]
  v_pk_add_f32 v[20:21], v[20:21], s[76:77]
  v_pk_add_f32 v[22:23], v[22:23], s[76:77]
  v_pk_mul_f32 v[8:9], v[24:25], s[84:85]
  v_pk_mul_f32 v[10:11], v[26:27], s[84:85]
  v_exp_f32_e64 v8, v8 clamp
  v_exp_f32_e64 v9, v9 clamp
  v_exp_f32_e64 v10, v10 clamp
  v_exp_f32_e64 v11, v11 clamp
  v_max_f32 v24, 0, v24
  v_max_f32 v25, 0, v25
  v_max_f32 v26, 0, v26
  v_max_f32 v27, 0, v27
  v_pk_add_f32 v[24:25], v[24:25], v[8:9]
  v_pk_add_f32 v[26:27], v[26:27], v[10:11]
  v_pk_add_f32 v[24:25], v[24:25], s[76:77]
  v_pk_add_f32 v[26:27], v[26:27], s[76:77]
  v_cvt_pk_bf16_f32 v20, v20, v21
  v_cvt_pk_bf16_f32 v21, v22, v23
  v_cvt_pk_bf16_f32 v22, v24, v25
  v_cvt_pk_bf16_f32 v23, v26, v27
  v_pk_mul_f32 v[8:9], v[28:29], s[84:85]
  v_pk_mul_f32 v[10:11], v[30:31], s[84:85]
  v_exp_f32_e64 v8, v8 clamp
  v_exp_f32_e64 v9, v9 clamp
  v_exp_f32_e64 v10, v10 clamp
  v_exp_f32_e64 v11, v11 clamp
  v_max_f32 v28, 0, v28
  v_max_f32 v29, 0, v29
  v_max_f32 v30, 0, v30
  v_max_f32 v31, 0, v31
  v_pk_add_f32 v[28:29], v[28:29], v[8:9]
  v_pk_add_f32 v[30:31], v[30:31], v[10:11]
  v_pk_add_f32 v[28:29], v[28:29], s[76:77]
  v_pk_add_f32 v[30:31], v[30:31], s[76:77]
  v_pk_mul_f32 v[8:9], v[32:33], s[84:85]
  v_pk_mul_f32 v[10:11], v[34:35], s[84:85]
  v_exp_f32_e64 v8, v8 clamp
  v_exp_f32_e64 v9, v9 clamp
  v_exp_f32_e64 v10, v10 clamp
  v_exp_f32_e64 v11, v11 clamp
  v_max_f32 v32, 0, v32
  v_max_f32 v33, 0, v33
  v_max_f32 v34, 0, v34
  v_max_f32 v35, 0, v35
  v_pk_add_f32 v[32:33], v[32:33], v[8:9]
  v_pk_add_f32 v[34:35], v[34:35], v[10:11]
  v_pk_add_f32 v[32:33], v[32:33], s[76:77]
  v_pk_add_f32 v[34:35], v[34:35], s[76:77]
  v_cvt_pk_bf16_f32 v28, v28, v29
  v_cvt_pk_bf16_f32 v29, v30, v31
  v_cvt_pk_bf16_f32 v30, v32, v33
  v_cvt_pk_bf16_f32 v31, v34, v35
  v_pk_mul_f32 v[8:9], v[36:37], s[84:85]
  v_pk_mul_f32 v[10:11], v[38:39], s[84:85]
  v_exp_f32_e64 v8, v8 clamp
  v_exp_f32_e64 v9, v9 clamp
  v_exp_f32_e64 v10, v10 clamp
  v_exp_f32_e64 v11, v11 clamp
  v_max_f32 v36, 0, v36
  v_max_f32 v37, 0, v37
  v_max_f32 v38, 0, v38
  v_max_f32 v39, 0, v39
  v_pk_add_f32 v[36:37], v[36:37], v[8:9]
  v_pk_add_f32 v[38:39], v[38:39], v[10:11]
  v_pk_add_f32 v[36:37], v[36:37], s[76:77]
  v_pk_add_f32 v[38:39], v[38:39], s[76:77]
  v_pk_mul_f32 v[8:9], v[40:41], s[84:85]
  v_pk_mul_f32 v[10:11], v[42:43], s[84:85]
  v_exp_f32_e64 v8, v8 clamp
  v_exp_f32_e64 v9, v9 clamp
  v_exp_f32_e64 v10, v10 clamp
  v_exp_f32_e64 v11, v11 clamp
  v_max_f32 v40, 0, v40
  v_max_f32 v41, 0, v41
  v_max_f32 v42, 0, v42
  v_max_f32 v43, 0, v43
  v_pk_add_f32 v[40:41], v[40:41], v[8:9]
  v_pk_add_f32 v[42:43], v[42:43], v[10:11]
  v_pk_add_f32 v[40:41], v[40:41], s[76:77]
  v_pk_add_f32 v[42:43], v[42:43], s[76:77]
  v_cvt_pk_bf16_f32 v36, v36, v37
  v_cvt_pk_bf16_f32 v37, v38, v39
  v_cvt_pk_bf16_f32 v38, v40, v41
  v_cvt_pk_bf16_f32 v39, v42, v43
  v_pk_mul_f32 v[8:9], v[44:45], s[84:85]
  v_pk_mul_f32 v[10:11], v[46:47], s[84:85]
  v_exp_f32_e64 v8, v8 clamp
  v_exp_f32_e64 v9, v9 clamp
  v_exp_f32_e64 v10, v10 clamp
  v_exp_f32_e64 v11, v11 clamp
  v_max_f32 v44, 0, v44
  v_max_f32 v45, 0, v45
  v_max_f32 v46, 0, v46
  v_max_f32 v47, 0, v47
  v_pk_add_f32 v[44:45], v[44:45], v[8:9]
  v_pk_add_f32 v[46:47], v[46:47], v[10:11]
  v_pk_add_f32 v[44:45], v[44:45], s[76:77]
  v_pk_add_f32 v[46:47], v[46:47], s[76:77]
  v_cvt_pk_bf16_f32 v44, v44, v45
  v_cvt_pk_bf16_f32 v45, v46, v47
  v_mov_b32 v46, 0
  v_mov_b32 v47, 0
  v_pk_mul_f32 v[8:9], v[48:49], s[84:85]
  v_pk_mul_f32 v[10:11], v[50:51], s[84:85]
  v_exp_f32_e64 v8, v8 clamp
  v_exp_f32_e64 v9, v9 clamp
  v_exp_f32_e64 v10, v10 clamp
  v_exp_f32_e64 v11, v11 clamp
  v_max_f32 v48, 0, v48
  v_max_f32 v49, 0, v49
  v_max_f32 v50, 0, v50
  v_max_f32 v51, 0, v51
  v_pk_add_f32 v[48:49], v[48:49], v[8:9]
  v_pk_add_f32 v[50:51], v[50:51], v[10:11]
  v_pk_add_f32 v[48:49], v[48:49], s[76:77]
  v_pk_add_f32 v[50:51], v[50:51], s[76:77]
  v_pk_mul_f32 v[8:9], v[52:53], s[84:85]
  v_pk_mul_f32 v[10:11], v[54:55], s[84:85]
  v_exp_f32_e64 v8, v8 clamp
  v_exp_f32_e64 v9, v9 clamp
  v_exp_f32_e64 v10, v10 clamp
  v_exp_f32_e64 v11, v11 clamp
  v_max_f32 v52, 0, v52
  v_max_f32 v53, 0, v53
  v_max_f32 v54, 0, v54
  v_max_f32 v55, 0, v55
  v_pk_add_f32 v[52:53], v[52:53], v[8:9]
  v_pk_add_f32 v[54:55], v[54:55], v[10:11]
  v_pk_add_f32 v[52:53], v[52:53], s[76:77]
  v_pk_add_f32 v[54:55], v[54:55], s[76:77]
  v_cvt_pk_bf16_f32 v48, v48, v49
  v_cvt_pk_bf16_f32 v49, v50, v51
  v_cvt_pk_bf16_f32 v50, v52, v53
  v_cvt_pk_bf16_f32 v51, v54, v55
  v_pk_mul_f32 v[8:9], v[56:57], s[84:85]
  v_pk_mul_f32 v[10:11], v[58:59], s[84:85]
  v_exp_f32_e64 v8, v8 clamp
  v_exp_f32_e64 v9, v9 clamp
  v_exp_f32_e64 v10, v10 clamp
  v_exp_f32_e64 v11, v11 clamp
  v_max_f32 v56, 0, v56
  v_max_f32 v57, 0, v57
  v_max_f32 v58, 0, v58
  v_max_f32 v59, 0, v59
  v_pk_add_f32 v[56:57], v[56:57], v[8:9]
  v_pk_add_f32 v[58:59], v[58:59], v[10:11]
  v_pk_add_f32 v[56:57], v[56:57], s[76:77]
  v_pk_add_f32 v[58:59], v[58:59], s[76:77]
  v_pk_mul_f32 v[8:9], v[60:61], s[84:85]
  v_pk_mul_f32 v[10:11], v[62:63], s[84:85]
  v_exp_f32_e64 v8, v8 clamp
  v_exp_f32_e64 v9, v9 clamp
  v_exp_f32_e64 v10, v10 clamp
  v_exp_f32_e64 v11, v11 clamp
  v_max_f32 v60, 0, v60
  v_max_f32 v61, 0, v61
  v_max_f32 v62, 0, v62
  v_max_f32 v63, 0, v63
  v_pk_add_f32 v[60:61], v[60:61], v[8:9]
  v_pk_add_f32 v[62:63], v[62:63], v[10:11]
  v_pk_add_f32 v[60:61], v[60:61], s[76:77]
  v_pk_add_f32 v[62:63], v[62:63], s[76:77]
  v_cvt_pk_bf16_f32 v56, v56, v57
  v_cvt_pk_bf16_f32 v57, v58, v59
  v_cvt_pk_bf16_f32 v58, v60, v61
  v_cvt_pk_bf16_f32 v59, v62, v63
  v_pk_mul_f32 v[8:9], v[64:65], s[84:85]
  v_pk_mul_f32 v[10:11], v[66:67], s[84:85]
  v_exp_f32_e64 v8, v8 clamp
  v_exp_f32_e64 v9, v9 clamp
  v_exp_f32_e64 v10, v10 clamp
  v_exp_f32_e64 v11, v11 clamp
  v_max_f32 v64, 0, v64
  v_max_f32 v65, 0, v65
  v_max_f32 v66, 0, v66
  v_max_f32 v67, 0, v67
  v_pk_add_f32 v[64:65], v[64:65], v[8:9]
  v_pk_add_f32 v[66:67], v[66:67], v[10:11]
  v_pk_add_f32 v[64:65], v[64:65], s[76:77]
  v_pk_add_f32 v[66:67], v[66:67], s[76:77]
  v_pk_mul_f32 v[8:9], v[68:69], s[84:85]
  v_pk_mul_f32 v[10:11], v[70:71], s[84:85]
  v_exp_f32_e64 v8, v8 clamp
  v_exp_f32_e64 v9, v9 clamp
  v_exp_f32_e64 v10, v10 clamp
  v_exp_f32_e64 v11, v11 clamp
  v_max_f32 v68, 0, v68
  v_max_f32 v69, 0, v69
  v_max_f32 v70, 0, v70
  v_max_f32 v71, 0, v71
  v_pk_add_f32 v[68:69], v[68:69], v[8:9]
  v_pk_add_f32 v[70:71], v[70:71], v[10:11]
  v_pk_add_f32 v[68:69], v[68:69], s[76:77]
  v_pk_add_f32 v[70:71], v[70:71], s[76:77]
  v_cvt_pk_bf16_f32 v64, v64, v65
  v_cvt_pk_bf16_f32 v65, v66, v67
  v_cvt_pk_bf16_f32 v66, v68, v69
  v_cvt_pk_bf16_f32 v67, v70, v71
  v_pk_mul_f32 v[8:9], v[72:73], s[84:85]
  v_pk_mul_f32 v[10:11], v[74:75], s[84:85]
  v_exp_f32_e64 v8, v8 clamp
  v_exp_f32_e64 v9, v9 clamp
  v_exp_f32_e64 v10, v10 clamp
  v_exp_f32_e64 v11, v11 clamp
  v_max_f32 v72, 0, v72
  v_max_f32 v73, 0, v73
  v_max_f32 v74, 0, v74
  v_max_f32 v75, 0, v75
  v_pk_add_f32 v[72:73], v[72:73], v[8:9]
  v_pk_add_f32 v[74:75], v[74:75], v[10:11]
  v_pk_add_f32 v[72:73], v[72:73], s[76:77]
  v_pk_add_f32 v[74:75], v[74:75], s[76:77]
  v_pk_mul_f32 v[8:9], v[76:77], s[84:85]
  v_pk_mul_f32 v[10:11], v[78:79], s[84:85]
  v_exp_f32_e64 v8, v8 clamp
  v_exp_f32_e64 v9, v9 clamp
  v_exp_f32_e64 v10, v10 clamp
  v_exp_f32_e64 v11, v11 clamp
  v_max_f32 v76, 0, v76
  v_max_f32 v77, 0, v77
  v_max_f32 v78, 0, v78
  v_max_f32 v79, 0, v79
  v_pk_add_f32 v[76:77], v[76:77], v[8:9]
  v_pk_add_f32 v[78:79], v[78:79], v[10:11]
  v_pk_add_f32 v[76:77], v[76:77], s[76:77]
  v_pk_add_f32 v[78:79], v[78:79], s[76:77]
  v_cvt_pk_bf16_f32 v72, v72, v73
  v_cvt_pk_bf16_f32 v73, v74, v75
  v_cvt_pk_bf16_f32 v74, v76, v77
  v_cvt_pk_bf16_f32 v75, v78, v79
  v_pk_mul_f32 v[8:9], v[80:81], s[84:85]
  v_pk_mul_f32 v[10:11], v[82:83], s[84:85]
  v_exp_f32_e64 v8, v8 clamp
  v_exp_f32_e64 v9, v9 clamp
  v_exp_f32_e64 v10, v10 clamp
  v_exp_f32_e64 v11, v11 clamp
  v_max_f32 v80, 0, v80
  v_max_f32 v81, 0, v81
  v_max_f32 v82, 0, v82
  v_max_f32 v83, 0, v83
  v_pk_add_f32 v[80:81], v[80:81], v[8:9]
  v_pk_add_f32 v[82:83], v[82:83], v[10:11]
  v_pk_add_f32 v[80:81], v[80:81], s[76:77]
  v_pk_add_f32 v[82:83], v[82:83], s[76:77]
  v_cvt_pk_bf16_f32 v80, v80, v81
  v_cvt_pk_bf16_f32 v81, v82, v83
  v_mov_b32 v82, 0
  v_mov_b32 v83, 0
  s_barrier
  ds_read_b128 v[84:87], v2 offset:0
  ds_read_b128 v[88:91], v2 offset:1024
  ds_read_b128 v[92:95], v2 offset:4096
  ds_read_b128 v[96:99], v2 offset:5120
  ds_read_b128 v[100:103], v2 offset:6144
  ds_read_b128 v[104:107], v2 offset:7168
  ds_read_b128 v[108:111], v2 offset:8192
  ds_read_b128 v[112:115], v2 offset:9216
  ds_read_b128 v[116:119], v2 offset:10240
  ds_read_b128 v[120:123], v2 offset:11264
  ds_read_b128 v[124:127], v2 offset:12288
  ds_read_b128 v[128:131], v2 offset:13312
  ds_read_b128 v[132:135], v2 offset:14336
  ds_read_b128 v[136:139], v2 offset:15360
  ds_read_b128 v[140:143], v2 offset:16384
  ds_read_b128 v[144:147], v2 offset:17408
  ds_read_b128 v[148:151], v2 offset:18432
  ds_read_b128 v[152:155], v2 offset:19456
  ds_read_b128 v[156:159], v2 offset:20480
  ds_read_b128 v[160:163], v2 offset:21504
  ds_read_b128 v[164:167], v2 offset:22528
  ds_read_b128 v[168:171], v2 offset:23552
  ds_read_b128 v[172:175], v2 offset:24576
  ds_read_b128 v[176:179], v2 offset:25600
  ds_read_b128 v[180:183], v2 offset:26624
  ds_read_b128 v[184:187], v2 offset:27648
  ds_read_b128 v[188:191], v2 offset:28672
  ds_read_b128 v[192:195], v2 offset:29696
  ds_read_b128 v[196:199], v2 offset:30720
  ds_read_b128 v[200:203], v2 offset:31744
  ds_read_b128 v[204:207], v2 offset:32768
  ds_read_b128 v[208:211], v2 offset:33792
  ds_read_b128 v[212:215], v2 offset:34816
  ds_read_b128 v[216:219], v2 offset:35840
  s_waitcnt lgkmcnt(0)
  s_cmp_eq_u32 s72, 3
  s_cbranch_scc1 L_at_nb
  s_barrier
L_at_nb:
  v_mfma_f32_16x16x32_bf16 v[240:243], v[84:87], v[12:15], 0
  v_mfma_f32_16x16x32_bf16 v[244:247], v[88:91], v[12:15], 0
  v_mfma_f32_16x16x32_bf16 v[248:251], v[84:87], v[48:51], 0
  v_mfma_f32_16x16x32_bf16 v[32:35], v[88:91], v[48:51], 0
  v_mfma_f32_16x16x32_bf16 v[16:19], v[92:95], v[12:15], 0
  v_mfma_f32_16x16x32_bf16 v[16:19], v[100:103], v[20:23], v[16:19]
  v_mfma_f32_16x16x32_bf16 v[24:27], v[96:99], v[12:15], 0
  v_mfma_f32_16x16x32_bf16 v[24:27], v[104:107], v[20:23], v[24:27]
  v_mfma_f32_16x16x32_bf16 v[52:55], v[92:95], v[48:51], 0
  v_mfma_f32_16x16x32_bf16 v[52:55], v[100:103], v[56:59], v[52:55]
  v_mfma_f32_16x16x32_bf16 v[60:63], v[96:99], v[48:51], 0
  v_mfma_f32_16x16x32_bf16 v[60:63], v[104:107], v[56:59], v[60:63]
  s_nop 3
  v_pk_add_f32 v[244:245], v[244:245], s[76:77]
  v_pk_add_f32 v[246:247], v[246:247], s[76:77]
  v_pk_add_f32 v[32:33], v[32:33], s[76:77]
  v_pk_add_f32 v[34:35], v[34:35], s[76:77]
  v_rcp_f32 v244, v244
  v_rcp_f32 v245, v245
  v_rcp_f32 v246, v246
  v_rcp_f32 v247, v247
  v_rcp_f32 v32, v32
  v_rcp_f32 v33, v33
  v_rcp_f32 v34, v34
  v_rcp_f32 v35, v35
  v_pk_mul_f32 v[240:241], v[240:241], v[244:245]
  v_pk_mul_f32 v[242:243], v[242:243], v[246:247]
  v_pk_mul_f32 v[248:249], v[248:249], v[32:33]
  v_pk_mul_f32 v[250:251], v[250:251], v[34:35]
  v_cvt_pk_bf16_f32 v220, v240, v241
  v_cvt_pk_bf16_f32 v221, v242, v243
  v_cvt_pk_bf16_f32 v224, v248, v249
  v_cvt_pk_bf16_f32 v225, v250, v251
  v_mfma_f32_16x16x32_bf16 v[240:243], v[108:111], v[12:15], 0
  v_mfma_f32_16x16x32_bf16 v[240:243], v[116:119], v[20:23], v[240:243]
  v_mfma_f32_16x16x32_bf16 v[244:247], v[112:115], v[12:15], 0
  v_mfma_f32_16x16x32_bf16 v[244:247], v[120:123], v[20:23], v[244:247]
  v_mfma_f32_16x16x32_bf16 v[248:251], v[108:111], v[48:51], 0
  v_mfma_f32_16x16x32_bf16 v[248:251], v[116:119], v[56:59], v[248:251]
  v_mfma_f32_16x16x32_bf16 v[32:35], v[112:115], v[48:51], 0
  v_mfma_f32_16x16x32_bf16 v[32:35], v[120:123], v[56:59], v[32:35]
  s_nop 3
  v_pk_add_f32 v[24:25], v[24:25], s[76:77]
  v_pk_add_f32 v[26:27], v[26:27], s[76:77]
  v_pk_add_f32 v[60:61], v[60:61], s[76:77]
  v_pk_add_f32 v[62:63], v[62:63], s[76:77]
  v_rcp_f32 v24, v24
  v_rcp_f32 v25, v25
  v_rcp_f32 v26, v26
  v_rcp_f32 v27, v27
  v_rcp_f32 v60, v60
  v_rcp_f32 v61, v61
  v_rcp_f32 v62, v62
  v_rcp_f32 v63, v63
  v_pk_mul_f32 v[16:17], v[16:17], v[24:25]
  v_pk_mul_f32 v[18:19], v[18:19], v[26:27]
  v_pk_mul_f32 v[52:53], v[52:53], v[60:61]
  v_pk_mul_f32 v[54:55], v[54:55], v[62:63]
  v_cvt_pk_bf16_f32 v222, v16, v17
  v_cvt_pk_bf16_f32 v223, v18, v19
  v_cvt_pk_bf16_f32 v226, v52, v53
  v_cvt_pk_bf16_f32 v227, v54, v55
  s_add_u32 s75, s74, 0
  buffer_store_dwordx4 v[220:223], v3, s[16:19], s75 offen offset:0 sc1
  buffer_store_dwordx4 v[224:227], v3, s[16:19], s75 offen offset:1024 sc1
  v_mfma_f32_16x16x32_bf16 v[16:19], v[124:127], v[20:23], 0
  v_mfma_f32_16x16x32_bf16 v[16:19], v[132:135], v[28:31], v[16:19]
  v_mfma_f32_16x16x32_bf16 v[24:27], v[128:131], v[20:23], 0
  v_mfma_f32_16x16x32_bf16 v[24:27], v[136:139], v[28:31], v[24:27]
  v_mfma_f32_16x16x32_bf16 v[52:55], v[124:127], v[56:59], 0
  v_mfma_f32_16x16x32_bf16 v[52:55], v[132:135], v[64:67], v[52:55]
  v_mfma_f32_16x16x32_bf16 v[60:63], v[128:131], v[56:59], 0
  v_mfma_f32_16x16x32_bf16 v[60:63], v[136:139], v[64:67], v[60:63]
  s_nop 3
  v_pk_add_f32 v[244:245], v[244:245], s[76:77]
  v_pk_add_f32 v[246:247], v[246:247], s[76:77]
  v_pk_add_f32 v[32:33], v[32:33], s[76:77]
  v_pk_add_f32 v[34:35], v[34:35], s[76:77]
  v_rcp_f32 v244, v244
  v_rcp_f32 v245, v245
  v_rcp_f32 v246, v246
  v_rcp_f32 v247, v247
  v_rcp_f32 v32, v32
  v_rcp_f32 v33, v33
  v_rcp_f32 v34, v34
  v_rcp_f32 v35, v35
  v_pk_mul_f32 v[240:241], v[240:241], v[244:245]
  v_pk_mul_f32 v[242:243], v[242:243], v[246:247]
  v_pk_mul_f32 v[248:249], v[248:249], v[32:33]
  v_pk_mul_f32 v[250:251], v[250:251], v[34:35]
  v_cvt_pk_bf16_f32 v228, v240, v241
  v_cvt_pk_bf16_f32 v229, v242, v243
  v_cvt_pk_bf16_f32 v232, v248, v249
  v_cvt_pk_bf16_f32 v233, v250, v251
  v_mfma_f32_16x16x32_bf16 v[240:243], v[140:143], v[20:23], 0
  v_mfma_f32_16x16x32_bf16 v[240:243], v[148:151], v[28:31], v[240:243]
  v_mfma_f32_16x16x32_bf16 v[244:247], v[144:147], v[20:23], 0
  v_mfma_f32_16x16x32_bf16 v[244:247], v[152:155], v[28:31], v[244:247]
  v_mfma_f32_16x16x32_bf16 v[248:251], v[140:143], v[56:59], 0
  v_mfma_f32_16x16x32_bf16 v[248:251], v[148:151], v[64:67], v[248:251]
  v_mfma_f32_16x16x32_bf16 v[32:35], v[144:147], v[56:59], 0
  v_mfma_f32_16x16x32_bf16 v[32:35], v[152:155], v[64:67], v[32:35]
  s_nop 3
  v_pk_add_f32 v[24:25], v[24:25], s[76:77]
  v_pk_add_f32 v[26:27], v[26:27], s[76:77]
  v_pk_add_f32 v[60:61], v[60:61], s[76:77]
  v_pk_add_f32 v[62:63], v[62:63], s[76:77]
  v_rcp_f32 v24, v24
  v_rcp_f32 v25, v25
  v_rcp_f32 v26, v26
  v_rcp_f32 v27, v27
  v_rcp_f32 v60, v60
  v_rcp_f32 v61, v61
  v_rcp_f32 v62, v62
  v_rcp_f32 v63, v63
  v_pk_mul_f32 v[16:17], v[16:17], v[24:25]
  v_pk_mul_f32 v[18:19], v[18:19], v[26:27]
  v_pk_mul_f32 v[52:53], v[52:53], v[60:61]
  v_pk_mul_f32 v[54:55], v[54:55], v[62:63]
  v_cvt_pk_bf16_f32 v230, v16, v17
  v_cvt_pk_bf16_f32 v231, v18, v19
  v_cvt_pk_bf16_f32 v234, v52, v53
  v_cvt_pk_bf16_f32 v235, v54, v55
  s_add_u32 s75, s74, 131072
  buffer_store_dwordx4 v[228:231], v3, s[16:19], s75 offen offset:0 sc1
  buffer_store_dwordx4 v[232:235], v3, s[16:19], s75 offen offset:1024 sc1
  v_mfma_f32_16x16x32_bf16 v[16:19], v[156:159], v[28:31], 0
  v_mfma_f32_16x16x32_bf16 v[16:19], v[164:167], v[36:39], v[16:19]
  v_mfma_f32_16x16x32_bf16 v[24:27], v[160:163], v[28:31], 0
  v_mfma_f32_16x16x32_bf16 v[24:27], v[168:171], v[36:39], v[24:27]
  v_mfma_f32_16x16x32_bf16 v[52:55], v[156:159], v[64:67], 0
  v_mfma_f32_16x16x32_bf16 v[52:55], v[164:167], v[72:75], v[52:55]
  v_mfma_f32_16x16x32_bf16 v[60:63], v[160:163], v[64:67], 0
  v_mfma_f32_16x16x32_bf16 v[60:63], v[168:171], v[72:75], v[60:63]
  s_nop 3
  v_pk_add_f32 v[244:245], v[244:245], s[76:77]
  v_pk_add_f32 v[246:247], v[246:247], s[76:77]
  v_pk_add_f32 v[32:33], v[32:33], s[76:77]
  v_pk_add_f32 v[34:35], v[34:35], s[76:77]
  v_rcp_f32 v244, v244
  v_rcp_f32 v245, v245
  v_rcp_f32 v246, v246
  v_rcp_f32 v247, v247
  v_rcp_f32 v32, v32
  v_rcp_f32 v33, v33
  v_rcp_f32 v34, v34
  v_rcp_f32 v35, v35
  v_pk_mul_f32 v[240:241], v[240:241], v[244:245]
  v_pk_mul_f32 v[242:243], v[242:243], v[246:247]
  v_pk_mul_f32 v[248:249], v[248:249], v[32:33]
  v_pk_mul_f32 v[250:251], v[250:251], v[34:35]
  v_cvt_pk_bf16_f32 v220, v240, v241
  v_cvt_pk_bf16_f32 v221, v242, v243
  v_cvt_pk_bf16_f32 v224, v248, v249
  v_cvt_pk_bf16_f32 v225, v250, v251
  v_mfma_f32_16x16x32_bf16 v[240:243], v[172:175], v[28:31], 0
  v_mfma_f32_16x16x32_bf16 v[240:243], v[180:183], v[36:39], v[240:243]
  v_mfma_f32_16x16x32_bf16 v[244:247], v[176:179], v[28:31], 0
  v_mfma_f32_16x16x32_bf16 v[244:247], v[184:187], v[36:39], v[244:247]
  v_mfma_f32_16x16x32_bf16 v[248:251], v[172:175], v[64:67], 0
  v_mfma_f32_16x16x32_bf16 v[248:251], v[180:183], v[72:75], v[248:251]
  v_mfma_f32_16x16x32_bf16 v[32:35], v[176:179], v[64:67], 0
  v_mfma_f32_16x16x32_bf16 v[32:35], v[184:187], v[72:75], v[32:35]
  s_nop 3
  v_pk_add_f32 v[24:25], v[24:25], s[76:77]
  v_pk_add_f32 v[26:27], v[26:27], s[76:77]
  v_pk_add_f32 v[60:61], v[60:61], s[76:77]
  v_pk_add_f32 v[62:63], v[62:63], s[76:77]
  v_rcp_f32 v24, v24
  v_rcp_f32 v25, v25
  v_rcp_f32 v26, v26
  v_rcp_f32 v27, v27
  v_rcp_f32 v60, v60
  v_rcp_f32 v61, v61
  v_rcp_f32 v62, v62
  v_rcp_f32 v63, v63
  v_pk_mul_f32 v[16:17], v[16:17], v[24:25]
  v_pk_mul_f32 v[18:19], v[18:19], v[26:27]
  v_pk_mul_f32 v[52:53], v[52:53], v[60:61]
  v_pk_mul_f32 v[54:55], v[54:55], v[62:63]
  v_cvt_pk_bf16_f32 v222, v16, v17
  v_cvt_pk_bf16_f32 v223, v18, v19
  v_cvt_pk_bf16_f32 v226, v52, v53
  v_cvt_pk_bf16_f32 v227, v54, v55
  s_add_u32 s75, s74, 262144
  buffer_store_dwordx4 v[220:223], v3, s[16:19], s75 offen offset:0 sc1
  buffer_store_dwordx4 v[224:227], v3, s[16:19], s75 offen offset:1024 sc1
  v_mfma_f32_16x16x32_bf16 v[16:19], v[188:191], v[36:39], 0
  v_mfma_f32_16x16x32_bf16 v[16:19], v[196:199], v[44:47], v[16:19]
  v_mfma_f32_16x16x32_bf16 v[24:27], v[192:195], v[36:39], 0
  v_mfma_f32_16x16x32_bf16 v[24:27], v[200:203], v[44:47], v[24:27]
  v_mfma_f32_16x16x32_bf16 v[52:55], v[188:191], v[72:75], 0
  v_mfma_f32_16x16x32_bf16 v[52:55], v[196:199], v[80:83], v[52:55]
  v_mfma_f32_16x16x32_bf16 v[60:63], v[192:195], v[72:75], 0
  v_mfma_f32_16x16x32_bf16 v[60:63], v[200:203], v[80:83], v[60:63]
  s_nop 3
  v_pk_add_f32 v[244:245], v[244:245], s[76:77]
  v_pk_add_f32 v[246:247], v[246:247], s[76:77]
  v_pk_add_f32 v[32:33], v[32:33], s[76:77]
  v_pk_add_f32 v[34:35], v[34:35], s[76:77]
  v_rcp_f32 v244, v244
  v_rcp_f32 v245, v245
  v_rcp_f32 v246, v246
  v_rcp_f32 v247, v247
  v_rcp_f32 v32, v32
  v_rcp_f32 v33, v33
  v_rcp_f32 v34, v34
  v_rcp_f32 v35, v35
  v_pk_mul_f32 v[240:241], v[240:241], v[244:245]
  v_pk_mul_f32 v[242:243], v[242:243], v[246:247]
  v_pk_mul_f32 v[248:249], v[248:249], v[32:33]
  v_pk_mul_f32 v[250:251], v[250:251], v[34:35]
  v_cvt_pk_bf16_f32 v228, v240, v241
  v_cvt_pk_bf16_f32 v229, v242, v243
  v_cvt_pk_bf16_f32 v232, v248, v249
  v_cvt_pk_bf16_f32 v233, v250, v251
  v_mfma_f32_16x16x32_bf16 v[240:243], v[204:207], v[36:39], 0
  v_mfma_f32_16x16x32_bf16 v[240:243], v[212:215], v[44:47], v[240:243]
  v_mfma_f32_16x16x32_bf16 v[244:247], v[208:211], v[36:39], 0
  v_mfma_f32_16x16x32_bf16 v[244:247], v[216:219], v[44:47], v[244:247]
  v_mfma_f32_16x16x32_bf16 v[248:251], v[204:207], v[72:75], 0
  v_mfma_f32_16x16x32_bf16 v[248:251], v[212:215], v[80:83], v[248:251]
  v_mfma_f32_16x16x32_bf16 v[32:35], v[208:211], v[72:75], 0
  v_mfma_f32_16x16x32_bf16 v[32:35], v[216:219], v[80:83], v[32:35]
  s_nop 3
  v_pk_add_f32 v[24:25], v[24:25], s[76:77]
  v_pk_add_f32 v[26:27], v[26:27], s[76:77]
  v_pk_add_f32 v[60:61], v[60:61], s[76:77]
  v_pk_add_f32 v[62:63], v[62:63], s[76:77]
  v_rcp_f32 v24, v24
  v_rcp_f32 v25, v25
  v_rcp_f32 v26, v26
  v_rcp_f32 v27, v27
  v_rcp_f32 v60, v60
  v_rcp_f32 v61, v61
  v_rcp_f32 v62, v62
  v_rcp_f32 v63, v63
  v_pk_mul_f32 v[16:17], v[16:17], v[24:25]
  v_pk_mul_f32 v[18:19], v[18:19], v[26:27]
  v_pk_mul_f32 v[52:53], v[52:53], v[60:61]
  v_pk_mul_f32 v[54:55], v[54:55], v[62:63]
  v_cvt_pk_bf16_f32 v230, v16, v17
  v_cvt_pk_bf16_f32 v231, v18, v19
  v_cvt_pk_bf16_f32 v234, v52, v53
  v_cvt_pk_bf16_f32 v235, v54, v55
  s_add_u32 s75, s74, 393216
  buffer_store_dwordx4 v[228:231], v3, s[16:19], s75 offen offset:0 sc1
  buffer_store_dwordx4 v[232:235], v3, s[16:19], s75 offen offset:1024 sc1
  s_nop 7
  v_pk_add_f32 v[244:245], v[244:245], s[76:77]
  v_pk_add_f32 v[246:247], v[246:247], s[76:77]
  v_pk_add_f32 v[32:33], v[32:33], s[76:77]
  v_pk_add_f32 v[34:35], v[34:35], s[76:77]
  v_rcp_f32 v244, v244
  v_rcp_f32 v245, v245
  v_rcp_f32 v246, v246
  v_rcp_f32 v247, v247
  v_rcp_f32 v32, v32
  v_rcp_f32 v33, v33
  v_rcp_f32 v34, v34
  v_rcp_f32 v35, v35
  v_pk_mul_f32 v[240:241], v[240:241], v[244:245]
  v_pk_mul_f32 v[242:243], v[242:243], v[246:247]
  v_pk_mul_f32 v[248:249], v[248:249], v[32:33]
  v_pk_mul_f32 v[250:251], v[250:251], v[34:35]
  v_cvt_pk_bf16_f32 v220, v240, v241
  v_cvt_pk_bf16_f32 v221, v242, v243
  v_mov_b32 v222, 0
  v_mov_b32 v223, 0
  v_cvt_pk_bf16_f32 v224, v248, v249
  v_cvt_pk_bf16_f32 v225, v250, v251
  v_mov_b32 v226, 0
  v_mov_b32 v227, 0
  s_add_u32 s75, s74, 524288
  buffer_store_dwordx4 v[220:223], v3, s[16:19], s75 offen offset:0 sc1
  buffer_store_dwordx4 v[224:227], v3, s[16:19], s75 offen offset:1024 sc1
  s_waitcnt vmcnt(0)
  v_mov_b32 v4, 163816
  v_mov_b32 v5, 1
  s_mov_b64 exec, 1
  ds_add_rtn_u32 v5, v4, v5
  s_lshl_b32 s67, s71, 2
  s_add_u32 s67, s67, s72
  s_lshl_b32 s67, s67, 7
  s_add_u32 s67, s67, 27688960
  s_waitcnt lgkmcnt(0)
  v_readfirstlane_b32 s68, v5
  s_mov_b64 exec, -1
  s_cmp_lg_u32 s68, 3
  s_cbranch_scc1 L_pub2
  v_mov_b32 v4, s54
  v_lshlrev_b32 v5, 2, v1
  s_mov_b64 exec, 1
  buffer_store_dword v4, v5, s[16:19], s67 offen sc1
  s_mov_b64 exec, -1
L_pub2:
  s_cmp_eq_u32 s72, 3
  s_cbranch_scc1 L_fin
  v_lshrrev_b32 v5, 4, v1
  v_bfe_u32 v6, v1, 2, 2
  v_and_b32 v7, 3, v1
  v_lshlrev_b32 v8, 4, v1
  s_and_b32 s84, s3, 1
  s_and_b32 s85, s3, 2
  v_lshl_add_u32 v10, v5, 2, v6
  v_mul_u32_u24 v11, 384, v10
  v_lshl_add_u32 v11, v7, 4, v11
  v_bfe_u32 v10, v10, 1, 1
  s_mul_i32 s67, s84, 3
  s_add_u32 s67, s67, 0
  v_xor_b32 v14, s67, v10
  v_lshl_add_u32 v2, v14, 6, v11
  s_mul_i32 s67, s84, 3
  s_add_u32 s67, s67, 1
  v_xor_b32 v14, s67, v10
  v_lshl_add_u32 v3, v14, 6, v11
  s_lshl_b32 s67, s85, 11
  s_add_u32 s67, s67, 12288
  v_add_u32 v4, s67, v8
  v_mov_b32 v16, 0
  v_mov_b32 v17, 0
  v_mov_b32 v18, 0
  v_mov_b32 v19, 0
  v_mov_b32 v20, 0
  v_mov_b32 v21, 0
  v_mov_b32 v22, 0
  v_mov_b32 v23, 0
  v_mov_b32 v24, 0
  v_mov_b32 v25, 0
  v_mov_b32 v26, 0
  v_mov_b32 v27, 0
  v_mov_b32 v28, 0
  v_mov_b32 v29, 0
  v_mov_b32 v30, 0
  v_mov_b32 v31, 0
  v_mov_b32 v32, 0
  v_mov_b32 v33, 0
  v_mov_b32 v34, 0
  v_mov_b32 v35, 0
  v_mov_b32 v36, 0
  v_mov_b32 v37, 0
  v_mov_b32 v38, 0
  v_mov_b32 v39, 0
  v_mov_b32 v40, 0
  v_mov_b32 v41, 0
  v_mov_b32 v42, 0
  v_mov_b32 v43, 0
  v_mov_b32 v44, 0
  v_mov_b32 v45, 0
  v_mov_b32 v46, 0
  v_mov_b32 v47, 0
  v_mov_b32 v48, 0
  v_mov_b32 v49, 0
  v_mov_b32 v50, 0
  v_mov_b32 v51, 0
  v_mov_b32 v52, 0
  v_mov_b32 v53, 0
  v_mov_b32 v54, 0
  v_mov_b32 v55, 0
  v_mov_b32 v56, 0
  v_mov_b32 v57, 0
  v_mov_b32 v58, 0
  v_mov_b32 v59, 0
  v_mov_b32 v60, 0
  v_mov_b32 v61, 0
  v_mov_b32 v62, 0
  v_mov_b32 v63, 0
  v_mov_b32 v64, 0
  v_mov_b32 v65, 0
  v_mov_b32 v66, 0
  v_mov_b32 v67, 0
  v_mov_b32 v68, 0
  v_mov_b32 v69, 0
  v_mov_b32 v70, 0
  v_mov_b32 v71, 0
  v_mov_b32 v72, 0
  v_mov_b32 v73, 0
  v_mov_b32 v74, 0
  v_mov_b32 v75, 0
  v_mov_b32 v76, 0
  v_mov_b32 v77, 0
  v_mov_b32 v78, 0
  v_mov_b32 v79, 0
  v_mov_b32 v80, 0
  v_mov_b32 v81, 0
  v_mov_b32 v82, 0
  v_mov_b32 v83, 0
  v_mov_b32 v84, 0
  v_mov_b32 v85, 0
  v_mov_b32 v86, 0
  v_mov_b32 v87, 0
  v_mov_b32 v88, 0
  v_mov_b32 v89, 0
  v_mov_b32 v90, 0
  v_mov_b32 v91, 0
  v_mov_b32 v92, 0
  v_mov_b32 v93, 0
  v_mov_b32 v94, 0
  v_mov_b32 v95, 0
  v_mov_b32 v96, 0
  v_mov_b32 v97, 0
  v_mov_b32 v98, 0
  v_mov_b32 v99, 0
  v_mov_b32 v100, 0
  v_mov_b32 v101, 0
  v_mov_b32 v102, 0
  v_mov_b32 v103, 0
  v_mov_b32 v104, 0
  v_mov_b32 v105, 0
  v_mov_b32 v106, 0
  v_mov_b32 v107, 0
  v_mov_b32 v108, 0
  v_mov_b32 v109, 0
  v_mov_b32 v110, 0
  v_mov_b32 v111, 0
  s_mov_b32 s60, 0
  s_barrier
  ds_read_b128 v[112:115], v4 offset:0
  ds_read_b64_tr_b16 v[128:129], v2 offset:0
  ds_read_b64_tr_b16 v[130:131], v2 offset:6144
  ds_read_b128 v[116:119], v4 offset:1024
  ds_read_b64_tr_b16 v[132:133], v2 offset:8
  ds_read_b64_tr_b16 v[134:135], v2 offset:6152
  ds_read_b128 v[120:123], v4 offset:2048
  ds_read_b64_tr_b16 v[136:137], v3 offset:0
  ds_read_b64_tr_b16 v[138:139], v3 offset:6144
  ds_read_b128 v[124:127], v4 offset:3072
  ds_read_b64_tr_b16 v[140:141], v3 offset:8
  ds_read_b64_tr_b16 v[142:143], v3 offset:6152
  ds_read_b64_tr_b16 v[144:145], v2 offset:128
  ds_read_b64_tr_b16 v[146:147], v2 offset:6272
  ds_read_b64_tr_b16 v[148:149], v2 offset:136
  ds_read_b64_tr_b16 v[150:151], v2 offset:6280
  s_add_u32 s69, s60, 20480
  s_cmp_eq_u32 s69, 102400
  s_cselect_b32 s69, 0, s69
  s_sub_u32 s60, s69, s60
  v_add_u32 v2, s60, v2
  v_add_u32 v3, s60, v3
  v_add_u32 v4, s60, v4
  s_mov_b32 s60, s69
  s_mov_b32 s61, 9
L_pj_main:
  s_waitcnt lgkmcnt(0)
  v_mfma_f32_16x16x32_bf16 v[16:19], v[128:131], v[112:115], v[16:19]
  s_barrier
  v_mfma_f32_16x16x32_bf16 v[40:43], v[128:131], v[116:119], v[40:43]
  ds_read_b128 v[152:155], v4 offset:0
  v_mfma_f32_16x16x32_bf16 v[64:67], v[128:131], v[120:123], v[64:67]
  ds_read_b64_tr_b16 v[168:169], v2 offset:0
  v_mfma_f32_16x16x32_bf16 v[88:91], v[128:131], v[124:127], v[88:91]
  ds_read_b64_tr_b16 v[170:171], v2 offset:6144
  v_mfma_f32_16x16x32_bf16 v[20:23], v[132:135], v[112:115], v[20:23]
  ds_read_b128 v[156:159], v4 offset:1024
  v_mfma_f32_16x16x32_bf16 v[44:47], v[132:135], v[116:119], v[44:47]
  ds_read_b64_tr_b16 v[172:173], v2 offset:8
  v_mfma_f32_16x16x32_bf16 v[68:71], v[132:135], v[120:123], v[68:71]
  ds_read_b64_tr_b16 v[174:175], v2 offset:6152
  v_mfma_f32_16x16x32_bf16 v[92:95], v[132:135], v[124:127], v[92:95]
  ds_read_b128 v[160:163], v4 offset:2048
  v_mfma_f32_16x16x32_bf16 v[24:27], v[136:139], v[112:115], v[24:27]
  ds_read_b64_tr_b16 v[176:177], v3 offset:0
  v_mfma_f32_16x16x32_bf16 v[48:51], v[136:139], v[116:119], v[48:51]
  ds_read_b64_tr_b16 v[178:179], v3 offset:6144
  v_mfma_f32_16x16x32_bf16 v[72:75], v[136:139], v[120:123], v[72:75]
  ds_read_b128 v[164:167], v4 offset:3072
  v_mfma_f32_16x16x32_bf16 v[96:99], v[136:139], v[124:127], v[96:99]
  ds_read_b64_tr_b16 v[180:181], v3 offset:8
  v_mfma_f32_16x16x32_bf16 v[28:31], v[140:143], v[112:115], v[28:31]
  ds_read_b64_tr_b16 v[182:183], v3 offset:6152
  v_mfma_f32_16x16x32_bf16 v[52:55], v[140:143], v[116:119], v[52:55]
  ds_read_b64_tr_b16 v[184:185], v2 offset:128
  v_mfma_f32_16x16x32_bf16 v[76:79], v[140:143], v[120:123], v[76:79]
  ds_read_b64_tr_b16 v[186:187], v2 offset:6272
  v_mfma_f32_16x16x32_bf16 v[100:103], v[140:143], v[124:127], v[100:103]
  ds_read_b64_tr_b16 v[188:189], v2 offset:136
  v_mfma_f32_16x16x32_bf16 v[32:35], v[144:147], v[112:115], v[32:35]
  ds_read_b64_tr_b16 v[190:191], v2 offset:6280
  v_mfma_f32_16x16x32_bf16 v[56:59], v[144:147], v[116:119], v[56:59]
  s_add_u32 s69, s60, 20480
  s_cmp_eq_u32 s69, 102400
  v_mfma_f32_16x16x32_bf16 v[80:83], v[144:147], v[120:123], v[80:83]
  s_cselect_b32 s69, 0, s69
  s_sub_u32 s60, s69, s60
  v_mfma_f32_16x16x32_bf16 v[104:107], v[144:147], v[124:127], v[104:107]
  v_add_u32 v2, s60, v2
  v_add_u32 v3, s60, v3
  v_mfma_f32_16x16x32_bf16 v[36:39], v[148:151], v[112:115], v[36:39]
  v_add_u32 v4, s60, v4
  s_mov_b32 s60, s69
  v_mfma_f32_16x16x32_bf16 v[60:63], v[148:151], v[116:119], v[60:63]
  v_mfma_f32_16x16x32_bf16 v[84:87], v[148:151], v[120:123], v[84:87]
  v_mfma_f32_16x16x32_bf16 v[108:111], v[148:151], v[124:127], v[108:111]
  s_waitcnt lgkmcnt(0)
  v_mfma_f32_16x16x32_bf16 v[16:19], v[168:171], v[152:155], v[16:19]
  s_barrier
  v_mfma_f32_16x16x32_bf16 v[40:43], v[168:171], v[156:159], v[40:43]
  ds_read_b128 v[112:115], v4 offset:0
  v_mfma_f32_16x16x32_bf16 v[64:67], v[168:171], v[160:163], v[64:67]
  ds_read_b64_tr_b16 v[128:129], v2 offset:0
  v_mfma_f32_16x16x32_bf16 v[88:91], v[168:171], v[164:167], v[88:91]
  ds_read_b64_tr_b16 v[130:131], v2 offset:6144
  v_mfma_f32_16x16x32_bf16 v[20:23], v[172:175], v[152:155], v[20:23]
  ds_read_b128 v[116:119], v4 offset:1024
  v_mfma_f32_16x16x32_bf16 v[44:47], v[172:175], v[156:159], v[44:47]
  ds_read_b64_tr_b16 v[132:133], v2 offset:8
  v_mfma_f32_16x16x32_bf16 v[68:71], v[172:175], v[160:163], v[68:71]
  ds_read_b64_tr_b16 v[134:135], v2 offset:6152
  v_mfma_f32_16x16x32_bf16 v[92:95], v[172:175], v[164:167], v[92:95]
  ds_read_b128 v[120:123], v4 offset:2048
  v_mfma_f32_16x16x32_bf16 v[24:27], v[176:179], v[152:155], v[24:27]
  ds_read_b64_tr_b16 v[136:137], v3 offset:0
  v_mfma_f32_16x16x32_bf16 v[48:51], v[176:179], v[156:159], v[48:51]
  ds_read_b64_tr_b16 v[138:139], v3 offset:6144
  v_mfma_f32_16x16x32_bf16 v[72:75], v[176:179], v[160:163], v[72:75]
  ds_read_b128 v[124:127], v4 offset:3072
  v_mfma_f32_16x16x32_bf16 v[96:99], v[176:179], v[164:167], v[96:99]
  ds_read_b64_tr_b16 v[140:141], v3 offset:8
  v_mfma_f32_16x16x32_bf16 v[28:31], v[180:183], v[152:155], v[28:31]
  ds_read_b64_tr_b16 v[142:143], v3 offset:6152
  v_mfma_f32_16x16x32_bf16 v[52:55], v[180:183], v[156:159], v[52:55]
  ds_read_b64_tr_b16 v[144:145], v2 offset:128
  v_mfma_f32_16x16x32_bf16 v[76:79], v[180:183], v[160:163], v[76:79]
  ds_read_b64_tr_b16 v[146:147], v2 offset:6272
  v_mfma_f32_16x16x32_bf16 v[100:103], v[180:183], v[164:167], v[100:103]
  ds_read_b64_tr_b16 v[148:149], v2 offset:136
  v_mfma_f32_16x16x32_bf16 v[32:35], v[184:187], v[152:155], v[32:35]
  ds_read_b64_tr_b16 v[150:151], v2 offset:6280
  v_mfma_f32_16x16x32_bf16 v[56:59], v[184:187], v[156:159], v[56:59]
  s_add_u32 s69, s60, 20480
  s_cmp_eq_u32 s69, 102400
  v_mfma_f32_16x16x32_bf16 v[80:83], v[184:187], v[160:163], v[80:83]
  s_cselect_b32 s69, 0, s69
  s_sub_u32 s60, s69, s60
  v_mfma_f32_16x16x32_bf16 v[104:107], v[184:187], v[164:167], v[104:107]
  v_add_u32 v2, s60, v2
  v_add_u32 v3, s60, v3
  v_mfma_f32_16x16x32_bf16 v[36:39], v[188:191], v[152:155], v[36:39]
  v_add_u32 v4, s60, v4
  s_mov_b32 s60, s69
  v_mfma_f32_16x16x32_bf16 v[60:63], v[188:191], v[156:159], v[60:63]
  v_mfma_f32_16x16x32_bf16 v[84:87], v[188:191], v[160:163], v[84:87]
  s_sub_u32 s61, s61, 1
  s_cmp_lg_u32 s61, 0
  v_mfma_f32_16x16x32_bf16 v[108:111], v[188:191], v[164:167], v[108:111]
  s_cbranch_scc1 L_pj_main
  s_waitcnt lgkmcnt(0)
  v_mfma_f32_16x16x32_bf16 v[16:19], v[128:131], v[112:115], v[16:19]
  s_barrier
  v_mfma_f32_16x16x32_bf16 v[40:43], v[128:131], v[116:119], v[40:43]
  ds_read_b128 v[152:155], v4 offset:0
  v_mfma_f32_16x16x32_bf16 v[64:67], v[128:131], v[120:123], v[64:67]
  ds_read_b64_tr_b16 v[168:169], v2 offset:0
  v_mfma_f32_16x16x32_bf16 v[88:91], v[128:131], v[124:127], v[88:91]
  ds_read_b64_tr_b16 v[170:171], v2 offset:6144
  v_mfma_f32_16x16x32_bf16 v[20:23], v[132:135], v[112:115], v[20:23]
  ds_read_b128 v[156:159], v4 offset:1024
  v_mfma_f32_16x16x32_bf16 v[44:47], v[132:135], v[116:119], v[44:47]
  ds_read_b64_tr_b16 v[172:173], v2 offset:8
  v_mfma_f32_16x16x32_bf16 v[68:71], v[132:135], v[120:123], v[68:71]
  ds_read_b64_tr_b16 v[174:175], v2 offset:6152
  v_mfma_f32_16x16x32_bf16 v[92:95], v[132:135], v[124:127], v[92:95]
  ds_read_b128 v[160:163], v4 offset:2048
  v_mfma_f32_16x16x32_bf16 v[24:27], v[136:139], v[112:115], v[24:27]
  ds_read_b64_tr_b16 v[176:177], v3 offset:0
  v_mfma_f32_16x16x32_bf16 v[48:51], v[136:139], v[116:119], v[48:51]
  ds_read_b64_tr_b16 v[178:179], v3 offset:6144
  v_mfma_f32_16x16x32_bf16 v[72:75], v[136:139], v[120:123], v[72:75]
  ds_read_b128 v[164:167], v4 offset:3072
  v_mfma_f32_16x16x32_bf16 v[96:99], v[136:139], v[124:127], v[96:99]
  ds_read_b64_tr_b16 v[180:181], v3 offset:8
  v_mfma_f32_16x16x32_bf16 v[28:31], v[140:143], v[112:115], v[28:31]
  ds_read_b64_tr_b16 v[182:183], v3 offset:6152
  v_mfma_f32_16x16x32_bf16 v[52:55], v[140:143], v[116:119], v[52:55]
  ds_read_b64_tr_b16 v[184:185], v2 offset:128
  v_mfma_f32_16x16x32_bf16 v[76:79], v[140:143], v[120:123], v[76:79]
  ds_read_b64_tr_b16 v[186:187], v2 offset:6272
  v_mfma_f32_16x16x32_bf16 v[100:103], v[140:143], v[124:127], v[100:103]
  ds_read_b64_tr_b16 v[188:189], v2 offset:136
  v_mfma_f32_16x16x32_bf16 v[32:35], v[144:147], v[112:115], v[32:35]
  ds_read_b64_tr_b16 v[190:191], v2 offset:6280
  v_mfma_f32_16x16x32_bf16 v[56:59], v[144:147], v[116:119], v[56:59]
  s_add_u32 s69, s60, 20480
  s_cmp_eq_u32 s69, 102400
  v_mfma_f32_16x16x32_bf16 v[80:83], v[144:147], v[120:123], v[80:83]
  s_cselect_b32 s69, 0, s69
  s_sub_u32 s60, s69, s60
  v_mfma_f32_16x16x32_bf16 v[104:107], v[144:147], v[124:127], v[104:107]
  v_add_u32 v2, s60, v2
  v_add_u32 v3, s60, v3
  v_mfma_f32_16x16x32_bf16 v[36:39], v[148:151], v[112:115], v[36:39]
  v_add_u32 v4, s60, v4
  s_mov_b32 s60, s69
  v_mfma_f32_16x16x32_bf16 v[60:63], v[148:151], v[116:119], v[60:63]
  v_mfma_f32_16x16x32_bf16 v[84:87], v[148:151], v[120:123], v[84:87]
  v_mfma_f32_16x16x32_bf16 v[108:111], v[148:151], v[124:127], v[108:111]
  s_waitcnt lgkmcnt(0)
  v_mfma_f32_16x16x32_bf16 v[16:19], v[168:171], v[152:155], v[16:19]
  v_mfma_f32_16x16x32_bf16 v[40:43], v[168:171], v[156:159], v[40:43]
  v_mfma_f32_16x16x32_bf16 v[64:67], v[168:171], v[160:163], v[64:67]
  v_mfma_f32_16x16x32_bf16 v[88:91], v[168:171], v[164:167], v[88:91]
  v_mfma_f32_16x16x32_bf16 v[20:23], v[172:175], v[152:155], v[20:23]
  v_mfma_f32_16x16x32_bf16 v[44:47], v[172:175], v[156:159], v[44:47]
  v_mfma_f32_16x16x32_bf16 v[68:71], v[172:175], v[160:163], v[68:71]
  v_mfma_f32_16x16x32_bf16 v[92:95], v[172:175], v[164:167], v[92:95]
  v_mfma_f32_16x16x32_bf16 v[24:27], v[176:179], v[152:155], v[24:27]
  v_mfma_f32_16x16x32_bf16 v[48:51], v[176:179], v[156:159], v[48:51]
  v_mfma_f32_16x16x32_bf16 v[72:75], v[176:179], v[160:163], v[72:75]
  v_mfma_f32_16x16x32_bf16 v[96:99], v[176:179], v[164:167], v[96:99]
  v_mfma_f32_16x16x32_bf16 v[28:31], v[180:183], v[152:155], v[28:31]
  v_mfma_f32_16x16x32_bf16 v[52:55], v[180:183], v[156:159], v[52:55]
  v_mfma_f32_16x16x32_bf16 v[76:79], v[180:183], v[160:163], v[76:79]
  v_mfma_f32_16x16x32_bf16 v[100:103], v[180:183], v[164:167], v[100:103]
  v_mfma_f32_16x16x32_bf16 v[32:35], v[184:187], v[152:155], v[32:35]
  v_mfma_f32_16x16x32_bf16 v[56:59], v[184:187], v[156:159], v[56:59]
  v_mfma_f32_16x16x32_bf16 v[80:83], v[184:187], v[160:163], v[80:83]
  v_mfma_f32_16x16x32_bf16 v[104:107], v[184:187], v[164:167], v[104:107]
  v_mfma_f32_16x16x32_bf16 v[36:39], v[188:191], v[152:155], v[36:39]
  v_mfma_f32_16x16x32_bf16 v[60:63], v[188:191], v[156:159], v[60:63]
  v_mfma_f32_16x16x32_bf16 v[84:87], v[188:191], v[160:163], v[84:87]
  v_mfma_f32_16x16x32_bf16 v[108:111], v[188:191], v[164:167], v[108:111]
  s_lshl_b32 s78, s72, 3
  s_and_b32 s67, s71, 7
  s_add_u32 s78, s78, s67
  s_lshl_b32 s78, s78, 1
  s_lshr_b32 s67, s71, 3
  s_add_u32 s78, s78, s67
  s_lshl_b32 s78, s78, 2
  s_lshl_b32 s79, s78, 2
  s_add_u32 s79, s79, s3
  s_mul_i32 s79, s79, 12288
  s_add_u32 s79, s79, 33563648
  v_cvt_pk_bf16_f32 v16, v16, v17
  v_cvt_pk_bf16_f32 v17, v18, v19
  v_cvt_pk_bf16_f32 v18, v20, v21
  v_cvt_pk_bf16_f32 v19, v22, v23
  buffer_store_dwordx4 v[16:19], v8, s[16:19], s79 offen offset:0 sc1
  v_cvt_pk_bf16_f32 v24, v24, v25
  v_cvt_pk_bf16_f32 v25, v26, v27
  v_cvt_pk_bf16_f32 v26, v28, v29
  v_cvt_pk_bf16_f32 v27, v30, v31
  buffer_store_dwordx4 v[24:27], v8, s[16:19], s79 offen offset:1024 sc1
  v_cvt_pk_bf16_f32 v32, v32, v33
  v_cvt_pk_bf16_f32 v33, v34, v35
  v_cvt_pk_bf16_f32 v34, v36, v37
  v_cvt_pk_bf16_f32 v35, v38, v39
  buffer_store_dwordx4 v[32:35], v8, s[16:19], s79 offen offset:2048 sc1
  s_add_u32 s79, s79, 49152
  v_cvt_pk_bf16_f32 v40, v40, v41
  v_cvt_pk_bf16_f32 v41, v42, v43
  v_cvt_pk_bf16_f32 v42, v44, v45
  v_cvt_pk_bf16_f32 v43, v46, v47
  buffer_store_dwordx4 v[40:43], v8, s[16:19], s79 offen offset:0 sc1
  v_cvt_pk_bf16_f32 v48, v48, v49
  v_cvt_pk_bf16_f32 v49, v50, v51
  v_cvt_pk_bf16_f32 v50, v52, v53
  v_cvt_pk_bf16_f32 v51, v54, v55
  buffer_store_dwordx4 v[48:51], v8, s[16:19], s79 offen offset:1024 sc1
  v_cvt_pk_bf16_f32 v56, v56, v57
  v_cvt_pk_bf16_f32 v57, v58, v59
  v_cvt_pk_bf16_f32 v58, v60, v61
  v_cvt_pk_bf16_f32 v59, v62, v63
  buffer_store_dwordx4 v[56:59], v8, s[16:19], s79 offen offset:2048 sc1
  s_add_u32 s79, s79, 49152
  v_cvt_pk_bf16_f32 v64, v64, v65
  v_cvt_pk_bf16_f32 v65, v66, v67
  v_cvt_pk_bf16_f32 v66, v68, v69
  v_cvt_pk_bf16_f32 v67, v70, v71
  buffer_store_dwordx4 v[64:67], v8, s[16:19], s79 offen offset:0 sc1
  v_cvt_pk_bf16_f32 v72, v72, v73
  v_cvt_pk_bf16_f32 v73, v74, v75
  v_cvt_pk_bf16_f32 v74, v76, v77
  v_cvt_pk_bf16_f32 v75, v78, v79
  buffer_store_dwordx4 v[72:75], v8, s[16:19], s79 offen offset:1024 sc1
  v_cvt_pk_bf16_f32 v80, v80, v81
  v_cvt_pk_bf16_f32 v81, v82, v83
  v_cvt_pk_bf16_f32 v82, v84, v85
  v_cvt_pk_bf16_f32 v83, v86, v87
  buffer_store_dwordx4 v[80:83], v8, s[16:19], s79 offen offset:2048 sc1
  s_add_u32 s79, s79, 49152
  v_cvt_pk_bf16_f32 v88, v88, v89
  v_cvt_pk_bf16_f32 v89, v90, v91
  v_cvt_pk_bf16_f32 v90, v92, v93
  v_cvt_pk_bf16_f32 v91, v94, v95
  buffer_store_dwordx4 v[88:91], v8, s[16:19], s79 offen offset:0 sc1
  v_cvt_pk_bf16_f32 v96, v96, v97
  v_cvt_pk_bf16_f32 v97, v98, v99
  v_cvt_pk_bf16_f32 v98, v100, v101
  v_cvt_pk_bf16_f32 v99, v102, v103
  buffer_store_dwordx4 v[96:99], v8, s[16:19], s79 offen offset:1024 sc1
  v_cvt_pk_bf16_f32 v104, v104, v105
  v_cvt_pk_bf16_f32 v105, v106, v107
  v_cvt_pk_bf16_f32 v106, v108, v109
  v_cvt_pk_bf16_f32 v107, v110, v111
  buffer_store_dwordx4 v[104:107], v8, s[16:19], s79 offen offset:2048 sc1
  s_add_u32 s79, s79, 49152
  s_add_u32 s78, s78, s3
  s_lshl_b32 s78, s78, 10
  s_add_u32 s78, s78, 27722240
  s_waitcnt vmcnt(0)
  v_mov_b32 v10, s54
  v_lshlrev_b32 v11, 2, v1
  s_mov_b64 exec, 1
  buffer_store_dword v10, v11, s[16:19], s78 offen sc1
  s_mov_b64 exec, -1
  s_branch L_fin
L_loaders:
  s_waitcnt lgkmcnt(0)
  s_barrier
  s_add_u32 s54, s54, 0x9e3779b9
  s_lshl_b32 s100, s54, 16
  s_and_b32 s100, s100, 0x9fff0000
  s_or_b32 s100, s100, 0x20000000
  s_and_b32 s101, s54, 0x9fff0000
  s_or_b32 s101, s101, 0x20000000
  s_sub_u32 s70, s3, 4
  s_cmp_lg_u32 s3, 5
  s_cbranch_scc1 L_nocode
  s_lshl_b32 s67, s53, 13
  s_cmp_ge_u32 s67, L_code_end-parallel_sum__linear_attn_block__mixer_token_mlp__prompt_kernel
  s_cbranch_scc1 L_nocode
  s_getpc_b64 s[80:81]
L_pc:
  s_sub_u32 s80, s80, L_pc-parallel_sum__linear_attn_block__mixer_token_mlp__prompt_kernel
  s_subb_u32 s81, s81, 0
  v_lshlrev_b32 v2, 7, v1
  v_add_u32 v2, s67, v2
  v_min_u32 v2, L_code_end-parallel_sum__linear_attn_block__mixer_token_mlp__prompt_kernel-4, v2
  v_mov_b32 v3, s81
  v_add_co_u32 v2, vcc, s80, v2
  s_nop 1
  v_addc_co_u32 v3, vcc, 0, v3, vcc
  global_load_dword v250, v[2:3], off
L_nocode:
  s_cmp_ge_u32 s53, 24
  s_cbranch_scc1 L_kv_ld
  s_and_b32 s71, s53, 3
  s_lshr_b32 s72, s53, 2
  s_mul_i32 s73, s52, 6
  s_add_u32 s73, s73, s72
  s_mul_i32 s67, s70, 192
  v_add_u32 v7, s67, v1
  v_add_u32 v8, 0, v7
  s_mov_b32 s67, 357913942
  v_mul_hi_u32 v9, v8, s67
  v_mul_u32_u24 v10, 12, v9
  v_sub_u32 v10, v8, v10
  v_bfe_u32 v8, v9, 3, 1
  v_lshlrev_b32 v8, 1, v8
  v_xor_b32 v10, v10, v8
  v_mul_u32_u24 v3, 9216, v9
  v_lshl_add_u32 v3, v10, 4, v3
  v_add_u32 v8, 64, v7
  s_mov_b32 s67, 357913942
  v_mul_hi_u32 v9, v8, s67
  v_mul_u32_u24 v10, 12, v9
  v_sub_u32 v10, v8, v10
  v_bfe_u32 v8, v9, 3, 1
  v_lshlrev_b32 v8, 1, v8
  v_xor_b32 v10, v10, v8
  v_mul_u32_u24 v4, 9216, v9
  v_lshl_add_u32 v4, v10, 4, v4
  v_subrev_u32 v4, 1024, v4
  v_add_u32 v8, 128, v7
  s_mov_b32 s67, 357913942
  v_mul_hi_u32 v9, v8, s67
  v_mul_u32_u24 v10, 12, v9
  v_sub_u32 v10, v8, v10
  v_bfe_u32 v8, v9, 3, 1
  v_lshlrev_b32 v8, 1, v8
  v_xor_b32 v10, v10, v8
  v_mul_u32_u24 v5, 9216, v9
  v_lshl_add_u32 v5, v10, 4, v5
  v_subrev_u32 v5, 2048, v5
  s_mul_i32 s65, s73, 192
  s_mul_i32 s79, s70, 3072
  s_add_u32 s79, s79, 18432
  s_mul_i32 s67, s71, 3
  s_lshl_b32 s68, s72, 1
  s_add_u32 s67, s67, s68
  s_cmp_ge_u32 s67, 12
  s_cselect_b32 s68, 12, 0
  s_sub_u32 s67, s67, s68
  s_mul_i32 s67, s67, 4
  s_mul_hi_u32 s78, s67, 357913942
  s_mov_b32 s56, s78
  s_mov_b32 s57, 0
  s_mov_b32 s58, 0
  s_mov_b32 s60, 0
  s_mul_i32 s64, s71, 9216
  s_add_u32 s64, s64, 0
  s_lshr_b32 s67, s70, 1
  s_and_b32 s68, s70, 1
  s_lshl_b32 s68, s68, 12
  s_mul_i32 s74, s67, 36864
  s_add_u32 s74, s74, s68
  s_mul_i32 s75, s67, 9216
  s_add_u32 s75, s75, s68
  s_mul_i32 s76, s70, 36864
  s_add_u32 s76, s76, 8192
  s_mul_i32 s77, s70, 9216
  s_add_u32 s77, s77, 8192
  v_lshlrev_b32 v2, 4, v1
  s_mul_i32 s81, s52, 1152
  s_mov_b32 s80, 12
  s_mov_b32 s83, 0
  s_mov_b32 s82, s53
  s_lshl_b32 s67, s82, 6
  v_add_u32 v12, s67, v1
  v_mov_b32 v18, 2147479552
  s_cmp_lt_u32 s3, 7
  s_cbranch_scc1 L_g1_nopf0
  v_mov_b32 v15, 163808
L_g1_pfa:
  s_cmp_eq_u32 s80, 0
  s_cbranch_scc1 L_g1_pfa_x
  ds_read_b32 v17, v15
  s_mov_b32 s67, 477218589
  v_mul_hi_u32 v13, v12, s67
  v_mul_u32_u24 v14, 9, v13
  v_sub_u32 v14, v12, v14
  v_mul_u32_u24 v13, 9216, v13
  v_lshl_add_u32 v13, v14, 7, v13
  s_waitcnt lgkmcnt(0)
  v_readfirstlane_b32 s67, v17
  s_cmp_ge_u32 s67, 4
  s_cbranch_scc1 L_g1_pfa_x
  buffer_load_dword v16, v13, s[20:23], s81 offen
  v_add_u32 v12, 1536, v12
  s_sub_u32 s80, s80, 1
  s_waitcnt vmcnt(1)
  s_branch L_g1_pfa
L_g1_pfa_x:
L_g1_nopf0:
  s_cmp_lg_u32 s3, 6
  s_cbranch_scc1 L_g1_nopfq
  s_and_b32 s82, s52, 3
  s_mul_i32 s81, s82, 288
  s_and_b32 s81, s81, 0xffffff80
  s_mul_i32 s82, s82, 165888
  s_lshl_b32 s67, s53, 6
  s_add_u32 s67, s67, 0
  v_add_u32 v12, s67, v1
  s_mov_b32 s67, 1431655766
  s_mov_b32 s68, 2
  v_mov_b32 v15, 2147479552
L_g1_pfq:
  v_mul_hi_u32 v13, v12, s67
  v_mul_u32_u24 v14, 3, v13
  v_sub_u32 v14, v12, v14
  v_mul_u32_u24 v13, 3456, v13
  v_cmp_gt_u32 vcc, 1728, v12
  v_lshl_add_u32 v13, v14, 7, v13
  v_add_u32 v12, 1536, v12
  v_cndmask_b32 v13, v15, v13, vcc
  s_waitcnt vmcnt(0)
  buffer_load_dword v16, v13, s[28:31], s81 offen
  s_sub_u32 s68, s68, 1
  s_cmp_lg_u32 s68, 0
  s_cbranch_scc1 L_g1_pfq
  s_lshr_b32 s82, s52, 2
  s_add_u32 s82, s82, s52
  s_and_b32 s82, s82, 3
  s_mul_i32 s82, s82, 165888
  s_lshl_b32 s67, s53, 6
  s_add_u32 s67, s67, 0
  v_add_u32 v12, s67, v1
  s_mov_b32 s67, 536870912
  s_mov_b32 s68, 1
  v_mov_b32 v15, 2147479552
L_g1_pfo:
  v_mul_hi_u32 v13, v12, s67
  v_mul_u32_u24 v14, 8, v13
  v_sub_u32 v14, v12, v14
  v_mul_u32_u24 v13, 1024, v13
  v_cmp_gt_u32 vcc, 1296, v12
  v_lshl_add_u32 v13, v14, 7, v13
  v_add_u32 v12, 1536, v12
  v_cndmask_b32 v13, v15, v13, vcc
  s_waitcnt vmcnt(0)
  buffer_load_dword v16, v13, s[32:35], s82 offen
  s_sub_u32 s68, s68, 1
  s_cmp_lg_u32 s68, 0
  s_cbranch_scc1 L_g1_pfo
L_g1_nopfq:
  v_mov_b32 v20, 163808
  s_mov_b32 s68, 0x80000
L_g1_lnw:
  ds_read_b32 v21, v20
  s_sub_u32 s68, s68, 1
  s_cmp_eq_u32 s68, 0
  s_cbranch_scc1 L_g1_lnw_x
  s_waitcnt lgkmcnt(0)
  v_readfirstlane_b32 s67, v21
  s_cmp_ge_u32 s67, 4
  s_cbranch_scc1 L_g1_lnw_x
  s_sleep 1
  s_branch L_g1_lnw
L_g1_lnw_x:
  s_waitcnt lgkmcnt(0)
  s_add_u32 s66, s58, s56
  s_mul_i32 s63, s66, 589824
  s_add_u32 m0, s60, s79
  s_add_u32 s63, s63, s65
  buffer_load_dwordx4 v3, s[20:23], s63 offen lds
  buffer_load_dwordx4 v4, s[20:23], s63 offen offset:1024 lds
  buffer_load_dwordx4 v5, s[20:23], s63 offen offset:2048 lds
  s_add_u32 s56, s56, 1
  s_cmp_eq_u32 s56, 4
  s_cselect_b32 s56, 0, s56
  s_add_u32 s57, s57, 1
  s_cmp_eq_u32 s57, 4
  s_cselect_b32 s57, 0, s57
  s_cselect_b32 s59, 4, 0
  s_add_u32 s58, s58, s59
  s_add_u32 s60, s60, 30720
  s_cmp_eq_u32 s60, 153600
  s_cselect_b32 s60, 0, s60
  s_add_u32 s66, s58, s56
  s_mul_i32 s63, s66, 589824
  s_add_u32 m0, s60, s79
  s_add_u32 s63, s63, s65
  buffer_load_dwordx4 v3, s[20:23], s63 offen lds
  buffer_load_dwordx4 v4, s[20:23], s63 offen offset:1024 lds
  buffer_load_dwordx4 v5, s[20:23], s63 offen offset:2048 lds
  s_add_u32 s56, s56, 1
  s_cmp_eq_u32 s56, 4
  s_cselect_b32 s56, 0, s56
  s_add_u32 s57, s57, 1
  s_cmp_eq_u32 s57, 4
  s_cselect_b32 s57, 0, s57
  s_cselect_b32 s59, 4, 0
  s_add_u32 s58, s58, s59
  s_add_u32 s60, s60, 30720
  s_cmp_eq_u32 s60, 153600
  s_cselect_b32 s60, 0, s60
  s_add_u32 s66, s58, s56
  s_mul_i32 s63, s66, 589824
  s_add_u32 m0, s60, s79
  s_add_u32 s63, s63, s65
  buffer_load_dwordx4 v3, s[20:23], s63 offen lds
  buffer_load_dwordx4 v4, s[20:23], s63 offen offset:1024 lds
  buffer_load_dwordx4 v5, s[20:23], s63 offen offset:2048 lds
  s_add_u32 s56, s56, 1
  s_cmp_eq_u32 s56, 4
  s_cselect_b32 s56, 0, s56
  s_add_u32 s57, s57, 1
  s_cmp_eq_u32 s57, 4
  s_cselect_b32 s57, 0, s57
  s_cselect_b32 s59, 4, 0
  s_add_u32 s58, s58, s59
  s_add_u32 s60, s60, 30720
  s_cmp_eq_u32 s60, 153600
  s_cselect_b32 s60, 0, s60
  s_add_u32 s66, s58, s56
  s_mul_i32 s63, s66, 589824
  s_add_u32 m0, s60, s79
  s_add_u32 s63, s63, s65
  buffer_load_dwordx4 v3, s[20:23], s63 offen lds
  buffer_load_dwordx4 v4, s[20:23], s63 offen offset:1024 lds
  buffer_load_dwordx4 v5, s[20:23], s63 offen offset:2048 lds
  s_add_u32 s56, s56, 1
  s_cmp_eq_u32 s56, 4
  s_cselect_b32 s56, 0, s56
  s_add_u32 s57, s57, 1
  s_cmp_eq_u32 s57, 4
  s_cselect_b32 s57, 0, s57
  s_cselect_b32 s59, 4, 0
  s_add_u32 s58, s58, s59
  s_add_u32 s60, s60, 30720
  s_cmp_eq_u32 s60, 153600
  s_cselect_b32 s60, 0, s60
  s_add_u32 s66, s58, s56
  s_mul_i32 s63, s66, 589824
  s_add_u32 m0, s60, s79
  s_add_u32 s63, s63, s65
  buffer_load_dwordx4 v3, s[20:23], s63 offen lds
  buffer_load_dwordx4 v4, s[20:23], s63 offen offset:1024 lds
  buffer_load_dwordx4 v5, s[20:23], s63 offen offset:2048 lds
  s_add_u32 s56, s56, 1
  s_cmp_eq_u32 s56, 4
  s_cselect_b32 s56, 0, s56
  s_add_u32 s57, s57, 1
  s_cmp_eq_u32 s57, 4
  s_cselect_b32 s57, 0, s57
  s_cselect_b32 s59, 4, 0
  s_add_u32 s58, s58, s59
  s_add_u32 s60, s60, 30720
  s_cmp_eq_u32 s60, 153600
  s_cselect_b32 s60, 0, s60
  s_cmp_lt_u32 s3, 7
  s_cbranch_scc1 L_g1_nopf
  v_mov_b32 v15, 163824
L_g1_pfb:
  s_cmp_eq_u32 s80, 0
  s_cbranch_scc1 L_g1_pfb_x
  ds_read_b32 v17, v15
  s_mov_b32 s67, 477218589
  v_mul_hi_u32 v13, v12, s67
  v_mul_u32_u24 v14, 9, v13
  v_sub_u32 v14, v12, v14
  v_mul_u32_u24 v13, 9216, v13
  v_lshl_add_u32 v13, v14, 7, v13
  s_waitcnt lgkmcnt(0)
  v_readfirstlane_b32 s67, v17
  s_cmp_ge_u32 s67, 1
  s_cbranch_scc1 L_g1_pfb_x
  buffer_load_dword v16, v13, s[20:23], s81 offen
  v_add_u32 v12, 1536, v12
  s_sub_u32 s80, s80, 1
  s_waitcnt vmcnt(1)
  s_branch L_g1_pfb
L_g1_pfb_x:
L_g1_nopf:
  s_cmp_lg_u32 s3, 4
  s_cbranch_scc1 L_g1gate_g
  s_mov_b32 s83, 27525120
  s_mov_b64 s[84:85], -1
  v_lshlrev_b32 v41, 7, v1
  s_mov_b32 s68, 0x8000
L_g1gate:
  buffer_load_dword v40, v41, s[16:19], s83 offen sc1
  s_waitcnt vmcnt(0)
  v_xor_b32 v40, s54, v40
  v_cmp_ne_u32 vcc, 0, v40
  s_sub_u32 s68, s68, 1
  s_cmp_eq_u32 s68, 0
  s_cbranch_scc1 L_g1gate_x
  s_and_b64 vcc, vcc, s[84:85]
  s_cbranch_scc0 L_g1gate_x
  s_sleep 2
  s_branch L_g1gate
L_g1gate_x:
  v_mov_b32 v40, 163824
  v_mov_b32 v41, 1
  s_mov_b64 exec, 1
  ds_add_u32 v40, v41
  s_mov_b64 exec, -1
L_g1gate_g:
  s_barrier
  s_mov_b32 s56, s78
  s_mov_b32 s57, 0
  s_mov_b32 s58, 0
  s_mov_b32 s60, 0
  s_add_u32 s66, s58, s56
  s_mul_i32 s62, s66, 73728
  s_add_u32 s62, s62, s64
  s_add_u32 m0, s60, s75
  s_add_u32 s67, s62, s74
  buffer_load_dwordx4 v2, s[16:19], s67 offen sc1 lds
  buffer_load_dwordx4 v2, s[16:19], s67 offen offset:1024 sc1 lds
  buffer_load_dwordx4 v2, s[16:19], s67 offen offset:2048 sc1 lds
  buffer_load_dwordx4 v2, s[16:19], s67 offen offset:3072 sc1 lds
  s_add_u32 m0, s60, s77
  s_add_u32 s68, s62, s76
  s_cmp_ge_u32 s70, 2
  s_cbranch_scc1 L_g1x_1
  buffer_load_dwordx4 v2, s[16:19], s68 offen sc1 lds
L_g1x_1:
  s_add_u32 s56, s56, 1
  s_cmp_eq_u32 s56, 4
  s_cselect_b32 s56, 0, s56
  s_add_u32 s57, s57, 1
  s_cmp_eq_u32 s57, 4
  s_cselect_b32 s57, 0, s57
  s_cselect_b32 s59, 4, 0
  s_add_u32 s58, s58, s59
  s_add_u32 s60, s60, 30720
  s_cmp_eq_u32 s60, 153600
  s_cselect_b32 s60, 0, s60
  s_add_u32 s66, s58, s56
  s_mul_i32 s62, s66, 73728
  s_add_u32 s62, s62, s64
  s_add_u32 m0, s60, s75
  s_add_u32 s67, s62, s74
  buffer_load_dwordx4 v2, s[16:19], s67 offen sc1 lds
  buffer_load_dwordx4 v2, s[16:19], s67 offen offset:1024 sc1 lds
  buffer_load_dwordx4 v2, s[16:19], s67 offen offset:2048 sc1 lds
  buffer_load_dwordx4 v2, s[16:19], s67 offen offset:3072 sc1 lds
  s_add_u32 m0, s60, s77
  s_add_u32 s68, s62, s76
  s_cmp_ge_u32 s70, 2
  s_cbranch_scc1 L_g1x_2
  buffer_load_dwordx4 v2, s[16:19], s68 offen sc1 lds
L_g1x_2:
  s_add_u32 s56, s56, 1
  s_cmp_eq_u32 s56, 4
  s_cselect_b32 s56, 0, s56
  s_add_u32 s57, s57, 1
  s_cmp_eq_u32 s57, 4
  s_cselect_b32 s57, 0, s57
  s_cselect_b32 s59, 4, 0
  s_add_u32 s58, s58, s59
  s_add_u32 s60, s60, 30720
  s_cmp_eq_u32 s60, 153600
  s_cselect_b32 s60, 0, s60
  s_add_u32 s66, s58, s56
  s_mul_i32 s62, s66, 73728
  s_add_u32 s62, s62, s64
  s_add_u32 m0, s60, s75
  s_add_u32 s67, s62, s74
  buffer_load_dwordx4 v2, s[16:19], s67 offen sc1 lds
  buffer_load_dwordx4 v2, s[16:19], s67 offen offset:1024 sc1 lds
  buffer_load_dwordx4 v2, s[16:19], s67 offen offset:2048 sc1 lds
  buffer_load_dwordx4 v2, s[16:19], s67 offen offset:3072 sc1 lds
  s_add_u32 m0, s60, s77
  s_add_u32 s68, s62, s76
  s_cmp_ge_u32 s70, 2
  s_cbranch_scc1 L_g1x_3
  buffer_load_dwordx4 v2, s[16:19], s68 offen sc1 lds
L_g1x_3:
  s_add_u32 s56, s56, 1
  s_cmp_eq_u32 s56, 4
  s_cselect_b32 s56, 0, s56
  s_add_u32 s57, s57, 1
  s_cmp_eq_u32 s57, 4
  s_cselect_b32 s57, 0, s57
  s_cselect_b32 s59, 4, 0
  s_add_u32 s58, s58, s59
  s_add_u32 s60, s60, 30720
  s_cmp_eq_u32 s60, 153600
  s_cselect_b32 s60, 0, s60
  s_add_u32 s66, s58, s56
  s_mul_i32 s62, s66, 73728
  s_add_u32 s62, s62, s64
  s_add_u32 m0, s60, s75
  s_add_u32 s67, s62, s74
  buffer_load_dwordx4 v2, s[16:19], s67 offen sc1 lds
  buffer_load_dwordx4 v2, s[16:19], s67 offen offset:1024 sc1 lds
  buffer_load_dwordx4 v2, s[16:19], s67 offen offset:2048 sc1 lds
  buffer_load_dwordx4 v2, s[16:19], s67 offen offset:3072 sc1 lds
  s_add_u32 m0, s60, s77
  s_add_u32 s68, s62, s76
  s_cmp_ge_u32 s70, 2
  s_cbranch_scc1 L_g1x_4
  buffer_load_dwordx4 v2, s[16:19], s68 offen sc1 lds
L_g1x_4:
  s_add_u32 s56, s56, 1
  s_cmp_eq_u32 s56, 4
  s_cselect_b32 s56, 0, s56
  s_add_u32 s57, s57, 1
  s_cmp_eq_u32 s57, 4
  s_cselect_b32 s57, 0, s57
  s_cselect_b32 s59, 4, 0
  s_add_u32 s58, s58, s59
  s_add_u32 s60, s60, 30720
  s_cmp_eq_u32 s60, 153600
  s_cselect_b32 s60, 0, s60
  s_add_u32 s66, s58, s56
  s_mul_i32 s62, s66, 73728
  s_add_u32 s62, s62, s64
  s_add_u32 m0, s60, s75
  s_add_u32 s67, s62, s74
  buffer_load_dwordx4 v2, s[16:19], s67 offen sc1 lds
  buffer_load_dwordx4 v2, s[16:19], s67 offen offset:1024 sc1 lds
  buffer_load_dwordx4 v2, s[16:19], s67 offen offset:2048 sc1 lds
  buffer_load_dwordx4 v2, s[16:19], s67 offen offset:3072 sc1 lds
  s_add_u32 m0, s60, s77
  s_add_u32 s68, s62, s76
  s_cmp_ge_u32 s70, 2
  s_cbranch_scc1 L_g1x_5
  buffer_load_dwordx4 v2, s[16:19], s68 offen sc1 lds
L_g1x_5:
  s_add_u32 s56, s56, 1
  s_cmp_eq_u32 s56, 4
  s_cselect_b32 s56, 0, s56
  s_add_u32 s57, s57, 1
  s_cmp_eq_u32 s57, 4
  s_cselect_b32 s57, 0, s57
  s_cselect_b32 s59, 4, 0
  s_add_u32 s58, s58, s59
  s_add_u32 s60, s60, 30720
  s_cmp_eq_u32 s60, 153600
  s_cselect_b32 s60, 0, s60
  s_waitcnt vmcnt(16)
  s_barrier
  s_cmp_lg_u32 s3, 5
  s_cbranch_scc1 L_g1_chk_s
  s_mov_b32 s80, 27525120
  s_mov_b32 s81, 27533312
  s_mov_b32 s82, 27541504
  s_mov_b32 s83, 27549696
  s_mov_b64 s[84:85], -1
  v_lshlrev_b32 v252, 7, v1
  s_mov_b32 s68, 0x8000
L_g1_chk:
  buffer_load_dword v248, v252, s[16:19], s80 offen sc1
  buffer_load_dword v249, v252, s[16:19], s81 offen sc1
  buffer_load_dword v250, v252, s[16:19], s82 offen sc1
  buffer_load_dword v251, v252, s[16:19], s83 offen sc1
  s_waitcnt vmcnt(0)
  v_xor_b32 v248, s54, v248
  v_xor_b32 v249, s54, v249
  v_xor_b32 v250, s54, v250
  v_xor_b32 v251, s54, v251
  v_or_b32 v248, v248, v249
  v_or_b32 v248, v248, v250
  v_or_b32 v248, v248, v251
  v_cmp_ne_u32 vcc, 0, v248
  s_sub_u32 s68, s68, 1
  s_cmp_eq_u32 s68, 0
  s_cbranch_scc1 L_g1_chk_x
  s_and_b64 vcc, vcc, s[84:85]
  s_cbranch_scc0 L_g1_chk_x
  s_sleep 4
  s_branch L_g1_chk
L_g1_chk_x:
L_g1_chk_s:
  s_waitcnt vmcnt(12)
  s_barrier
  s_add_u32 s66, s58, s56
  s_mul_i32 s63, s66, 589824
  s_add_u32 m0, s60, s79
  s_add_u32 s63, s63, s65
  buffer_load_dwordx4 v3, s[20:23], s63 offen lds
  buffer_load_dwordx4 v4, s[20:23], s63 offen offset:1024 lds
  buffer_load_dwordx4 v5, s[20:23], s63 offen offset:2048 lds
  s_add_u32 s66, s58, s56
  s_mul_i32 s62, s66, 73728
  s_add_u32 s62, s62, s64
  s_add_u32 m0, s60, s75
  s_add_u32 s67, s62, s74
  buffer_load_dwordx4 v2, s[16:19], s67 offen sc1 lds
  buffer_load_dwordx4 v2, s[16:19], s67 offen offset:1024 sc1 lds
  buffer_load_dwordx4 v2, s[16:19], s67 offen offset:2048 sc1 lds
  buffer_load_dwordx4 v2, s[16:19], s67 offen offset:3072 sc1 lds
  s_add_u32 m0, s60, s77
  s_add_u32 s68, s62, s76
  s_cmp_ge_u32 s70, 2
  s_cbranch_scc1 L_g1x_6
  buffer_load_dwordx4 v2, s[16:19], s68 offen sc1 lds
L_g1x_6:
  s_add_u32 s56, s56, 1
  s_cmp_eq_u32 s56, 4
  s_cselect_b32 s56, 0, s56
  s_add_u32 s57, s57, 1
  s_cmp_eq_u32 s57, 4
  s_cselect_b32 s57, 0, s57
  s_cselect_b32 s59, 4, 0
  s_add_u32 s58, s58, s59
  s_add_u32 s60, s60, 30720
  s_cmp_eq_u32 s60, 153600
  s_cselect_b32 s60, 0, s60
  s_waitcnt vmcnt(15)
  s_barrier
  s_add_u32 s66, s58, s56
  s_mul_i32 s63, s66, 589824
  s_add_u32 m0, s60, s79
  s_add_u32 s63, s63, s65
  buffer_load_dwordx4 v3, s[20:23], s63 offen lds
  buffer_load_dwordx4 v4, s[20:23], s63 offen offset:1024 lds
  buffer_load_dwordx4 v5, s[20:23], s63 offen offset:2048 lds
  s_add_u32 s66, s58, s56
  s_mul_i32 s62, s66, 73728
  s_add_u32 s62, s62, s64
  s_add_u32 m0, s60, s75
  s_add_u32 s67, s62, s74
  buffer_load_dwordx4 v2, s[16:19], s67 offen sc1 lds
  buffer_load_dwordx4 v2, s[16:19], s67 offen offset:1024 sc1 lds
  buffer_load_dwordx4 v2, s[16:19], s67 offen offset:2048 sc1 lds
  buffer_load_dwordx4 v2, s[16:19], s67 offen offset:3072 sc1 lds
  s_add_u32 m0, s60, s77
  s_add_u32 s68, s62, s76
  s_cmp_ge_u32 s70, 2
  s_cbranch_scc1 L_g1x_7
  buffer_load_dwordx4 v2, s[16:19], s68 offen sc1 lds
L_g1x_7:
  s_add_u32 s56, s56, 1
  s_cmp_eq_u32 s56, 4
  s_cselect_b32 s56, 0, s56
  s_add_u32 s57, s57, 1
  s_cmp_eq_u32 s57, 4
  s_cselect_b32 s57, 0, s57
  s_cselect_b32 s59, 4, 0
  s_add_u32 s58, s58, s59
  s_add_u32 s60, s60, 30720
  s_cmp_eq_u32 s60, 153600
  s_cselect_b32 s60, 0, s60
  s_waitcnt vmcnt(18)
  s_barrier
  s_add_u32 s66, s58, s56
  s_mul_i32 s63, s66, 589824
  s_add_u32 m0, s60, s79
  s_add_u32 s63, s63, s65
  buffer_load_dwordx4 v3, s[20:23], s63 offen lds
  buffer_load_dwordx4 v4, s[20:23], s63 offen offset:1024 lds
  buffer_load_dwordx4 v5, s[20:23], s63 offen offset:2048 lds
  s_add_u32 s66, s58, s56
  s_mul_i32 s62, s66, 73728
  s_add_u32 s62, s62, s64
  s_add_u32 m0, s60, s75
  s_add_u32 s67, s62, s74
  buffer_load_dwordx4 v2, s[16:19], s67 offen sc1 lds
  buffer_load_dwordx4 v2, s[16:19], s67 offen offset:1024 sc1 lds
  buffer_load_dwordx4 v2, s[16:19], s67 offen offset:2048 sc1 lds
  buffer_load_dwordx4 v2, s[16:19], s67 offen offset:3072 sc1 lds
  s_add_u32 m0, s60, s77
  s_add_u32 s68, s62, s76
  s_cmp_ge_u32 s70, 2
  s_cbranch_scc1 L_g1x_8
  buffer_load_dwordx4 v2, s[16:19], s68 offen sc1 lds
L_g1x_8:
  s_add_u32 s56, s56, 1
  s_cmp_eq_u32 s56, 4
  s_cselect_b32 s56, 0, s56
  s_add_u32 s57, s57, 1
  s_cmp_eq_u32 s57, 4
  s_cselect_b32 s57, 0, s57
  s_cselect_b32 s59, 4, 0
  s_add_u32 s58, s58, s59
  s_add_u32 s60, s60, 30720
  s_cmp_eq_u32 s60, 153600
  s_cselect_b32 s60, 0, s60
  s_waitcnt vmcnt(21)
  s_barrier
  s_add_u32 s66, s58, s56
  s_mul_i32 s63, s66, 589824
  s_add_u32 m0, s60, s79
  s_add_u32 s63, s63, s65
  buffer_load_dwordx4 v3, s[20:23], s63 offen lds
  buffer_load_dwordx4 v4, s[20:23], s63 offen offset:1024 lds
  buffer_load_dwordx4 v5, s[20:23], s63 offen offset:2048 lds
  s_add_u32 s66, s58, s56
  s_mul_i32 s62, s66, 73728
  s_add_u32 s62, s62, s64
  s_add_u32 m0, s60, s75
  s_add_u32 s67, s62, s74
  buffer_load_dwordx4 v2, s[16:19], s67 offen sc1 lds
  buffer_load_dwordx4 v2, s[16:19], s67 offen offset:1024 sc1 lds
  buffer_load_dwordx4 v2, s[16:19], s67 offen offset:2048 sc1 lds
  buffer_load_dwordx4 v2, s[16:19], s67 offen offset:3072 sc1 lds
  s_add_u32 m0, s60, s77
  s_add_u32 s68, s62, s76
  s_cmp_ge_u32 s70, 2
  s_cbranch_scc1 L_g1x_9
  buffer_load_dwordx4 v2, s[16:19], s68 offen sc1 lds
L_g1x_9:
  s_add_u32 s56, s56, 1
  s_cmp_eq_u32 s56, 4
  s_cselect_b32 s56, 0, s56
  s_add_u32 s57, s57, 1
  s_cmp_eq_u32 s57, 4
  s_cselect_b32 s57, 0, s57
  s_cselect_b32 s59, 4, 0
  s_add_u32 s58, s58, s59
  s_add_u32 s60, s60, 30720
  s_cmp_eq_u32 s60, 153600
  s_cselect_b32 s60, 0, s60
  s_mov_b32 s61, 23
L_g1_ld:
  s_waitcnt vmcnt(21)
  s_barrier
  s_add_u32 s66, s58, s56
  s_mul_i32 s63, s66, 589824
  s_add_u32 m0, s60, s79
  s_add_u32 s63, s63, s65
  buffer_load_dwordx4 v3, s[20:23], s63 offen lds
  buffer_load_dwordx4 v4, s[20:23], s63 offen offset:1024 lds
  buffer_load_dwordx4 v5, s[20:23], s63 offen offset:2048 lds
  s_add_u32 s66, s58, s56
  s_mul_i32 s62, s66, 73728
  s_add_u32 s62, s62, s64
  s_add_u32 m0, s60, s75
  s_add_u32 s67, s62, s74
  buffer_load_dwordx4 v2, s[16:19], s67 offen sc1 lds
  buffer_load_dwordx4 v2, s[16:19], s67 offen offset:1024 sc1 lds
  buffer_load_dwordx4 v2, s[16:19], s67 offen offset:2048 sc1 lds
  buffer_load_dwordx4 v2, s[16:19], s67 offen offset:3072 sc1 lds
  s_add_u32 m0, s60, s77
  s_add_u32 s68, s62, s76
  s_cmp_ge_u32 s70, 2
  s_cbranch_scc1 L_g1x_10
  buffer_load_dwordx4 v2, s[16:19], s68 offen sc1 lds
L_g1x_10:
  s_add_u32 s56, s56, 1
  s_cmp_eq_u32 s56, 4
  s_cselect_b32 s56, 0, s56
  s_add_u32 s57, s57, 1
  s_cmp_eq_u32 s57, 4
  s_cselect_b32 s57, 0, s57
  s_cselect_b32 s59, 4, 0
  s_add_u32 s58, s58, s59
  s_add_u32 s60, s60, 30720
  s_cmp_eq_u32 s60, 153600
  s_cselect_b32 s60, 0, s60
  s_sub_u32 s61, s61, 1
  s_cmp_lg_u32 s61, 0
  s_cbranch_scc1 L_g1_ld
  s_waitcnt vmcnt(21)
  s_barrier
  s_waitcnt vmcnt(14)
  s_barrier
  s_waitcnt vmcnt(7)
  s_barrier
  s_waitcnt vmcnt(0)
  s_barrier
  s_cmp_lt_u32 s3, 7
  s_cbranch_scc1 L_g1_nopf2
  s_mov_b32 s82, s53
  s_and_b32 s81, s52, 3
  s_mul_i32 s81, s81, 4718592
  s_lshr_b32 s67, s52, 2
  s_lshl_b32 s67, s67, 11
  s_add_u32 s81, s81, s67
  s_lshl_b32 s67, s82, 6
  s_add_u32 s67, s67, 0
  v_add_u32 v12, s67, v1
  s_mov_b32 s67, 268435456
  s_mov_b32 s68, 2
  v_mov_b32 v15, 2147479552
L_g1_pf2:
  v_mul_hi_u32 v13, v12, s67
  v_mul_u32_u24 v14, 16, v13
  v_sub_u32 v14, v12, v14
  v_mul_u32_u24 v13, 4096, v13
  v_lshl_add_u32 v13, v14, 7, v13
  v_add_u32 v12, 1536, v12
  s_waitcnt vmcnt(2)
  buffer_load_dword v16, v13, s[24:27], s81 offen
  s_sub_u32 s68, s68, 1
  s_cmp_lg_u32 s68, 0
  s_cbranch_scc1 L_g1_pf2
  s_mov_b32 s80, 10
L_g1_nopf2:
  s_barrier
  v_lshlrev_b32 v210, 4, v1
  s_lshl_b32 s67, s3, 12
  v_add_u32 v208, s67, v210
  v_add_u32 v209, 65536, v208
  s_mov_b32 s82, 0xbdd2d3e8
  s_mov_b32 s83, 0xbdd2d3e8
  v_mov_b32 v212, 0xc0135761
  v_mov_b32 v213, 0xc0135761
  s_mul_i32 s84, s73, 110592
  s_mul_i32 s67, s71, 9216
  s_add_u32 s84, s84, s67
  s_add_u32 s84, s84, 4718592
  s_waitcnt lgkmcnt(0)
  s_barrier
  ds_read_b128 v[128:131], v208 offset:0
  ds_read_b128 v[132:135], v208 offset:1024
  ds_read_b128 v[136:139], v208 offset:2048
  ds_read_b128 v[140:143], v208 offset:3072
  ds_read_b128 v[144:147], v208 offset:32768
  ds_read_b128 v[148:151], v208 offset:33792
  ds_read_b128 v[152:155], v208 offset:34816
  ds_read_b128 v[156:159], v208 offset:35840
  ds_read_b128 v[160:163], v209 offset:0
  ds_read_b128 v[164:167], v209 offset:1024
  ds_read_b128 v[168:171], v209 offset:2048
  ds_read_b128 v[172:175], v209 offset:3072
  ds_read_b128 v[176:179], v209 offset:32768
  ds_read_b128 v[180:183], v209 offset:33792
  ds_read_b128 v[184:187], v209 offset:34816
  ds_read_b128 v[188:191], v209 offset:35840
  s_add_u32 s85, s3, 0
  s_mul_hi_u32 s67, s85, 1431655766
  s_mul_i32 s68, s67, 3
  s_sub_u32 s85, s85, s68
  s_mul_i32 s85, s85, 36864
  s_lshl_b32 s67, s67, 10
  s_add_u32 s85, s85, s67
  s_add_u32 s85, s85, s84
  s_waitcnt lgkmcnt(12)
  v_pk_add_f32 v[128:129], v[128:129], v[132:133]
  v_pk_add_f32 v[130:131], v[130:131], v[134:135]
  v_pk_add_f32 v[132:133], v[136:137], v[140:141]
  v_pk_add_f32 v[134:135], v[138:139], v[142:143]
  v_pk_mul_f32 v[192:193], v[128:129], v[128:129]
  v_pk_mul_f32 v[194:195], v[130:131], v[130:131]
  v_pk_mul_f32 v[196:197], v[132:133], v[132:133]
  v_pk_mul_f32 v[198:199], v[134:135], v[134:135]
  v_pk_fma_f32 v[192:193], v[192:193], s[82:83], v[212:213]
  v_pk_fma_f32 v[194:195], v[194:195], s[82:83], v[212:213]
  v_pk_fma_f32 v[196:197], v[196:197], s[82:83], v[212:213]
  v_pk_fma_f32 v[198:199], v[198:199], s[82:83], v[212:213]
  v_pk_mul_f32 v[192:193], v[192:193], v[128:129]
  v_pk_mul_f32 v[194:195], v[194:195], v[130:131]
  v_pk_mul_f32 v[196:197], v[196:197], v[132:133]
  v_pk_mul_f32 v[198:199], v[198:199], v[134:135]
  v_exp_f32 v192, v192
  v_exp_f32 v193, v193
  v_exp_f32 v194, v194
  v_exp_f32 v195, v195
  v_exp_f32 v196, v196
  v_exp_f32 v197, v197
  v_exp_f32 v198, v198
  v_exp_f32 v199, v199
  v_pk_add_f32 v[192:193], v[192:193], 1.0 op_sel_hi:[1,0]
  v_pk_add_f32 v[194:195], v[194:195], 1.0 op_sel_hi:[1,0]
  v_pk_add_f32 v[196:197], v[196:197], 1.0 op_sel_hi:[1,0]
  v_pk_add_f32 v[198:199], v[198:199], 1.0 op_sel_hi:[1,0]
  v_rcp_f32 v192, v192
  v_rcp_f32 v193, v193
  v_rcp_f32 v194, v194
  v_rcp_f32 v195, v195
  v_rcp_f32 v196, v196
  v_rcp_f32 v197, v197
  v_rcp_f32 v198, v198
  v_rcp_f32 v199, v199
  v_pk_mul_f32 v[192:193], v[192:193], v[128:129]
  v_pk_mul_f32 v[194:195], v[194:195], v[130:131]
  v_pk_mul_f32 v[196:197], v[196:197], v[132:133]
  v_pk_mul_f32 v[198:199], v[198:199], v[134:135]
  v_cvt_pk_bf16_f32 v136, v192, v193
  v_cvt_pk_bf16_f32 v137, v194, v195
  v_cvt_pk_bf16_f32 v138, v196, v197
  v_cvt_pk_bf16_f32 v139, v198, v199
  buffer_store_dwordx4 v[136:139], v210, s[16:19], s85 offen sc1
  s_add_u32 s85, s3, 8
  s_mul_hi_u32 s67, s85, 1431655766
  s_mul_i32 s68, s67, 3
  s_sub_u32 s85, s85, s68
  s_mul_i32 s85, s85, 36864
  s_lshl_b32 s67, s67, 10
  s_add_u32 s85, s85, s67
  s_add_u32 s85, s85, s84
  s_waitcnt lgkmcnt(8)
  v_pk_add_f32 v[144:145], v[144:145], v[148:149]
  v_pk_add_f32 v[146:147], v[146:147], v[150:151]
  v_pk_add_f32 v[148:149], v[152:153], v[156:157]
  v_pk_add_f32 v[150:151], v[154:155], v[158:159]
  v_pk_mul_f32 v[200:201], v[144:145], v[144:145]
  v_pk_mul_f32 v[202:203], v[146:147], v[146:147]
  v_pk_mul_f32 v[204:205], v[148:149], v[148:149]
  v_pk_mul_f32 v[206:207], v[150:151], v[150:151]
  v_pk_fma_f32 v[200:201], v[200:201], s[82:83], v[212:213]
  v_pk_fma_f32 v[202:203], v[202:203], s[82:83], v[212:213]
  v_pk_fma_f32 v[204:205], v[204:205], s[82:83], v[212:213]
  v_pk_fma_f32 v[206:207], v[206:207], s[82:83], v[212:213]
  v_pk_mul_f32 v[200:201], v[200:201], v[144:145]
  v_pk_mul_f32 v[202:203], v[202:203], v[146:147]
  v_pk_mul_f32 v[204:205], v[204:205], v[148:149]
  v_pk_mul_f32 v[206:207], v[206:207], v[150:151]
  v_exp_f32 v200, v200
  v_exp_f32 v201, v201
  v_exp_f32 v202, v202
  v_exp_f32 v203, v203
  v_exp_f32 v204, v204
  v_exp_f32 v205, v205
  v_exp_f32 v206, v206
  v_exp_f32 v207, v207
  v_pk_add_f32 v[200:201], v[200:201], 1.0 op_sel_hi:[1,0]
  v_pk_add_f32 v[202:203], v[202:203], 1.0 op_sel_hi:[1,0]
  v_pk_add_f32 v[204:205], v[204:205], 1.0 op_sel_hi:[1,0]
  v_pk_add_f32 v[206:207], v[206:207], 1.0 op_sel_hi:[1,0]
  v_rcp_f32 v200, v200
  v_rcp_f32 v201, v201
  v_rcp_f32 v202, v202
  v_rcp_f32 v203, v203
  v_rcp_f32 v204, v204
  v_rcp_f32 v205, v205
  v_rcp_f32 v206, v206
  v_rcp_f32 v207, v207
  v_pk_mul_f32 v[200:201], v[200:201], v[144:145]
  v_pk_mul_f32 v[202:203], v[202:203], v[146:147]
  v_pk_mul_f32 v[204:205], v[204:205], v[148:149]
  v_pk_mul_f32 v[206:207], v[206:207], v[150:151]
  v_cvt_pk_bf16_f32 v152, v200, v201
  v_cvt_pk_bf16_f32 v153, v202, v203
  v_cvt_pk_bf16_f32 v154, v204, v205
  v_cvt_pk_bf16_f32 v155, v206, v207
  buffer_store_dwordx4 v[152:155], v210, s[16:19], s85 offen sc1
  s_add_u32 s85, s3, 16
  s_mul_hi_u32 s67, s85, 1431655766
  s_mul_i32 s68, s67, 3
  s_sub_u32 s85, s85, s68
  s_mul_i32 s85, s85, 36864
  s_lshl_b32 s67, s67, 10
  s_add_u32 s85, s85, s67
  s_add_u32 s85, s85, s84
  s_waitcnt lgkmcnt(4)
  v_pk_add_f32 v[160:161], v[160:161], v[164:165]
  v_pk_add_f32 v[162:163], v[162:163], v[166:167]
  v_pk_add_f32 v[164:165], v[168:169], v[172:173]
  v_pk_add_f32 v[166:167], v[170:171], v[174:175]
  v_pk_mul_f32 v[192:193], v[160:161], v[160:161]
  v_pk_mul_f32 v[194:195], v[162:163], v[162:163]
  v_pk_mul_f32 v[196:197], v[164:165], v[164:165]
  v_pk_mul_f32 v[198:199], v[166:167], v[166:167]
  v_pk_fma_f32 v[192:193], v[192:193], s[82:83], v[212:213]
  v_pk_fma_f32 v[194:195], v[194:195], s[82:83], v[212:213]
  v_pk_fma_f32 v[196:197], v[196:197], s[82:83], v[212:213]
  v_pk_fma_f32 v[198:199], v[198:199], s[82:83], v[212:213]
  v_pk_mul_f32 v[192:193], v[192:193], v[160:161]
  v_pk_mul_f32 v[194:195], v[194:195], v[162:163]
  v_pk_mul_f32 v[196:197], v[196:197], v[164:165]
  v_pk_mul_f32 v[198:199], v[198:199], v[166:167]
  v_exp_f32 v192, v192
  v_exp_f32 v193, v193
  v_exp_f32 v194, v194
  v_exp_f32 v195, v195
  v_exp_f32 v196, v196
  v_exp_f32 v197, v197
  v_exp_f32 v198, v198
  v_exp_f32 v199, v199
  v_pk_add_f32 v[192:193], v[192:193], 1.0 op_sel_hi:[1,0]
  v_pk_add_f32 v[194:195], v[194:195], 1.0 op_sel_hi:[1,0]
  v_pk_add_f32 v[196:197], v[196:197], 1.0 op_sel_hi:[1,0]
  v_pk_add_f32 v[198:199], v[198:199], 1.0 op_sel_hi:[1,0]
  v_rcp_f32 v192, v192
  v_rcp_f32 v193, v193
  v_rcp_f32 v194, v194
  v_rcp_f32 v195, v195
  v_rcp_f32 v196, v196
  v_rcp_f32 v197, v197
  v_rcp_f32 v198, v198
  v_rcp_f32 v199, v199
  v_pk_mul_f32 v[192:193], v[192:193], v[160:161]
  v_pk_mul_f32 v[194:195], v[194:195], v[162:163]
  v_pk_mul_f32 v[196:197], v[196:197], v[164:165]
  v_pk_mul_f32 v[198:199], v[198:199], v[166:167]
  v_cvt_pk_bf16_f32 v168, v192, v193
  v_cvt_pk_bf16_f32 v169, v194, v195
  v_cvt_pk_bf16_f32 v170, v196, v197
  v_cvt_pk_bf16_f32 v171, v198, v199
  buffer_store_dwordx4 v[168:171], v210, s[16:19], s85 offen sc1
  s_cmp_ge_u32 s3, 3
  s_cbranch_scc1 L_g1fl
  s_add_u32 s85, s3, 24
  s_mul_hi_u32 s67, s85, 1431655766
  s_mul_i32 s68, s67, 3
  s_sub_u32 s85, s85, s68
  s_mul_i32 s85, s85, 36864
  s_lshl_b32 s67, s67, 10
  s_add_u32 s85, s85, s67
  s_add_u32 s85, s85, s84
  s_waitcnt lgkmcnt(0)
  v_pk_add_f32 v[176:177], v[176:177], v[180:181]
  v_pk_add_f32 v[178:179], v[178:179], v[182:183]
  v_pk_add_f32 v[180:181], v[184:185], v[188:189]
  v_pk_add_f32 v[182:183], v[186:187], v[190:191]
  v_pk_mul_f32 v[200:201], v[176:177], v[176:177]
  v_pk_mul_f32 v[202:203], v[178:179], v[178:179]
  v_pk_mul_f32 v[204:205], v[180:181], v[180:181]
  v_pk_mul_f32 v[206:207], v[182:183], v[182:183]
  v_pk_fma_f32 v[200:201], v[200:201], s[82:83], v[212:213]
  v_pk_fma_f32 v[202:203], v[202:203], s[82:83], v[212:213]
  v_pk_fma_f32 v[204:205], v[204:205], s[82:83], v[212:213]
  v_pk_fma_f32 v[206:207], v[206:207], s[82:83], v[212:213]
  v_pk_mul_f32 v[200:201], v[200:201], v[176:177]
  v_pk_mul_f32 v[202:203], v[202:203], v[178:179]
  v_pk_mul_f32 v[204:205], v[204:205], v[180:181]
  v_pk_mul_f32 v[206:207], v[206:207], v[182:183]
  v_exp_f32 v200, v200
  v_exp_f32 v201, v201
  v_exp_f32 v202, v202
  v_exp_f32 v203, v203
  v_exp_f32 v204, v204
  v_exp_f32 v205, v205
  v_exp_f32 v206, v206
  v_exp_f32 v207, v207
  v_pk_add_f32 v[200:201], v[200:201], 1.0 op_sel_hi:[1,0]
  v_pk_add_f32 v[202:203], v[202:203], 1.0 op_sel_hi:[1,0]
  v_pk_add_f32 v[204:205], v[204:205], 1.0 op_sel_hi:[1,0]
  v_pk_add_f32 v[206:207], v[206:207], 1.0 op_sel_hi:[1,0]
  v_rcp_f32 v200, v200
  v_rcp_f32 v201, v201
  v_rcp_f32 v202, v202
  v_rcp_f32 v203, v203
  v_rcp_f32 v204, v204
  v_rcp_f32 v205, v205
  v_rcp_f32 v206, v206
  v_rcp_f32 v207, v207
  v_pk_mul_f32 v[200:201], v[200:201], v[176:177]
  v_pk_mul_f32 v[202:203], v[202:203], v[178:179]
  v_pk_mul_f32 v[204:205], v[204:205], v[180:181]
  v_pk_mul_f32 v[206:207], v[206:207], v[182:183]
  v_cvt_pk_bf16_f32 v184, v200, v201
  v_cvt_pk_bf16_f32 v185, v202, v203
  v_cvt_pk_bf16_f32 v186, v204, v205
  v_cvt_pk_bf16_f32 v187, v206, v207
  buffer_store_dwordx4 v[184:187], v210, s[16:19], s85 offen sc1
L_g1fl:
  s_waitcnt lgkmcnt(0)
  s_barrier
  s_waitcnt vmcnt(0)
  v_mov_b32 v4, 163812
  v_mov_b32 v5, 1
  s_mov_b64 exec, 1
  ds_add_rtn_u32 v5, v4, v5
  s_lshl_b32 s67, s52, 5
  s_add_u32 s67, s67, s53
  s_lshl_b32 s67, s67, 7
  s_add_u32 s67, s67, 27557888
  s_waitcnt lgkmcnt(0)
  v_readfirstlane_b32 s68, v5
  s_mov_b64 exec, -1
  s_cmp_lg_u32 s68, 7
  s_cbranch_scc1 L_pub1gl
  v_mov_b32 v4, s54
  v_lshlrev_b32 v5, 2, v1
  s_mov_b64 exec, 1
  buffer_store_dword v4, v5, s[16:19], s67 offen sc1
  s_mov_b64 exec, -1
L_pub1gl:
  s_and_b32 s73, s52, 3
  s_lshr_b32 s71, s52, 2
  s_lshl_b32 s71, s71, 3
  s_and_b32 s67, s53, 7
  s_add_u32 s71, s71, s67
  s_lshr_b32 s72, s53, 3
  v_lshlrev_b32 v2, 4, v1
  s_lshl_b32 s67, s70, 7
  v_add_u32 v7, s67, v1
  v_add_u32 v8, 0, v7
  v_lshrrev_b32 v9, 4, v8
  v_and_b32 v10, 15, v8
  v_bfe_u32 v8, v9, 0, 3
  v_lshlrev_b32 v8, 1, v8
  v_xor_b32 v10, v10, v8
  v_mul_u32_u24 v3, 4096, v9
  v_lshl_add_u32 v3, v10, 4, v3
  v_add_u32 v8, 64, v7
  v_lshrrev_b32 v9, 4, v8
  v_and_b32 v10, 15, v8
  v_bfe_u32 v8, v9, 0, 3
  v_lshlrev_b32 v8, 1, v8
  v_xor_b32 v10, v10, v8
  v_mul_u32_u24 v4, 4096, v9
  v_lshl_add_u32 v4, v10, 4, v4
  v_subrev_u32 v4, 1024, v4
  s_mul_i32 s65, s73, 4718592
  s_lshl_b32 s67, s71, 8
  s_add_u32 s65, s65, s67
  s_lshl_b32 s75, s70, 11
  s_add_u32 s75, s75, 12288
  s_and_b32 s67, s53, 7
  s_mul_i32 s67, s67, 3
  s_lshl_b32 s68, s72, 3
  s_add_u32 s67, s67, s68
  s_cmp_ge_u32 s67, 24
  s_cselect_b32 s68, 24, 0
  s_sub_u32 s67, s67, s68
  s_mul_i32 s67, s67, 12
  s_mul_hi_u32 s78, s67, 178956971
  s_mov_b32 s56, s78
  s_mov_b32 s57, 0
  s_mov_b32 s58, 0
  s_mov_b32 s60, 0
  s_mul_i32 s74, s70, 3072
  s_mul_i32 s64, s73, 1327104
  s_mul_i32 s67, s72, 12288
  s_add_u32 s64, s64, s67
  s_add_u32 s64, s64, s74
  s_add_u32 s64, s64, 4718592
  s_mul_i32 s67, s70, 192
  v_add_u32 v7, s67, v1
  v_add_u32 v8, 0, v7
  s_mov_b32 s67, 178956971
  v_mul_hi_u32 v9, v8, s67
  v_mul_u32_u24 v10, 24, v9
  v_sub_u32 v10, v8, v10
  v_bfe_u32 v8, v9, 1, 1
  v_lshlrev_b32 v8, 2, v8
  v_xor_b32 v10, v10, v8
  v_mul_u32_u24 v24, 1152, v9
  v_lshl_add_u32 v24, v10, 4, v24
  v_add_u32 v8, 64, v7
  s_mov_b32 s67, 178956971
  v_mul_hi_u32 v9, v8, s67
  v_mul_u32_u24 v10, 24, v9
  v_sub_u32 v10, v8, v10
  v_bfe_u32 v8, v9, 1, 1
  v_lshlrev_b32 v8, 2, v8
  v_xor_b32 v10, v10, v8
  v_mul_u32_u24 v25, 1152, v9
  v_lshl_add_u32 v25, v10, 4, v25
  v_subrev_u32 v25, 1024, v25
  v_add_u32 v8, 128, v7
  s_mov_b32 s67, 178956971
  v_mul_hi_u32 v9, v8, s67
  v_mul_u32_u24 v10, 24, v9
  v_sub_u32 v10, v8, v10
  v_bfe_u32 v8, v9, 1, 1
  v_lshlrev_b32 v8, 2, v8
  v_xor_b32 v10, v10, v8
  v_mul_u32_u24 v26, 1152, v9
  v_lshl_add_u32 v26, v10, 4, v26
  v_subrev_u32 v26, 2048, v26
  s_add_u32 s66, s58, s56
  s_lshl_b32 s63, s66, 17
  s_add_u32 m0, s60, s75
  s_add_u32 s63, s63, s65
  buffer_load_dwordx4 v3, s[24:27], s63 offen lds
  buffer_load_dwordx4 v4, s[24:27], s63 offen offset:1024 lds
  s_add_u32 s56, s56, 1
  s_cmp_eq_u32 s56, 12
  s_cselect_b32 s56, 0, s56
  s_add_u32 s57, s57, 1
  s_cmp_eq_u32 s57, 12
  s_cselect_b32 s57, 0, s57
  s_cselect_b32 s59, 12, 0
  s_add_u32 s58, s58, s59
  s_add_u32 s60, s60, 20480
  s_cmp_eq_u32 s60, 143360
  s_cselect_b32 s60, 0, s60
  s_add_u32 s66, s58, s56
  s_lshl_b32 s63, s66, 17
  s_add_u32 m0, s60, s75
  s_add_u32 s63, s63, s65
  buffer_load_dwordx4 v3, s[24:27], s63 offen lds
  buffer_load_dwordx4 v4, s[24:27], s63 offen offset:1024 lds
  s_add_u32 s56, s56, 1
  s_cmp_eq_u32 s56, 12
  s_cselect_b32 s56, 0, s56
  s_add_u32 s57, s57, 1
  s_cmp_eq_u32 s57, 12
  s_cselect_b32 s57, 0, s57
  s_cselect_b32 s59, 12, 0
  s_add_u32 s58, s58, s59
  s_add_u32 s60, s60, 20480
  s_cmp_eq_u32 s60, 143360
  s_cselect_b32 s60, 0, s60
  s_add_u32 s66, s58, s56
  s_lshl_b32 s63, s66, 17
  s_add_u32 m0, s60, s75
  s_add_u32 s63, s63, s65
  buffer_load_dwordx4 v3, s[24:27], s63 offen lds
  buffer_load_dwordx4 v4, s[24:27], s63 offen offset:1024 lds
  s_add_u32 s56, s56, 1
  s_cmp_eq_u32 s56, 12
  s_cselect_b32 s56, 0, s56
  s_add_u32 s57, s57, 1
  s_cmp_eq_u32 s57, 12
  s_cselect_b32 s57, 0, s57
  s_cselect_b32 s59, 12, 0
  s_add_u32 s58, s58, s59
  s_add_u32 s60, s60, 20480
  s_cmp_eq_u32 s60, 143360
  s_cselect_b32 s60, 0, s60
  s_add_u32 s66, s58, s56
  s_lshl_b32 s63, s66, 17
  s_add_u32 m0, s60, s75
  s_add_u32 s63, s63, s65
  buffer_load_dwordx4 v3, s[24:27], s63 offen lds
  buffer_load_dwordx4 v4, s[24:27], s63 offen offset:1024 lds
  s_add_u32 s56, s56, 1
  s_cmp_eq_u32 s56, 12
  s_cselect_b32 s56, 0, s56
  s_add_u32 s57, s57, 1
  s_cmp_eq_u32 s57, 12
  s_cselect_b32 s57, 0, s57
  s_cselect_b32 s59, 12, 0
  s_add_u32 s58, s58, s59
  s_add_u32 s60, s60, 20480
  s_cmp_eq_u32 s60, 143360
  s_cselect_b32 s60, 0, s60
  s_add_u32 s66, s58, s56
  s_lshl_b32 s63, s66, 17
  s_add_u32 m0, s60, s75
  s_add_u32 s63, s63, s65
  buffer_load_dwordx4 v3, s[24:27], s63 offen lds
  buffer_load_dwordx4 v4, s[24:27], s63 offen offset:1024 lds
  s_add_u32 s56, s56, 1
  s_cmp_eq_u32 s56, 12
  s_cselect_b32 s56, 0, s56
  s_add_u32 s57, s57, 1
  s_cmp_eq_u32 s57, 12
  s_cselect_b32 s57, 0, s57
  s_cselect_b32 s59, 12, 0
  s_add_u32 s58, s58, s59
  s_add_u32 s60, s60, 20480
  s_cmp_eq_u32 s60, 143360
  s_cselect_b32 s60, 0, s60
  s_add_u32 s66, s58, s56
  s_lshl_b32 s63, s66, 17
  s_add_u32 m0, s60, s75
  s_add_u32 s63, s63, s65
  buffer_load_dwordx4 v3, s[24:27], s63 offen lds
  buffer_load_dwordx4 v4, s[24:27], s63 offen offset:1024 lds
  s_add_u32 s56, s56, 1
  s_cmp_eq_u32 s56, 12
  s_cselect_b32 s56, 0, s56
  s_add_u32 s57, s57, 1
  s_cmp_eq_u32 s57, 12
  s_cselect_b32 s57, 0, s57
  s_cselect_b32 s59, 12, 0
  s_add_u32 s58, s58, s59
  s_add_u32 s60, s60, 20480
  s_cmp_eq_u32 s60, 143360
  s_cselect_b32 s60, 0, s60
  s_add_u32 s66, s58, s56
  s_lshl_b32 s63, s66, 17
  s_add_u32 m0, s60, s75
  s_add_u32 s63, s63, s65
  buffer_load_dwordx4 v3, s[24:27], s63 offen lds
  buffer_load_dwordx4 v4, s[24:27], s63 offen offset:1024 lds
  s_add_u32 s56, s56, 1
  s_cmp_eq_u32 s56, 12
  s_cselect_b32 s56, 0, s56
  s_add_u32 s57, s57, 1
  s_cmp_eq_u32 s57, 12
  s_cselect_b32 s57, 0, s57
  s_cselect_b32 s59, 12, 0
  s_add_u32 s58, s58, s59
  s_add_u32 s60, s60, 20480
  s_cmp_eq_u32 s60, 143360
  s_cselect_b32 s60, 0, s60
  s_cmp_lt_u32 s3, 7
  s_cbranch_scc1 L_g2_nopf
  v_mov_b32 v15, 163828
L_g2_pf:
  s_cmp_eq_u32 s80, 0
  s_cbranch_scc1 L_g2_pf_x
  ds_read_b32 v17, v15
  s_mov_b32 s67, 268435456
  v_mul_hi_u32 v13, v12, s67
  v_mul_u32_u24 v14, 16, v13
  v_sub_u32 v14, v12, v14
  v_mul_u32_u24 v13, 4096, v13
  v_lshl_add_u32 v13, v14, 7, v13
  s_waitcnt lgkmcnt(0)
  v_readfirstlane_b32 s67, v17
  s_cmp_ge_u32 s67, 1
  s_cbranch_scc1 L_g2_pf_x
  buffer_load_dword v16, v13, s[24:27], s81 offen
  v_add_u32 v12, 1536, v12
  s_sub_u32 s80, s80, 1
  s_waitcnt vmcnt(1)
  s_branch L_g2_pf
L_g2_pf_x:
L_g2_nopf:
  s_cmp_lg_u32 s3, 4
  s_cbranch_scc1 L_g2gate_g
  s_lshl_b32 s83, s73, 13
  s_add_u32 s83, s83, 27557888
  s_mov_b32 s84, 0xffffff
  s_mov_b32 s85, 0xffffff
  v_lshlrev_b32 v41, 7, v1
  s_mov_b32 s68, 0x8000
L_g2gate:
  buffer_load_dword v40, v41, s[16:19], s83 offen sc1
  s_waitcnt vmcnt(0)
  v_xor_b32 v40, s54, v40
  v_cmp_ne_u32 vcc, 0, v40
  s_sub_u32 s68, s68, 1
  s_cmp_eq_u32 s68, 0
  s_cbranch_scc1 L_g2gate_x
  s_and_b64 vcc, vcc, s[84:85]
  s_cbranch_scc0 L_g2gate_x
  s_sleep 2
  s_branch L_g2gate
L_g2gate_x:
  v_mov_b32 v40, 163828
  v_mov_b32 v41, 1
  s_mov_b64 exec, 1
  ds_add_u32 v40, v41
  s_mov_b64 exec, -1
L_g2gate_g:
  s_barrier
  s_mov_b32 s56, s78
  s_mov_b32 s57, 0
  s_mov_b32 s58, 0
  s_mov_b32 s60, 0
  s_add_u32 s66, s58, s56
  s_mul_i32 s62, s66, 36864
  s_add_u32 m0, s60, s74
  s_add_u32 s62, s62, s64
  buffer_load_dwordx4 v2, s[16:19], s62 offen sc1 lds
  buffer_load_dwordx4 v2, s[16:19], s62 offen offset:1024 sc1 lds
  buffer_load_dwordx4 v2, s[16:19], s62 offen offset:2048 sc1 lds
  s_add_u32 s56, s56, 1
  s_cmp_eq_u32 s56, 12
  s_cselect_b32 s56, 0, s56
  s_add_u32 s57, s57, 1
  s_cmp_eq_u32 s57, 12
  s_cselect_b32 s57, 0, s57
  s_cselect_b32 s59, 12, 0
  s_add_u32 s58, s58, s59
  s_add_u32 s60, s60, 20480
  s_cmp_eq_u32 s60, 143360
  s_cselect_b32 s60, 0, s60
  s_add_u32 s66, s58, s56
  s_mul_i32 s62, s66, 36864
  s_add_u32 m0, s60, s74
  s_add_u32 s62, s62, s64
  buffer_load_dwordx4 v2, s[16:19], s62 offen sc1 lds
  buffer_load_dwordx4 v2, s[16:19], s62 offen offset:1024 sc1 lds
  buffer_load_dwordx4 v2, s[16:19], s62 offen offset:2048 sc1 lds
  s_add_u32 s56, s56, 1
  s_cmp_eq_u32 s56, 12
  s_cselect_b32 s56, 0, s56
  s_add_u32 s57, s57, 1
  s_cmp_eq_u32 s57, 12
  s_cselect_b32 s57, 0, s57
  s_cselect_b32 s59, 12, 0
  s_add_u32 s58, s58, s59
  s_add_u32 s60, s60, 20480
  s_cmp_eq_u32 s60, 143360
  s_cselect_b32 s60, 0, s60
  s_add_u32 s66, s58, s56
  s_mul_i32 s62, s66, 36864
  s_add_u32 m0, s60, s74
  s_add_u32 s62, s62, s64
  buffer_load_dwordx4 v2, s[16:19], s62 offen sc1 lds
  buffer_load_dwordx4 v2, s[16:19], s62 offen offset:1024 sc1 lds
  buffer_load_dwordx4 v2, s[16:19], s62 offen offset:2048 sc1 lds
  s_add_u32 s56, s56, 1
  s_cmp_eq_u32 s56, 12
  s_cselect_b32 s56, 0, s56
  s_add_u32 s57, s57, 1
  s_cmp_eq_u32 s57, 12
  s_cselect_b32 s57, 0, s57
  s_cselect_b32 s59, 12, 0
  s_add_u32 s58, s58, s59
  s_add_u32 s60, s60, 20480
  s_cmp_eq_u32 s60, 143360
  s_cselect_b32 s60, 0, s60
  s_add_u32 s66, s58, s56
  s_mul_i32 s62, s66, 36864
  s_add_u32 m0, s60, s74
  s_add_u32 s62, s62, s64
  buffer_load_dwordx4 v2, s[16:19], s62 offen sc1 lds
  buffer_load_dwordx4 v2, s[16:19], s62 offen offset:1024 sc1 lds
  buffer_load_dwordx4 v2, s[16:19], s62 offen offset:2048 sc1 lds
  s_add_u32 s56, s56, 1
  s_cmp_eq_u32 s56, 12
  s_cselect_b32 s56, 0, s56
  s_add_u32 s57, s57, 1
  s_cmp_eq_u32 s57, 12
  s_cselect_b32 s57, 0, s57
  s_cselect_b32 s59, 12, 0
  s_add_u32 s58, s58, s59
  s_add_u32 s60, s60, 20480
  s_cmp_eq_u32 s60, 143360
  s_cselect_b32 s60, 0, s60
  s_add_u32 s66, s58, s56
  s_mul_i32 s62, s66, 36864
  s_add_u32 m0, s60, s74
  s_add_u32 s62, s62, s64
  buffer_load_dwordx4 v2, s[16:19], s62 offen sc1 lds
  buffer_load_dwordx4 v2, s[16:19], s62 offen offset:1024 sc1 lds
  buffer_load_dwordx4 v2, s[16:19], s62 offen offset:2048 sc1 lds
  s_add_u32 s56, s56, 1
  s_cmp_eq_u32 s56, 12
  s_cselect_b32 s56, 0, s56
  s_add_u32 s57, s57, 1
  s_cmp_eq_u32 s57, 12
  s_cselect_b32 s57, 0, s57
  s_cselect_b32 s59, 12, 0
  s_add_u32 s58, s58, s59
  s_add_u32 s60, s60, 20480
  s_cmp_eq_u32 s60, 143360
  s_cselect_b32 s60, 0, s60
  s_add_u32 s66, s58, s56
  s_mul_i32 s62, s66, 36864
  s_add_u32 m0, s60, s74
  s_add_u32 s62, s62, s64
  buffer_load_dwordx4 v2, s[16:19], s62 offen sc1 lds
  buffer_load_dwordx4 v2, s[16:19], s62 offen offset:1024 sc1 lds
  buffer_load_dwordx4 v2, s[16:19], s62 offen offset:2048 sc1 lds
  s_add_u32 s56, s56, 1
  s_cmp_eq_u32 s56, 12
  s_cselect_b32 s56, 0, s56
  s_add_u32 s57, s57, 1
  s_cmp_eq_u32 s57, 12
  s_cselect_b32 s57, 0, s57
  s_cselect_b32 s59, 12, 0
  s_add_u32 s58, s58, s59
  s_add_u32 s60, s60, 20480
  s_cmp_eq_u32 s60, 143360
  s_cselect_b32 s60, 0, s60
  s_add_u32 s66, s58, s56
  s_mul_i32 s62, s66, 36864
  s_add_u32 m0, s60, s74
  s_add_u32 s62, s62, s64
  buffer_load_dwordx4 v2, s[16:19], s62 offen sc1 lds
  buffer_load_dwordx4 v2, s[16:19], s62 offen offset:1024 sc1 lds
  buffer_load_dwordx4 v2, s[16:19], s62 offen offset:2048 sc1 lds
  s_add_u32 s56, s56, 1
  s_cmp_eq_u32 s56, 12
  s_cselect_b32 s56, 0, s56
  s_add_u32 s57, s57, 1
  s_cmp_eq_u32 s57, 12
  s_cselect_b32 s57, 0, s57
  s_cselect_b32 s59, 12, 0
  s_add_u32 s58, s58, s59
  s_add_u32 s60, s60, 20480
  s_cmp_eq_u32 s60, 143360
  s_cselect_b32 s60, 0, s60
  s_waitcnt vmcnt(18)
  s_barrier
  s_waitcnt vmcnt(15)
  s_barrier
  s_add_u32 s66, s58, s56
  s_lshl_b32 s63, s66, 17
  s_add_u32 m0, s60, s75
  s_add_u32 s63, s63, s65
  buffer_load_dwordx4 v3, s[24:27], s63 offen lds
  buffer_load_dwordx4 v4, s[24:27], s63 offen offset:1024 lds
  s_add_u32 s66, s58, s56
  s_mul_i32 s62, s66, 36864
  s_add_u32 m0, s60, s74
  s_add_u32 s62, s62, s64
  buffer_load_dwordx4 v2, s[16:19], s62 offen sc1 lds
  buffer_load_dwordx4 v2, s[16:19], s62 offen offset:1024 sc1 lds
  buffer_load_dwordx4 v2, s[16:19], s62 offen offset:2048 sc1 lds
  s_add_u32 s56, s56, 1
  s_cmp_eq_u32 s56, 12
  s_cselect_b32 s56, 0, s56
  s_add_u32 s57, s57, 1
  s_cmp_eq_u32 s57, 12
  s_cselect_b32 s57, 0, s57
  s_cselect_b32 s59, 12, 0
  s_add_u32 s58, s58, s59
  s_add_u32 s60, s60, 20480
  s_cmp_eq_u32 s60, 143360
  s_cselect_b32 s60, 0, s60
  s_waitcnt vmcnt(17)
  s_barrier
  s_add_u32 s66, s58, s56
  s_lshl_b32 s63, s66, 17
  s_add_u32 m0, s60, s75
  s_add_u32 s63, s63, s65
  buffer_load_dwordx4 v3, s[24:27], s63 offen lds
  buffer_load_dwordx4 v4, s[24:27], s63 offen offset:1024 lds
  s_add_u32 s66, s58, s56
  s_mul_i32 s62, s66, 36864
  s_add_u32 m0, s60, s74
  s_add_u32 s62, s62, s64
  buffer_load_dwordx4 v2, s[16:19], s62 offen sc1 lds
  buffer_load_dwordx4 v2, s[16:19], s62 offen offset:1024 sc1 lds
  buffer_load_dwordx4 v2, s[16:19], s62 offen offset:2048 sc1 lds
  s_add_u32 s56, s56, 1
  s_cmp_eq_u32 s56, 12
  s_cselect_b32 s56, 0, s56
  s_add_u32 s57, s57, 1
  s_cmp_eq_u32 s57, 12
  s_cselect_b32 s57, 0, s57
  s_cselect_b32 s59, 12, 0
  s_add_u32 s58, s58, s59
  s_add_u32 s60, s60, 20480
  s_cmp_eq_u32 s60, 143360
  s_cselect_b32 s60, 0, s60
  s_waitcnt vmcnt(19)
  s_barrier
  s_add_u32 s66, s58, s56
  s_lshl_b32 s63, s66, 17
  s_add_u32 m0, s60, s75
  s_add_u32 s63, s63, s65
  buffer_load_dwordx4 v3, s[24:27], s63 offen lds
  buffer_load_dwordx4 v4, s[24:27], s63 offen offset:1024 lds
  s_add_u32 s66, s58, s56
  s_mul_i32 s62, s66, 36864
  s_add_u32 m0, s60, s74
  s_add_u32 s62, s62, s64
  buffer_load_dwordx4 v2, s[16:19], s62 offen sc1 lds
  buffer_load_dwordx4 v2, s[16:19], s62 offen offset:1024 sc1 lds
  buffer_load_dwordx4 v2, s[16:19], s62 offen offset:2048 sc1 lds
  s_add_u32 s56, s56, 1
  s_cmp_eq_u32 s56, 12
  s_cselect_b32 s56, 0, s56
  s_add_u32 s57, s57, 1
  s_cmp_eq_u32 s57, 12
  s_cselect_b32 s57, 0, s57
  s_cselect_b32 s59, 12, 0
  s_add_u32 s58, s58, s59
  s_add_u32 s60, s60, 20480
  s_cmp_eq_u32 s60, 143360
  s_cselect_b32 s60, 0, s60
  s_waitcnt vmcnt(21)
  s_barrier
  s_add_u32 s66, s58, s56
  s_lshl_b32 s63, s66, 17
  s_add_u32 m0, s60, s75
  s_add_u32 s63, s63, s65
  buffer_load_dwordx4 v3, s[24:27], s63 offen lds
  buffer_load_dwordx4 v4, s[24:27], s63 offen offset:1024 lds
  s_add_u32 s66, s58, s56
  s_mul_i32 s62, s66, 36864
  s_add_u32 m0, s60, s74
  s_add_u32 s62, s62, s64
  buffer_load_dwordx4 v2, s[16:19], s62 offen sc1 lds
  buffer_load_dwordx4 v2, s[16:19], s62 offen offset:1024 sc1 lds
  buffer_load_dwordx4 v2, s[16:19], s62 offen offset:2048 sc1 lds
  s_add_u32 s56, s56, 1
  s_cmp_eq_u32 s56, 12
  s_cselect_b32 s56, 0, s56
  s_add_u32 s57, s57, 1
  s_cmp_eq_u32 s57, 12
  s_cselect_b32 s57, 0, s57
  s_cselect_b32 s59, 12, 0
  s_add_u32 s58, s58, s59
  s_add_u32 s60, s60, 20480
  s_cmp_eq_u32 s60, 143360
  s_cselect_b32 s60, 0, s60
  s_waitcnt vmcnt(23)
  s_barrier
  s_add_u32 s66, s58, s56
  s_lshl_b32 s63, s66, 17
  s_add_u32 m0, s60, s75
  s_add_u32 s63, s63, s65
  buffer_load_dwordx4 v3, s[24:27], s63 offen lds
  buffer_load_dwordx4 v4, s[24:27], s63 offen offset:1024 lds
  s_add_u32 s66, s58, s56
  s_mul_i32 s62, s66, 36864
  s_add_u32 m0, s60, s74
  s_add_u32 s62, s62, s64
  buffer_load_dwordx4 v2, s[16:19], s62 offen sc1 lds
  buffer_load_dwordx4 v2, s[16:19], s62 offen offset:1024 sc1 lds
  buffer_load_dwordx4 v2, s[16:19], s62 offen offset:2048 sc1 lds
  s_add_u32 s56, s56, 1
  s_cmp_eq_u32 s56, 12
  s_cselect_b32 s56, 0, s56
  s_add_u32 s57, s57, 1
  s_cmp_eq_u32 s57, 12
  s_cselect_b32 s57, 0, s57
  s_cselect_b32 s59, 12, 0
  s_add_u32 s58, s58, s59
  s_add_u32 s60, s60, 20480
  s_cmp_eq_u32 s60, 143360
  s_cselect_b32 s60, 0, s60
  s_waitcnt vmcnt(25)
  s_barrier
  s_add_u32 s66, s58, s56
  s_lshl_b32 s63, s66, 17
  s_add_u32 m0, s60, s75
  s_add_u32 s63, s63, s65
  buffer_load_dwordx4 v3, s[24:27], s63 offen lds
  buffer_load_dwordx4 v4, s[24:27], s63 offen offset:1024 lds
  s_add_u32 s66, s58, s56
  s_mul_i32 s62, s66, 36864
  s_add_u32 m0, s60, s74
  s_add_u32 s62, s62, s64
  buffer_load_dwordx4 v2, s[16:19], s62 offen sc1 lds
  buffer_load_dwordx4 v2, s[16:19], s62 offen offset:1024 sc1 lds
  buffer_load_dwordx4 v2, s[16:19], s62 offen offset:2048 sc1 lds
  s_add_u32 s56, s56, 1
  s_cmp_eq_u32 s56, 12
  s_cselect_b32 s56, 0, s56
  s_add_u32 s57, s57, 1
  s_cmp_eq_u32 s57, 12
  s_cselect_b32 s57, 0, s57
  s_cselect_b32 s59, 12, 0
  s_add_u32 s58, s58, s59
  s_add_u32 s60, s60, 20480
  s_cmp_eq_u32 s60, 143360
  s_cselect_b32 s60, 0, s60
  s_mov_b32 s61, 23
L_g2_ld:
  s_waitcnt vmcnt(25)
  s_barrier
  s_add_u32 s66, s58, s56
  s_lshl_b32 s63, s66, 17
  s_add_u32 m0, s60, s75
  s_add_u32 s63, s63, s65
  buffer_load_dwordx4 v3, s[24:27], s63 offen lds
  buffer_load_dwordx4 v4, s[24:27], s63 offen offset:1024 lds
  s_add_u32 s66, s58, s56
  s_mul_i32 s62, s66, 36864
  s_add_u32 m0, s60, s74
  s_add_u32 s62, s62, s64
  buffer_load_dwordx4 v2, s[16:19], s62 offen sc1 lds
  buffer_load_dwordx4 v2, s[16:19], s62 offen offset:1024 sc1 lds
  buffer_load_dwordx4 v2, s[16:19], s62 offen offset:2048 sc1 lds
  s_add_u32 s56, s56, 1
  s_cmp_eq_u32 s56, 12
  s_cselect_b32 s56, 0, s56
  s_add_u32 s57, s57, 1
  s_cmp_eq_u32 s57, 12
  s_cselect_b32 s57, 0, s57
  s_cselect_b32 s59, 12, 0
  s_add_u32 s58, s58, s59
  s_add_u32 s60, s60, 20480
  s_cmp_eq_u32 s60, 143360
  s_cselect_b32 s60, 0, s60
  s_sub_u32 s61, s61, 1
  s_cmp_lg_u32 s61, 0
  s_cbranch_scc1 L_g2_ld
  s_waitcnt vmcnt(25)
  s_barrier
  s_waitcnt vmcnt(20)
  s_barrier
  s_waitcnt vmcnt(15)
  s_barrier
  s_waitcnt vmcnt(10)
  s_barrier
  s_waitcnt vmcnt(5)
  s_barrier
  s_waitcnt vmcnt(0)
  s_barrier
  s_branch L_fin
L_kv_ld:
  s_and_b32 s72, s52, 3
  s_lshr_b32 s71, s52, 2
  s_lshl_b32 s71, s71, 3
  s_add_u32 s71, s71, s53
  s_sub_u32 s71, s71, 24
  s_lshl_b32 s64, s71, 13
  s_add_u32 s64, s64, 2359296
  s_mul_i32 s65, s72, 288
  s_add_u32 s65, s65, 1152
  s_cmp_lt_u32 s3, 6
  s_cbranch_scc1 L_kv_nopf
  s_sub_u32 s80, s53, 24
  s_and_b32 s81, s65, 0xffffff80
  s_sub_u32 s67, s3, 6
  s_mul_i32 s67, s67, 1152
  s_add_u32 s81, s81, s67
  s_lshl_b32 s67, s80, 6
  s_add_u32 s67, s67, 0
  v_add_u32 v12, s67, v1
  s_mov_b32 s67, 1431655766
  s_mov_b32 s68, 4
  v_mov_b32 v15, 2147479552
L_kv_pfa:
  v_mul_hi_u32 v13, v12, s67
  v_mul_u32_u24 v14, 3, v13
  v_sub_u32 v14, v12, v14
  v_mul_u32_u24 v13, 3456, v13
  v_cmp_gt_u32 vcc, 1728, v12
  v_lshl_add_u32 v13, v14, 7, v13
  v_add_u32 v12, 512, v12
  v_cndmask_b32 v13, v15, v13, vcc
  s_waitcnt vmcnt(0)
  buffer_load_dword v16, v13, s[28:31], s81 offen
  s_sub_u32 s68, s68, 1
  s_cmp_lg_u32 s68, 0
  s_cbranch_scc1 L_kv_pfa
L_kv_nopf:
  v_lshlrev_b32 v102, 4, v1
  s_lshl_b32 s67, s70, 8
  v_add_u32 v109, s67, v1
  v_add_u32 v110, 0, v109
  s_mov_b32 s67, 119304648
  v_mul_hi_u32 v111, v110, s67
  v_mul_u32_u24 v112, 36, v111
  v_sub_u32 v112, v110, v112
  v_bfe_u32 v110, v111, 3, 1
  v_lshlrev_b32 v110, 1, v110
  v_xor_b32 v112, v112, v110
  v_mul_u32_u24 v103, 3456, v111
  v_lshl_add_u32 v103, v112, 4, v103
  v_cmp_le_u32 vcc, 18, v112
  v_mov_b32 v110, 864
  s_nop 0
  v_cndmask_b32 v110, 0, v110, vcc
  v_add_u32 v103, v103, v110
  v_add_u32 v110, 64, v109
  s_mov_b32 s67, 119304648
  v_mul_hi_u32 v111, v110, s67
  v_mul_u32_u24 v112, 36, v111
  v_sub_u32 v112, v110, v112
  v_bfe_u32 v110, v111, 3, 1
  v_lshlrev_b32 v110, 1, v110
  v_xor_b32 v112, v112, v110
  v_mul_u32_u24 v104, 3456, v111
  v_lshl_add_u32 v104, v112, 4, v104
  v_cmp_le_u32 vcc, 18, v112
  v_mov_b32 v110, 864
  s_nop 0
  v_cndmask_b32 v110, 0, v110, vcc
  v_add_u32 v104, v104, v110
  v_subrev_u32 v104, 1024, v104
  v_add_u32 v110, 128, v109
  s_mov_b32 s67, 119304648
  v_mul_hi_u32 v111, v110, s67
  v_mul_u32_u24 v112, 36, v111
  v_sub_u32 v112, v110, v112
  v_bfe_u32 v110, v111, 3, 1
  v_lshlrev_b32 v110, 1, v110
  v_xor_b32 v112, v112, v110
  v_mul_u32_u24 v105, 3456, v111
  v_lshl_add_u32 v105, v112, 4, v105
  v_cmp_le_u32 vcc, 18, v112
  v_mov_b32 v110, 864
  s_nop 0
  v_cndmask_b32 v110, 0, v110, vcc
  v_add_u32 v105, v105, v110
  v_subrev_u32 v105, 2048, v105
  v_add_u32 v110, 192, v109
  s_mov_b32 s67, 119304648
  v_mul_hi_u32 v111, v110, s67
  v_mul_u32_u24 v112, 36, v111
  v_sub_u32 v112, v110, v112
  v_bfe_u32 v110, v111, 3, 1
  v_lshlrev_b32 v110, 1, v110
  v_xor_b32 v112, v112, v110
  v_mul_u32_u24 v106, 3456, v111
  v_lshl_add_u32 v106, v112, 4, v106
  v_cmp_le_u32 vcc, 18, v112
  v_mov_b32 v110, 864
  s_nop 0
  v_cndmask_b32 v110, 0, v110, vcc
  v_add_u32 v106, v106, v110
  v_subrev_u32 v106, 3072, v106
  s_lshl_b32 s67, s70, 6
  v_add_u32 v109, s67, v1
  v_add_u32 v110, 1024, v109
  s_mov_b32 s67, 119304648
  v_mul_hi_u32 v111, v110, s67
  v_mul_u32_u24 v112, 36, v111
  v_sub_u32 v112, v110, v112
  v_bfe_u32 v110, v111, 3, 1
  v_lshlrev_b32 v110, 1, v110
  v_xor_b32 v112, v112, v110
  v_mul_u32_u24 v107, 3456, v111
  v_lshl_add_u32 v107, v112, 4, v107
  v_cmp_le_u32 vcc, 18, v112
  v_mov_b32 v110, 864
  s_nop 0
  v_cndmask_b32 v110, 0, v110, vcc
  v_add_u32 v107, v107, v110
  s_lshl_b32 s67, s70, 6
  s_add_u32 s67, s67, 0
  v_add_u32 v109, s67, v1
  s_mov_b32 s67, 28256364
  v_mul_hi_u32 v110, v109, s67
  v_mul_u32_u24 v111, 152, v110
  v_sub_u32 v109, v109, v111
  s_mov_b32 s67, 238609295
  v_mul_hi_u32 v111, v109, s67
  v_cmp_gt_u32 vcc, 144, v109
  v_mul_u32_u24 v112, 18, v111
  v_sub_u32 v112, v109, v112
  v_lshl_add_u32 v110, v110, 3, v111
  v_mul_u32_u24 v110, 3456, v110
  v_lshl_add_u32 v110, v112, 4, v110
  v_mov_b32 v111, 2147479552
  v_cndmask_b32 v96, v111, v110, vcc
  s_lshl_b32 s67, s70, 6
  s_add_u32 s67, s67, 256
  v_add_u32 v109, s67, v1
  s_mov_b32 s67, 28256364
  v_mul_hi_u32 v110, v109, s67
  v_mul_u32_u24 v111, 152, v110
  v_sub_u32 v109, v109, v111
  s_mov_b32 s67, 238609295
  v_mul_hi_u32 v111, v109, s67
  v_cmp_gt_u32 vcc, 144, v109
  v_mul_u32_u24 v112, 18, v111
  v_sub_u32 v112, v109, v112
  v_lshl_add_u32 v110, v110, 3, v111
  v_mul_u32_u24 v110, 3456, v110
  v_lshl_add_u32 v110, v112, 4, v110
  v_mov_b32 v111, 2147479552
  v_cndmask_b32 v97, v111, v110, vcc
  s_lshl_b32 s67, s70, 6
  s_add_u32 s67, s67, 512
  v_add_u32 v109, s67, v1
  s_mov_b32 s67, 28256364
  v_mul_hi_u32 v110, v109, s67
  v_mul_u32_u24 v111, 152, v110
  v_sub_u32 v109, v109, v111
  s_mov_b32 s67, 238609295
  v_mul_hi_u32 v111, v109, s67
  v_cmp_gt_u32 vcc, 144, v109
  v_mul_u32_u24 v112, 18, v111
  v_sub_u32 v112, v109, v112
  v_lshl_add_u32 v110, v110, 3, v111
  v_mul_u32_u24 v110, 3456, v110
  v_lshl_add_u32 v110, v112, 4, v110
  v_mov_b32 v111, 2147479552
  v_cndmask_b32 v98, v111, v110, vcc
  v_lshlrev_b32 v28, 2, v1
  s_lshl_b32 s67, s70, 8
  v_add_u32 v28, s67, v28
  v_and_b32 v30, 3, v1
  s_lshl_b32 s67, s70, 2
  v_add_u32 v30, s67, v30
  v_lshrrev_b32 v31, 2, v1
  s_mov_b32 s67, 3641
  v_mov_b32 v29, 2147479552
  v_add_u32 v32, 0, v30
  v_add_u32 v44, 0, v31
  v_mul_u32_u24 v32, s67, v32
  v_mul_u32_u24 v44, s67, v44
  v_lshrrev_b32 v32, 16, v32
  v_lshrrev_b32 v44, 16, v44
  v_add_u32 v33, 16, v30
  v_add_u32 v45, 16, v31
  v_mul_u32_u24 v33, s67, v33
  v_mul_u32_u24 v45, s67, v45
  v_lshrrev_b32 v33, 16, v33
  v_lshrrev_b32 v45, 16, v45
  v_add_u32 v34, 32, v30
  v_add_u32 v46, 32, v31
  v_mul_u32_u24 v34, s67, v34
  v_mul_u32_u24 v46, s67, v46
  v_lshrrev_b32 v34, 16, v34
  v_lshrrev_b32 v46, 16, v46
  v_add_u32 v35, 48, v30
  v_add_u32 v47, 48, v31
  v_mul_u32_u24 v35, s67, v35
  v_mul_u32_u24 v47, s67, v47
  v_lshrrev_b32 v35, 16, v35
  v_lshrrev_b32 v47, 16, v47
  v_add_u32 v36, 64, v30
  v_add_u32 v48, 64, v31
  v_mul_u32_u24 v36, s67, v36
  v_mul_u32_u24 v48, s67, v48
  v_lshrrev_b32 v36, 16, v36
  v_lshrrev_b32 v48, 16, v48
  v_add_u32 v37, 80, v30
  v_add_u32 v49, 80, v31
  v_mul_u32_u24 v37, s67, v37
  v_mul_u32_u24 v49, s67, v49
  v_lshrrev_b32 v37, 16, v37
  v_lshrrev_b32 v49, 16, v49
  v_add_u32 v38, 96, v30
  v_add_u32 v50, 96, v31
  v_mul_u32_u24 v38, s67, v38
  v_mul_u32_u24 v50, s67, v50
  v_lshrrev_b32 v38, 16, v38
  v_lshrrev_b32 v50, 16, v50
  v_add_u32 v39, 112, v30
  v_add_u32 v51, 112, v31
  v_mul_u32_u24 v39, s67, v39
  v_mul_u32_u24 v51, s67, v51
  v_lshrrev_b32 v39, 16, v39
  v_lshrrev_b32 v51, 16, v51
  v_add_u32 v40, 128, v30
  v_add_u32 v52, 128, v31
  v_mul_u32_u24 v40, s67, v40
  v_mul_u32_u24 v52, s67, v52
  v_lshrrev_b32 v40, 16, v40
  v_lshrrev_b32 v52, 16, v52
  v_cmp_eq_u32 vcc, v32, v44
  s_nop 1
  v_cndmask_b32 v56, v29, v28, vcc
  v_cmp_eq_u32 vcc, v32, v45
  s_nop 1
  v_cndmask_b32 v57, v29, v28, vcc
  v_cmp_eq_u32 vcc, v33, v44
  s_nop 1
  v_cndmask_b32 v58, v29, v28, vcc
  v_cmp_eq_u32 vcc, v33, v45
  s_nop 1
  v_cndmask_b32 v59, v29, v28, vcc
  v_cmp_eq_u32 vcc, v33, v46
  s_nop 1
  v_cndmask_b32 v60, v29, v28, vcc
  v_cmp_eq_u32 vcc, v34, v45
  s_nop 1
  v_cndmask_b32 v61, v29, v28, vcc
  v_cmp_eq_u32 vcc, v34, v46
  s_nop 1
  v_cndmask_b32 v62, v29, v28, vcc
  v_cmp_eq_u32 vcc, v34, v47
  s_nop 1
  v_cndmask_b32 v63, v29, v28, vcc
  v_cmp_eq_u32 vcc, v35, v46
  s_nop 1
  v_cndmask_b32 v64, v29, v28, vcc
  v_cmp_eq_u32 vcc, v35, v47
  s_nop 1
  v_cndmask_b32 v65, v29, v28, vcc
  v_cmp_eq_u32 vcc, v35, v48
  s_nop 1
  v_cndmask_b32 v66, v29, v28, vcc
  v_cmp_eq_u32 vcc, v36, v47
  s_nop 1
  v_cndmask_b32 v67, v29, v28, vcc
  v_cmp_eq_u32 vcc, v36, v48
  s_nop 1
  v_cndmask_b32 v68, v29, v28, vcc
  v_cmp_eq_u32 vcc, v36, v49
  s_nop 1
  v_cndmask_b32 v69, v29, v28, vcc
  v_cmp_eq_u32 vcc, v37, v48
  s_nop 1
  v_cndmask_b32 v70, v29, v28, vcc
  v_cmp_eq_u32 vcc, v37, v49
  s_nop 1
  v_cndmask_b32 v71, v29, v28, vcc
  v_cmp_eq_u32 vcc, v37, v50
  s_nop 1
  v_cndmask_b32 v72, v29, v28, vcc
  v_cmp_eq_u32 vcc, v38, v49
  s_nop 1
  v_cndmask_b32 v73, v29, v28, vcc
  v_cmp_eq_u32 vcc, v38, v50
  s_nop 1
  v_cndmask_b32 v74, v29, v28, vcc
  v_cmp_eq_u32 vcc, v38, v51
  s_nop 1
  v_cndmask_b32 v75, v29, v28, vcc
  v_cmp_eq_u32 vcc, v39, v50
  s_nop 1
  v_cndmask_b32 v76, v29, v28, vcc
  v_cmp_eq_u32 vcc, v39, v51
  s_nop 1
  v_cndmask_b32 v77, v29, v28, vcc
  v_cmp_eq_u32 vcc, v39, v52
  s_nop 1
  v_cndmask_b32 v78, v29, v28, vcc
  v_cmp_eq_u32 vcc, v40, v51
  s_nop 1
  v_cndmask_b32 v79, v29, v28, vcc
  v_cmp_eq_u32 vcc, v40, v52
  s_nop 1
  v_cndmask_b32 v80, v29, v28, vcc
  v_cmp_gt_u32 vcc, 576, v28
  s_nop 1
  v_cndmask_b32 v81, v29, v28, vcc
  v_mov_b32 v20, 163808
  s_mov_b32 s68, 0x80000
L_kv_lnw:
  ds_read_b32 v21, v20
  s_sub_u32 s68, s68, 1
  s_cmp_eq_u32 s68, 0
  s_cbranch_scc1 L_kv_lnw_x
  s_waitcnt lgkmcnt(0)
  v_readfirstlane_b32 s67, v21
  s_cmp_ge_u32 s67, 4
  s_cbranch_scc1 L_kv_lnw_x
  s_sleep 1
  s_branch L_kv_lnw
L_kv_lnw_x:
  s_waitcnt lgkmcnt(0)
  s_sub_u32 s80, s53, 24
  s_lshl_b32 s80, s80, 2
  s_add_u32 s80, s80, s70
  s_lshl_b32 s81, s80, 13
  v_lshlrev_b32 v24, 7, v1
  v_add_u32 v24, s81, v24
  s_mul_i32 s73, s70, 2048
  s_add_u32 s64, s64, s73
  s_lshl_b32 s74, s70, 12
  s_add_u32 s74, s74, 8192
  s_lshl_b32 s75, s70, 10
  s_add_u32 s75, s75, 24576
  s_mov_b32 s60, 0
  s_mov_b32 s63, s65
  s_mov_b32 s62, s64
  s_add_u32 m0, s60, s74
  s_nop 0
  buffer_load_dwordx4 v103, s[28:31], s63 offen lds
  buffer_load_dwordx4 v104, s[28:31], s63 offen offset:1024 lds
  buffer_load_dwordx4 v105, s[28:31], s63 offen offset:2048 lds
  buffer_load_dwordx4 v106, s[28:31], s63 offen offset:3072 lds
  s_add_u32 m0, s60, s75
  s_cmp_ge_u32 s70, 2
  s_cbranch_scc1 L_wx_11
  buffer_load_dwordx4 v107, s[28:31], s63 offen lds
L_wx_11:
  s_add_u32 s63, s63, 110592
  s_add_u32 s60, s60, 26624
  s_cmp_eq_u32 s60, 133120
  s_cselect_b32 s60, 0, s60
  s_add_u32 m0, s60, s74
  s_nop 0
  buffer_load_dwordx4 v103, s[28:31], s63 offen lds
  buffer_load_dwordx4 v104, s[28:31], s63 offen offset:1024 lds
  buffer_load_dwordx4 v105, s[28:31], s63 offen offset:2048 lds
  buffer_load_dwordx4 v106, s[28:31], s63 offen offset:3072 lds
  s_add_u32 m0, s60, s75
  s_cmp_ge_u32 s70, 2
  s_cbranch_scc1 L_wx_12
  buffer_load_dwordx4 v107, s[28:31], s63 offen lds
L_wx_12:
  s_add_u32 s63, s63, 110592
  s_add_u32 s60, s60, 26624
  s_cmp_eq_u32 s60, 133120
  s_cselect_b32 s60, 0, s60
  s_add_u32 m0, s60, s74
  s_nop 0
  buffer_load_dwordx4 v103, s[28:31], s63 offen lds
  buffer_load_dwordx4 v104, s[28:31], s63 offen offset:1024 lds
  buffer_load_dwordx4 v105, s[28:31], s63 offen offset:2048 lds
  buffer_load_dwordx4 v106, s[28:31], s63 offen offset:3072 lds
  s_add_u32 m0, s60, s75
  s_cmp_ge_u32 s70, 2
  s_cbranch_scc1 L_wx_13
  buffer_load_dwordx4 v107, s[28:31], s63 offen lds
L_wx_13:
  s_add_u32 s63, s63, 110592
  s_add_u32 s60, s60, 26624
  s_cmp_eq_u32 s60, 133120
  s_cselect_b32 s60, 0, s60
  s_add_u32 m0, s60, s74
  s_nop 0
  buffer_load_dwordx4 v103, s[28:31], s63 offen lds
  buffer_load_dwordx4 v104, s[28:31], s63 offen offset:1024 lds
  buffer_load_dwordx4 v105, s[28:31], s63 offen offset:2048 lds
  buffer_load_dwordx4 v106, s[28:31], s63 offen offset:3072 lds
  s_add_u32 m0, s60, s75
  s_cmp_ge_u32 s70, 2
  s_cbranch_scc1 L_wx_14
  buffer_load_dwordx4 v107, s[28:31], s63 offen lds
L_wx_14:
  s_add_u32 s63, s63, 110592
  s_add_u32 s60, s60, 26624
  s_cmp_eq_u32 s60, 133120
  s_cselect_b32 s60, 0, s60
  s_add_u32 m0, s60, s74
  s_nop 0
  buffer_load_dwordx4 v103, s[28:31], s63 offen lds
  buffer_load_dwordx4 v104, s[28:31], s63 offen offset:1024 lds
  buffer_load_dwordx4 v105, s[28:31], s63 offen offset:2048 lds
  buffer_load_dwordx4 v106, s[28:31], s63 offen offset:3072 lds
  s_add_u32 m0, s60, s75
  s_cmp_ge_u32 s70, 2
  s_cbranch_scc1 L_wx_15
  buffer_load_dwordx4 v107, s[28:31], s63 offen lds
L_wx_15:
  s_add_u32 s63, s63, 110592
  s_add_u32 s60, s60, 26624
  s_cmp_eq_u32 s60, 133120
  s_cselect_b32 s60, 0, s60
  s_cmp_lg_u32 s3, 4
  s_cbranch_scc1 L_kvgate_g
  s_lshl_b32 s83, s71, 11
  s_add_u32 s83, s83, 27525120
  s_mov_b64 s[84:85], 0xffff
  v_lshlrev_b32 v41, 7, v1
  s_mov_b32 s68, 0x8000
L_kvgate:
  buffer_load_dword v40, v41, s[16:19], s83 offen sc1
  s_waitcnt vmcnt(0)
  v_xor_b32 v40, s54, v40
  v_cmp_ne_u32 vcc, 0, v40
  s_sub_u32 s68, s68, 1
  s_cmp_eq_u32 s68, 0
  s_cbranch_scc1 L_kvgate_x
  s_and_b64 vcc, vcc, s[84:85]
  s_cbranch_scc0 L_kvgate_x
  s_sleep 2
  s_branch L_kvgate
L_kvgate_x:
  v_mov_b32 v40, 163824
  v_mov_b32 v41, 1
  s_mov_b64 exec, 1
  ds_add_u32 v40, v41
  s_mov_b64 exec, -1
L_kvgate_g:
  s_barrier
  s_add_u32 m0, s60, s73
  s_nop 0
  buffer_load_dwordx4 v102, s[16:19], s62 offen sc1 lds
  buffer_load_dwordx4 v102, s[16:19], s62 offen offset:1024 sc1 lds
  s_add_u32 s62, s62, 131072
  s_add_u32 s60, s60, 26624
  s_cmp_eq_u32 s60, 133120
  s_cselect_b32 s60, 0, s60
  s_add_u32 m0, s60, s73
  s_nop 0
  buffer_load_dwordx4 v102, s[16:19], s62 offen sc1 lds
  buffer_load_dwordx4 v102, s[16:19], s62 offen offset:1024 sc1 lds
  s_add_u32 s62, s62, 131072
  s_add_u32 s60, s60, 26624
  s_cmp_eq_u32 s60, 133120
  s_cselect_b32 s60, 0, s60
  s_add_u32 m0, s60, s73
  s_nop 0
  buffer_load_dwordx4 v102, s[16:19], s62 offen sc1 lds
  buffer_load_dwordx4 v102, s[16:19], s62 offen offset:1024 sc1 lds
  s_add_u32 s62, s62, 131072
  s_add_u32 s60, s60, 26624
  s_cmp_eq_u32 s60, 133120
  s_cselect_b32 s60, 0, s60
  s_add_u32 m0, s60, s73
  s_nop 0
  buffer_load_dwordx4 v102, s[16:19], s62 offen sc1 lds
  buffer_load_dwordx4 v102, s[16:19], s62 offen offset:1024 sc1 lds
  s_add_u32 s62, s62, 131072
  s_add_u32 s60, s60, 26624
  s_cmp_eq_u32 s60, 133120
  s_cselect_b32 s60, 0, s60
  s_add_u32 m0, s60, s73
  s_nop 0
  buffer_load_dwordx4 v102, s[16:19], s62 offen sc1 lds
  buffer_load_dwordx4 v102, s[16:19], s62 offen offset:1024 sc1 lds
  s_add_u32 s62, s62, 131072
  s_add_u32 s60, s60, 26624
  s_cmp_eq_u32 s60, 133120
  s_cselect_b32 s60, 0, s60
  s_waitcnt vmcnt(8)
  s_barrier
  s_waitcnt vmcnt(6)
  s_barrier
  s_waitcnt vmcnt(4)
  s_barrier
  s_add_u32 m0, s60, s74
  s_nop 0
  buffer_load_dwordx4 v103, s[28:31], s63 offen lds
  buffer_load_dwordx4 v104, s[28:31], s63 offen offset:1024 lds
  buffer_load_dwordx4 v105, s[28:31], s63 offen offset:2048 lds
  buffer_load_dwordx4 v106, s[28:31], s63 offen offset:3072 lds
  s_add_u32 m0, s60, s75
  s_cmp_ge_u32 s70, 2
  s_cbranch_scc1 L_wx_16
  buffer_load_dwordx4 v107, s[28:31], s63 offen lds
L_wx_16:
  s_add_u32 s63, s63, 110592
  s_add_u32 m0, s60, s73
  s_nop 0
  buffer_load_dwordx4 v102, s[16:19], s62 offen sc1 lds
  buffer_load_dwordx4 v102, s[16:19], s62 offen offset:1024 sc1 lds
  s_add_u32 s62, s62, 131072
  s_add_u32 s60, s60, 26624
  s_cmp_eq_u32 s60, 133120
  s_cselect_b32 s60, 0, s60
  s_waitcnt vmcnt(8)
  s_barrier
  s_add_u32 m0, s60, s74
  s_nop 0
  buffer_load_dwordx4 v103, s[28:31], s63 offen lds
  buffer_load_dwordx4 v104, s[28:31], s63 offen offset:1024 lds
  buffer_load_dwordx4 v105, s[28:31], s63 offen offset:2048 lds
  buffer_load_dwordx4 v106, s[28:31], s63 offen offset:3072 lds
  s_add_u32 m0, s60, s75
  s_cmp_ge_u32 s70, 2
  s_cbranch_scc1 L_wx_17
  buffer_load_dwordx4 v107, s[28:31], s63 offen lds
L_wx_17:
  s_add_u32 s63, s63, 110592
  s_add_u32 m0, s60, s73
  s_nop 0
  buffer_load_dwordx4 v102, s[16:19], s62 offen sc1 lds
  buffer_load_dwordx4 v102, s[16:19], s62 offen offset:1024 sc1 lds
  s_add_u32 s62, s62, 131072
  s_add_u32 s60, s60, 26624
  s_cmp_eq_u32 s60, 133120
  s_cselect_b32 s60, 0, s60
  s_waitcnt vmcnt(12)
  s_barrier
  s_add_u32 m0, s60, s74
  s_nop 0
  buffer_load_dwordx4 v103, s[28:31], s63 offen lds
  buffer_load_dwordx4 v104, s[28:31], s63 offen offset:1024 lds
  buffer_load_dwordx4 v105, s[28:31], s63 offen offset:2048 lds
  buffer_load_dwordx4 v106, s[28:31], s63 offen offset:3072 lds
  s_add_u32 m0, s60, s75
  s_cmp_ge_u32 s70, 2
  s_cbranch_scc1 L_wx_18
  buffer_load_dwordx4 v107, s[28:31], s63 offen lds
L_wx_18:
  s_add_u32 s63, s63, 110592
  s_add_u32 m0, s60, s73
  s_nop 0
  buffer_load_dwordx4 v102, s[16:19], s62 offen sc1 lds
  buffer_load_dwordx4 v102, s[16:19], s62 offen offset:1024 sc1 lds
  s_add_u32 s62, s62, 131072
  s_add_u32 s60, s60, 26624
  s_cmp_eq_u32 s60, 133120
  s_cselect_b32 s60, 0, s60
  s_mov_b32 s61, 10
L_kv_ldl:
  s_waitcnt vmcnt(12)
  s_barrier
  s_add_u32 m0, s60, s74
  s_nop 0
  buffer_load_dwordx4 v103, s[28:31], s63 offen lds
  buffer_load_dwordx4 v104, s[28:31], s63 offen offset:1024 lds
  buffer_load_dwordx4 v105, s[28:31], s63 offen offset:2048 lds
  buffer_load_dwordx4 v106, s[28:31], s63 offen offset:3072 lds
  s_add_u32 m0, s60, s75
  s_cmp_ge_u32 s70, 2
  s_cbranch_scc1 L_wx_19
  buffer_load_dwordx4 v107, s[28:31], s63 offen lds
L_wx_19:
  s_add_u32 s63, s63, 110592
  s_add_u32 m0, s60, s73
  s_nop 0
  buffer_load_dwordx4 v102, s[16:19], s62 offen sc1 lds
  buffer_load_dwordx4 v102, s[16:19], s62 offen offset:1024 sc1 lds
  s_add_u32 s62, s62, 131072
  s_add_u32 s60, s60, 26624
  s_cmp_eq_u32 s60, 133120
  s_cselect_b32 s60, 0, s60
  s_sub_u32 s61, s61, 1
  s_cmp_lg_u32 s61, 0
  s_cbranch_scc1 L_kv_ldl
  s_waitcnt vmcnt(12)
  s_barrier
  s_waitcnt vmcnt(6)
  s_barrier
  s_waitcnt vmcnt(0)
  s_barrier
  s_barrier
  s_cmp_lg_u32 s3, 5
  s_cbranch_scc1 L_kv_chk_s
  s_mov_b32 s80, 27525120
  s_mov_b32 s81, 27533312
  s_mov_b32 s82, 27541504
  s_mov_b32 s83, 27549696
  s_mov_b64 s[84:85], -1
  v_lshlrev_b32 v252, 7, v1
  s_mov_b32 s68, 0x8000
L_kv_chk:
  buffer_load_dword v248, v252, s[16:19], s80 offen sc1
  buffer_load_dword v249, v252, s[16:19], s81 offen sc1
  buffer_load_dword v250, v252, s[16:19], s82 offen sc1
  buffer_load_dword v251, v252, s[16:19], s83 offen sc1
  s_waitcnt vmcnt(0)
  v_xor_b32 v248, s54, v248
  v_xor_b32 v249, s54, v249
  v_xor_b32 v250, s54, v250
  v_xor_b32 v251, s54, v251
  v_or_b32 v248, v248, v249
  v_or_b32 v248, v248, v250
  v_or_b32 v248, v248, v251
  v_cmp_ne_u32 vcc, 0, v248
  s_sub_u32 s68, s68, 1
  s_cmp_eq_u32 s68, 0
  s_cbranch_scc1 L_kv_chk_x
  s_and_b64 vcc, vcc, s[84:85]
  s_cbranch_scc0 L_kv_chk_x
  s_sleep 4
  s_branch L_kv_chk
L_kv_chk_x:
L_kv_chk_s:
  s_sub_u32 s80, s53, 24
  s_lshl_b32 s80, s80, 2
  s_add_u32 s80, s80, s70
  s_mul_i32 s81, s72, 288
  s_and_b32 s81, s81, 0xffffff80
  s_lshl_b32 s67, s80, 6
  s_add_u32 s67, s67, 0
  v_add_u32 v12, s67, v1
  s_mov_b32 s67, 1431655766
  s_mov_b32 s68, 1
  v_mov_b32 v15, 2147479552
L_kv_pfq:
  v_mul_hi_u32 v13, v12, s67
  v_mul_u32_u24 v14, 3, v13
  v_sub_u32 v14, v12, v14
  v_mul_u32_u24 v13, 3456, v13
  v_cmp_gt_u32 vcc, 1728, v12
  v_lshl_add_u32 v13, v14, 7, v13
  v_add_u32 v12, 2048, v12
  v_cndmask_b32 v13, v15, v13, vcc
  s_waitcnt vmcnt(4)
  buffer_load_dword v16, v13, s[28:31], s81 offen
  s_sub_u32 s68, s68, 1
  s_cmp_lg_u32 s68, 0
  s_cbranch_scc1 L_kv_pfq
  s_barrier
  v_lshlrev_b32 v6, 2, v1
  s_lshl_b32 s67, s70, 8
  v_add_u32 v2, s67, v6
  v_add_u32 v3, 51200, v2
  ds_read_b32 v128, v2 offset:0
  ds_read_b32 v129, v2 offset:25600
  ds_read_b32 v130, v3 offset:0
  ds_read_b32 v131, v3 offset:25600
  ds_read_b32 v132, v2 offset:1024
  ds_read_b32 v133, v2 offset:26624
  ds_read_b32 v134, v3 offset:1024
  ds_read_b32 v135, v3 offset:26624
  ds_read_b32 v136, v2 offset:2048
  ds_read_b32 v137, v2 offset:27648
  ds_read_b32 v138, v3 offset:2048
  ds_read_b32 v139, v3 offset:27648
  ds_read_b32 v140, v2 offset:3072
  ds_read_b32 v141, v2 offset:28672
  ds_read_b32 v142, v3 offset:3072
  ds_read_b32 v143, v3 offset:28672
  ds_read_b32 v144, v2 offset:4096
  ds_read_b32 v145, v2 offset:29696
  ds_read_b32 v146, v3 offset:4096
  ds_read_b32 v147, v3 offset:29696
  ds_read_b32 v148, v2 offset:5120
  ds_read_b32 v149, v2 offset:30720
  ds_read_b32 v150, v3 offset:5120
  ds_read_b32 v151, v3 offset:30720
  ds_read_b32 v152, v2 offset:6144
  ds_read_b32 v153, v2 offset:31744
  ds_read_b32 v154, v3 offset:6144
  ds_read_b32 v155, v3 offset:31744
  ds_read_b32 v156, v2 offset:7168
  ds_read_b32 v157, v2 offset:32768
  ds_read_b32 v158, v3 offset:7168
  ds_read_b32 v159, v3 offset:32768
  ds_read_b32 v160, v2 offset:8192
  ds_read_b32 v161, v2 offset:33792
  ds_read_b32 v162, v3 offset:8192
  ds_read_b32 v163, v3 offset:33792
  ds_read_b32 v164, v2 offset:9216
  ds_read_b32 v165, v2 offset:34816
  ds_read_b32 v166, v3 offset:9216
  ds_read_b32 v167, v3 offset:34816
  ds_read_b32 v168, v2 offset:10240
  ds_read_b32 v169, v2 offset:35840
  ds_read_b32 v170, v3 offset:10240
  ds_read_b32 v171, v3 offset:35840
  ds_read_b32 v172, v2 offset:11264
  ds_read_b32 v173, v2 offset:36864
  ds_read_b32 v174, v3 offset:11264
  ds_read_b32 v175, v3 offset:36864
  ds_read_b32 v176, v2 offset:12288
  ds_read_b32 v177, v2 offset:37888
  ds_read_b32 v178, v3 offset:12288
  ds_read_b32 v179, v3 offset:37888
  ds_read_b32 v180, v2 offset:13312
  ds_read_b32 v181, v2 offset:38912
  ds_read_b32 v182, v3 offset:13312
  ds_read_b32 v183, v3 offset:38912
  ds_read_b32 v184, v2 offset:14336
  ds_read_b32 v185, v2 offset:39936
  ds_read_b32 v186, v3 offset:14336
  ds_read_b32 v187, v3 offset:39936
  ds_read_b32 v188, v2 offset:15360
  ds_read_b32 v189, v2 offset:40960
  ds_read_b32 v190, v3 offset:15360
  ds_read_b32 v191, v3 offset:40960
  ds_read_b32 v192, v2 offset:16384
  ds_read_b32 v193, v2 offset:41984
  ds_read_b32 v194, v3 offset:16384
  ds_read_b32 v195, v3 offset:41984
  ds_read_b32 v196, v2 offset:17408
  ds_read_b32 v197, v2 offset:43008
  ds_read_b32 v198, v3 offset:17408
  ds_read_b32 v199, v3 offset:43008
  ds_read_b32 v200, v2 offset:18432
  ds_read_b32 v201, v2 offset:44032
  ds_read_b32 v202, v3 offset:18432
  ds_read_b32 v203, v3 offset:44032
  ds_read_b32 v204, v2 offset:19456
  ds_read_b32 v205, v2 offset:45056
  ds_read_b32 v206, v3 offset:19456
  ds_read_b32 v207, v3 offset:45056
  ds_read_b32 v208, v2 offset:20480
  ds_read_b32 v209, v2 offset:46080
  ds_read_b32 v210, v3 offset:20480
  ds_read_b32 v211, v3 offset:46080
  ds_read_b32 v212, v2 offset:21504
  ds_read_b32 v213, v2 offset:47104
  ds_read_b32 v214, v3 offset:21504
  ds_read_b32 v215, v3 offset:47104
  ds_read_b32 v216, v2 offset:22528
  ds_read_b32 v217, v2 offset:48128
  ds_read_b32 v218, v3 offset:22528
  ds_read_b32 v219, v3 offset:48128
  ds_read_b32 v220, v2 offset:23552
  ds_read_b32 v221, v2 offset:49152
  ds_read_b32 v222, v3 offset:23552
  ds_read_b32 v223, v3 offset:49152
  ds_read_b32 v224, v2 offset:24576
  ds_read_b32 v225, v2 offset:50176
  ds_read_b32 v226, v3 offset:24576
  ds_read_b32 v227, v3 offset:50176
  v_add_u32 v8, 102400, v2
  ds_read_b32 v228, v8 offset:0
  ds_read_b32 v229, v8 offset:576
  ds_read_b32 v230, v8 offset:1152
  ds_read_b32 v231, v8 offset:1728
  s_waitcnt lgkmcnt(0)
  s_barrier
  s_lshl_b32 s73, s70, 11
  s_lshl_b32 s74, s70, 10
  s_add_u32 s74, s74, 8192
  s_lshl_b32 s62, s71, 13
  s_add_u32 s62, s62, s73
  s_add_u32 s62, s62, 2359296
  s_mul_i32 s63, s72, 288
  s_mov_b32 s60, 0
  s_add_u32 s67, s60, s74
  s_add_u32 m0, s67, 0
  s_nop 0
  buffer_load_dwordx4 v96, s[28:31], s63 offen lds
  s_add_u32 m0, s67, 4096
  s_nop 0
  buffer_load_dwordx4 v97, s[28:31], s63 offen lds
  s_add_u32 m0, s67, 8192
  s_cmp_ge_u32 s70, 2
  s_cbranch_scc1 L_wx_20
  buffer_load_dwordx4 v98, s[28:31], s63 offen lds
L_wx_20:
  s_add_u32 s63, s63, 110592
  s_add_u32 s60, s60, 18432
  s_cmp_eq_u32 s60, 92160
  s_cselect_b32 s60, 0, s60
  s_add_u32 s67, s60, s74
  s_add_u32 m0, s67, 0
  s_nop 0
  buffer_load_dwordx4 v96, s[28:31], s63 offen lds
  s_add_u32 m0, s67, 4096
  s_nop 0
  buffer_load_dwordx4 v97, s[28:31], s63 offen lds
  s_add_u32 m0, s67, 8192
  s_cmp_ge_u32 s70, 2
  s_cbranch_scc1 L_wx_21
  buffer_load_dwordx4 v98, s[28:31], s63 offen lds
L_wx_21:
  s_add_u32 s63, s63, 110592
  s_add_u32 s60, s60, 18432
  s_cmp_eq_u32 s60, 92160
  s_cselect_b32 s60, 0, s60
  s_add_u32 s67, s60, s74
  s_add_u32 m0, s67, 0
  s_nop 0
  buffer_load_dwordx4 v96, s[28:31], s63 offen lds
  s_add_u32 m0, s67, 4096
  s_nop 0
  buffer_load_dwordx4 v97, s[28:31], s63 offen lds
  s_add_u32 m0, s67, 8192
  s_cmp_ge_u32 s70, 2
  s_cbranch_scc1 L_wx_22
  buffer_load_dwordx4 v98, s[28:31], s63 offen lds
L_wx_22:
  s_add_u32 s63, s63, 110592
  s_add_u32 s60, s60, 18432
  s_cmp_eq_u32 s60, 92160
  s_cselect_b32 s60, 0, s60
  s_add_u32 s67, s60, s74
  s_add_u32 m0, s67, 0
  s_nop 0
  buffer_load_dwordx4 v96, s[28:31], s63 offen lds
  s_add_u32 m0, s67, 4096
  s_nop 0
  buffer_load_dwordx4 v97, s[28:31], s63 offen lds
  s_add_u32 m0, s67, 8192
  s_cmp_ge_u32 s70, 2
  s_cbranch_scc1 L_wx_23
  buffer_load_dwordx4 v98, s[28:31], s63 offen lds
L_wx_23:
  s_add_u32 s63, s63, 110592
  s_add_u32 s60, s60, 18432
  s_cmp_eq_u32 s60, 92160
  s_cselect_b32 s60, 0, s60
  s_add_u32 s67, s60, s74
  s_add_u32 m0, s67, 0
  s_nop 0
  buffer_load_dwordx4 v96, s[28:31], s63 offen lds
  s_add_u32 m0, s67, 4096
  s_nop 0
  buffer_load_dwordx4 v97, s[28:31], s63 offen lds
  s_add_u32 m0, s67, 8192
  s_cmp_ge_u32 s70, 2
  s_cbranch_scc1 L_wx_24
  buffer_load_dwordx4 v98, s[28:31], s63 offen lds
L_wx_24:
  s_add_u32 s63, s63, 110592
  s_add_u32 s60, s60, 18432
  s_cmp_eq_u32 s60, 92160
  s_cselect_b32 s60, 0, s60
  s_add_u32 m0, s60, s73
  s_nop 0
  buffer_load_dwordx4 v102, s[16:19], s62 offen sc1 lds
  buffer_load_dwordx4 v102, s[16:19], s62 offen offset:1024 sc1 lds
  s_add_u32 s62, s62, 131072
  s_add_u32 s60, s60, 18432
  s_cmp_eq_u32 s60, 92160
  s_cselect_b32 s60, 0, s60
  s_add_u32 m0, s60, s73
  s_nop 0
  buffer_load_dwordx4 v102, s[16:19], s62 offen sc1 lds
  buffer_load_dwordx4 v102, s[16:19], s62 offen offset:1024 sc1 lds
  s_add_u32 s62, s62, 131072
  s_add_u32 s60, s60, 18432
  s_cmp_eq_u32 s60, 92160
  s_cselect_b32 s60, 0, s60
  s_add_u32 m0, s60, s73
  s_nop 0
  buffer_load_dwordx4 v102, s[16:19], s62 offen sc1 lds
  buffer_load_dwordx4 v102, s[16:19], s62 offen offset:1024 sc1 lds
  s_add_u32 s62, s62, 131072
  s_add_u32 s60, s60, 18432
  s_cmp_eq_u32 s60, 92160
  s_cselect_b32 s60, 0, s60
  s_add_u32 m0, s60, s73
  s_nop 0
  buffer_load_dwordx4 v102, s[16:19], s62 offen sc1 lds
  buffer_load_dwordx4 v102, s[16:19], s62 offen offset:1024 sc1 lds
  s_add_u32 s62, s62, 131072
  s_add_u32 s60, s60, 18432
  s_cmp_eq_u32 s60, 92160
  s_cselect_b32 s60, 0, s60
  s_add_u32 m0, s60, s73
  s_nop 0
  buffer_load_dwordx4 v102, s[16:19], s62 offen sc1 lds
  buffer_load_dwordx4 v102, s[16:19], s62 offen offset:1024 sc1 lds
  s_add_u32 s62, s62, 131072
  s_add_u32 s60, s60, 18432
  s_cmp_eq_u32 s60, 92160
  s_cselect_b32 s60, 0, s60
  s_and_b32 s79, s52, 3
  s_lshl_b32 s79, s79, 15
  s_add_u32 s79, s79, 27262976
  v_pk_add_f32 v[128:129], v[128:129], v[130:131]
  s_add_u32 s84, s79, 0
  v_add_f32 v128, v128, v129
  buffer_atomic_add_f32 v128, v56, s[16:19], s84 offen offset:0
  v_pk_add_f32 v[132:133], v[132:133], v[134:135]
  v_add_f32 v132, v132, v133
  buffer_atomic_add_f32 v132, v57, s[16:19], s84 offen offset:1024
  v_pk_add_f32 v[136:137], v[136:137], v[138:139]
  v_add_f32 v136, v136, v137
  buffer_atomic_add_f32 v136, v58, s[16:19], s84 offen offset:2048
  v_pk_add_f32 v[140:141], v[140:141], v[142:143]
  v_add_f32 v140, v140, v141
  buffer_atomic_add_f32 v140, v59, s[16:19], s84 offen offset:3072
  v_pk_add_f32 v[144:145], v[144:145], v[146:147]
  s_add_u32 s84, s79, 4096
  v_add_f32 v144, v144, v145
  buffer_atomic_add_f32 v144, v60, s[16:19], s84 offen offset:0
  v_pk_add_f32 v[148:149], v[148:149], v[150:151]
  v_add_f32 v148, v148, v149
  buffer_atomic_add_f32 v148, v61, s[16:19], s84 offen offset:1024
  v_pk_add_f32 v[152:153], v[152:153], v[154:155]
  v_add_f32 v152, v152, v153
  buffer_atomic_add_f32 v152, v62, s[16:19], s84 offen offset:2048
  v_pk_add_f32 v[156:157], v[156:157], v[158:159]
  v_add_f32 v156, v156, v157
  buffer_atomic_add_f32 v156, v63, s[16:19], s84 offen offset:3072
  v_pk_add_f32 v[160:161], v[160:161], v[162:163]
  s_add_u32 s84, s79, 8192
  v_add_f32 v160, v160, v161
  buffer_atomic_add_f32 v160, v64, s[16:19], s84 offen offset:0
  v_pk_add_f32 v[164:165], v[164:165], v[166:167]
  v_add_f32 v164, v164, v165
  buffer_atomic_add_f32 v164, v65, s[16:19], s84 offen offset:1024
  v_pk_add_f32 v[168:169], v[168:169], v[170:171]
  v_add_f32 v168, v168, v169
  buffer_atomic_add_f32 v168, v66, s[16:19], s84 offen offset:2048
  v_pk_add_f32 v[172:173], v[172:173], v[174:175]
  v_add_f32 v172, v172, v173
  buffer_atomic_add_f32 v172, v67, s[16:19], s84 offen offset:3072
  v_pk_add_f32 v[176:177], v[176:177], v[178:179]
  s_add_u32 s84, s79, 12288
  v_add_f32 v176, v176, v177
  buffer_atomic_add_f32 v176, v68, s[16:19], s84 offen offset:0
  v_pk_add_f32 v[180:181], v[180:181], v[182:183]
  v_add_f32 v180, v180, v181
  buffer_atomic_add_f32 v180, v69, s[16:19], s84 offen offset:1024
  v_pk_add_f32 v[184:185], v[184:185], v[186:187]
  v_add_f32 v184, v184, v185
  buffer_atomic_add_f32 v184, v70, s[16:19], s84 offen offset:2048
  v_pk_add_f32 v[188:189], v[188:189], v[190:191]
  v_add_f32 v188, v188, v189
  buffer_atomic_add_f32 v188, v71, s[16:19], s84 offen offset:3072
  v_pk_add_f32 v[192:193], v[192:193], v[194:195]
  s_add_u32 s84, s79, 16384
  v_add_f32 v192, v192, v193
  buffer_atomic_add_f32 v192, v72, s[16:19], s84 offen offset:0
  v_pk_add_f32 v[196:197], v[196:197], v[198:199]
  v_add_f32 v196, v196, v197
  buffer_atomic_add_f32 v196, v73, s[16:19], s84 offen offset:1024
  v_pk_add_f32 v[200:201], v[200:201], v[202:203]
  v_add_f32 v200, v200, v201
  buffer_atomic_add_f32 v200, v74, s[16:19], s84 offen offset:2048
  v_pk_add_f32 v[204:205], v[204:205], v[206:207]
  v_add_f32 v204, v204, v205
  buffer_atomic_add_f32 v204, v75, s[16:19], s84 offen offset:3072
  v_pk_add_f32 v[208:209], v[208:209], v[210:211]
  s_add_u32 s84, s79, 20480
  v_add_f32 v208, v208, v209
  buffer_atomic_add_f32 v208, v76, s[16:19], s84 offen offset:0
  v_pk_add_f32 v[212:213], v[212:213], v[214:215]
  v_add_f32 v212, v212, v213
  buffer_atomic_add_f32 v212, v77, s[16:19], s84 offen offset:1024
  v_pk_add_f32 v[216:217], v[216:217], v[218:219]
  v_add_f32 v216, v216, v217
  buffer_atomic_add_f32 v216, v78, s[16:19], s84 offen offset:2048
  v_pk_add_f32 v[220:221], v[220:221], v[222:223]
  v_add_f32 v220, v220, v221
  buffer_atomic_add_f32 v220, v79, s[16:19], s84 offen offset:3072
  v_pk_add_f32 v[224:225], v[224:225], v[226:227]
  s_add_u32 s84, s79, 24576
  v_add_f32 v224, v224, v225
  buffer_atomic_add_f32 v224, v80, s[16:19], s84 offen offset:0
  v_pk_add_f32 v[228:229], v[228:229], v[230:231]
  v_add_f32 v228, v228, v229
  buffer_atomic_add_f32 v228, v81, s[16:19], s84 offen offset:1024
  s_waitcnt vmcnt(34)
  s_barrier
  s_waitcnt vmcnt(32)
  s_barrier
  s_waitcnt vmcnt(30)
  s_barrier
  s_add_u32 s67, s60, s74
  s_add_u32 m0, s67, 0
  s_nop 0
  buffer_load_dwordx4 v96, s[28:31], s63 offen lds
  s_add_u32 m0, s67, 4096
  s_nop 0
  buffer_load_dwordx4 v97, s[28:31], s63 offen lds
  s_add_u32 m0, s67, 8192
  s_cmp_ge_u32 s70, 2
  s_cbranch_scc1 L_wx_25
  buffer_load_dwordx4 v98, s[28:31], s63 offen lds
L_wx_25:
  s_add_u32 s63, s63, 110592
  s_add_u32 m0, s60, s73
  s_nop 0
  buffer_load_dwordx4 v102, s[16:19], s62 offen sc1 lds
  buffer_load_dwordx4 v102, s[16:19], s62 offen offset:1024 sc1 lds
  s_add_u32 s62, s62, 131072
  s_add_u32 s60, s60, 18432
  s_cmp_eq_u32 s60, 92160
  s_cselect_b32 s60, 0, s60
  s_waitcnt vmcnt(32)
  s_barrier
  s_add_u32 s67, s60, s74
  s_add_u32 m0, s67, 0
  s_nop 0
  buffer_load_dwordx4 v96, s[28:31], s63 offen lds
  s_add_u32 m0, s67, 4096
  s_nop 0
  buffer_load_dwordx4 v97, s[28:31], s63 offen lds
  s_add_u32 m0, s67, 8192
  s_cmp_ge_u32 s70, 2
  s_cbranch_scc1 L_wx_26
  buffer_load_dwordx4 v98, s[28:31], s63 offen lds
L_wx_26:
  s_add_u32 s63, s63, 110592
  s_add_u32 m0, s60, s73
  s_nop 0
  buffer_load_dwordx4 v102, s[16:19], s62 offen sc1 lds
  buffer_load_dwordx4 v102, s[16:19], s62 offen offset:1024 sc1 lds
  s_add_u32 s62, s62, 131072
  s_add_u32 s60, s60, 18432
  s_cmp_eq_u32 s60, 92160
  s_cselect_b32 s60, 0, s60
  s_waitcnt vmcnt(34)
  s_barrier
  s_add_u32 s67, s60, s74
  s_add_u32 m0, s67, 0
  s_nop 0
  buffer_load_dwordx4 v96, s[28:31], s63 offen lds
  s_add_u32 m0, s67, 4096
  s_nop 0
  buffer_load_dwordx4 v97, s[28:31], s63 offen lds
  s_add_u32 m0, s67, 8192
  s_cmp_ge_u32 s70, 2
  s_cbranch_scc1 L_wx_27
  buffer_load_dwordx4 v98, s[28:31], s63 offen lds
L_wx_27:
  s_add_u32 s63, s63, 110592
  s_add_u32 m0, s60, s73
  s_nop 0
  buffer_load_dwordx4 v102, s[16:19], s62 offen sc1 lds
  buffer_load_dwordx4 v102, s[16:19], s62 offen offset:1024 sc1 lds
  s_add_u32 s62, s62, 131072
  s_add_u32 s60, s60, 18432
  s_cmp_eq_u32 s60, 92160
  s_cselect_b32 s60, 0, s60
  s_waitcnt vmcnt(8)
  s_barrier
  s_add_u32 s67, s60, s74
  s_add_u32 m0, s67, 0
  s_nop 0
  buffer_load_dwordx4 v96, s[28:31], s63 offen lds
  s_add_u32 m0, s67, 4096
  s_nop 0
  buffer_load_dwordx4 v97, s[28:31], s63 offen lds
  s_add_u32 m0, s67, 8192
  s_cmp_ge_u32 s70, 2
  s_cbranch_scc1 L_wx_28
  buffer_load_dwordx4 v98, s[28:31], s63 offen lds
L_wx_28:
  s_add_u32 s63, s63, 110592
  s_add_u32 m0, s60, s73
  s_nop 0
  buffer_load_dwordx4 v102, s[16:19], s62 offen sc1 lds
  buffer_load_dwordx4 v102, s[16:19], s62 offen offset:1024 sc1 lds
  s_add_u32 s62, s62, 131072
  s_add_u32 s60, s60, 18432
  s_cmp_eq_u32 s60, 92160
  s_cselect_b32 s60, 0, s60
  v_mov_b32 v4, 163812
  v_mov_b32 v5, 1
  s_mov_b64 exec, 1
  ds_add_rtn_u32 v5, v4, v5
  s_sub_u32 s67, s2, 192
  s_lshl_b32 s67, s67, 7
  s_add_u32 s67, s67, 27590656
  s_waitcnt lgkmcnt(0)
  v_readfirstlane_b32 s68, v5
  s_mov_b64 exec, -1
  s_cmp_lg_u32 s68, 3
  s_cbranch_scc1 L_pub1l
  v_mov_b32 v4, s54
  v_lshlrev_b32 v5, 2, v1
  s_mov_b64 exec, 1
  buffer_store_dword v4, v5, s[16:19], s67 offen sc1
  s_mov_b64 exec, -1
L_pub1l:
  s_mov_b32 s61, 9
L_a1_ld:
  s_waitcnt vmcnt(8)
  s_barrier
  s_add_u32 s67, s60, s74
  s_add_u32 m0, s67, 0
  s_nop 0
  buffer_load_dwordx4 v96, s[28:31], s63 offen lds
  s_add_u32 m0, s67, 4096
  s_nop 0
  buffer_load_dwordx4 v97, s[28:31], s63 offen lds
  s_add_u32 m0, s67, 8192
  s_cmp_ge_u32 s70, 2
  s_cbranch_scc1 L_wx_29
  buffer_load_dwordx4 v98, s[28:31], s63 offen lds
L_wx_29:
  s_add_u32 s63, s63, 110592
  s_add_u32 m0, s60, s73
  s_nop 0
  buffer_load_dwordx4 v102, s[16:19], s62 offen sc1 lds
  buffer_load_dwordx4 v102, s[16:19], s62 offen offset:1024 sc1 lds
  s_add_u32 s62, s62, 131072
  s_add_u32 s60, s60, 18432
  s_cmp_eq_u32 s60, 92160
  s_cselect_b32 s60, 0, s60
  s_sub_u32 s61, s61, 1
  s_cmp_lg_u32 s61, 0
  s_cbranch_scc1 L_a1_ld
  s_waitcnt vmcnt(8)
  s_barrier
  s_waitcnt vmcnt(4)
  s_barrier
  s_waitcnt vmcnt(0)
  s_barrier
  s_mov_b32 s84, 0x11111111
  s_lshl_b32 s84, s84, s72
  s_mov_b32 s85, s84
  s_mov_b32 s83, 27590656
  v_lshlrev_b32 v11, 7, v1
  s_mov_b32 s68, 0x8000
L_a_pkv:
  buffer_load_dword v10, v11, s[16:19], s83 offen sc1
  s_waitcnt vmcnt(0)
  v_xor_b32 v10, s54, v10
  v_cmp_ne_u32 vcc, 0, v10
  s_sub_u32 s68, s68, 1
  s_cmp_eq_u32 s68, 0
  s_cbranch_scc1 L_a_pkv_x
  s_and_b64 vcc, vcc, s[84:85]
  s_cbranch_scc0 L_a_pkv_x
  s_sleep 2
  s_branch L_a_pkv
L_a_pkv_x:
  s_lshl_b32 s75, s72, 15
  s_add_u32 s75, s75, 27262976
  s_add_u32 s76, s75, 25600
  v_lshrrev_b32 v9, 4, v1
  v_lshlrev_b32 v9, 4, v9
  v_add_u32 v8, 94208, v102
  s_cmp_lg_u32 s70, 0
  s_cbranch_scc1 L_bp1
  s_add_u32 s77, s75, 0
  buffer_load_dwordx4 v[128:131], v102, s[16:19], s77 offen sc1
  s_add_u32 s77, s75, 2048
  buffer_load_dwordx4 v[132:135], v102, s[16:19], s77 offen sc1
  s_add_u32 s77, s75, 10240
  buffer_load_dwordx4 v[136:139], v102, s[16:19], s77 offen sc1
  s_add_u32 s77, s75, 12288
  buffer_load_dwordx4 v[140:143], v102, s[16:19], s77 offen sc1
  s_add_u32 s77, s75, 14336
  buffer_load_dwordx4 v[144:147], v102, s[16:19], s77 offen sc1
  s_add_u32 s77, s75, 22528
  buffer_load_dwordx4 v[148:151], v102, s[16:19], s77 offen sc1
  s_add_u32 s77, s75, 24576
  buffer_load_dwordx4 v[152:155], v102, s[16:19], s77 offen sc1
  buffer_load_dwordx4 v[176:179], v9, s[16:19], s76 offen offset:0 sc1
  buffer_load_dwordx4 v[180:183], v9, s[16:19], s76 offen offset:64 sc1
  buffer_load_dwordx4 v[184:187], v9, s[16:19], s76 offen offset:192 sc1
  buffer_load_dwordx4 v[188:191], v9, s[16:19], s76 offen offset:256 sc1
  buffer_load_dwordx4 v[192:195], v9, s[16:19], s76 offen offset:320 sc1
  buffer_load_dwordx4 v[196:199], v9, s[16:19], s76 offen offset:448 sc1
  buffer_load_dwordx4 v[200:203], v9, s[16:19], s76 offen offset:512 sc1
  s_waitcnt vmcnt(0)
  v_cvt_pk_bf16_f32 v12, v128, v129
  v_cvt_pk_bf16_f32 v13, v130, v131
  v_cvt_pk_bf16_f32 v16, v176, v177
  v_cvt_pk_bf16_f32 v17, v178, v179
  v_cvt_pk_bf16_f32 v14, v132, v133
  v_cvt_pk_bf16_f32 v15, v134, v135
  s_mov_b32 s80, 0xffff
  s_mov_b32 s81, 0x0
  v_cndmask_b32 v4, 0, v180, s[80:81]
  s_mov_b32 s82, 0xffff
  s_mov_b32 s83, 0x0
  v_cndmask_b32 v5, 0, v181, s[82:83]
  v_cvt_pk_bf16_f32 v18, v4, v5
  v_cvt_pk_bf16_f32 v19, 0, 0
  ds_write_b128 v8, v[12:15] offset:0
  ds_write_b128 v8, v[16:19] offset:1024
  v_mov_b32 v20, 0
  v_mov_b32 v21, 0
  v_mov_b32 v24, 0
  v_mov_b32 v25, 0
  v_cvt_pk_bf16_f32 v22, v136, v137
  v_cvt_pk_bf16_f32 v23, v138, v139
  s_mov_b32 s80, 0x0
  s_mov_b32 s81, 0xff00ff
  v_cndmask_b32 v4, 0, v184, s[80:81]
  s_mov_b32 s82, 0x0
  s_mov_b32 s83, 0xff00ff
  v_cndmask_b32 v5, 0, v185, s[82:83]
  s_mov_b32 s80, 0xff0000
  s_mov_b32 s81, 0xff00ff
  v_cndmask_b32 v6, 0, v186, s[80:81]
  s_mov_b32 s82, 0xff0000
  s_mov_b32 s83, 0xff00ff
  v_cndmask_b32 v7, 0, v187, s[82:83]
  v_cvt_pk_bf16_f32 v26, v4, v5
  v_cvt_pk_bf16_f32 v27, v6, v7
  ds_write_b128 v8, v[20:23] offset:16384
  ds_write_b128 v8, v[24:27] offset:17408
  v_cvt_pk_bf16_f32 v28, v140, v141
  v_cvt_pk_bf16_f32 v29, v142, v143
  s_mov_b32 s80, 0xff00ff
  s_mov_b32 s81, 0xff00ff00
  v_cndmask_b32 v4, 0, v188, s[80:81]
  s_mov_b32 s82, 0xff00ff
  s_mov_b32 s83, 0xff00ff00
  v_cndmask_b32 v5, 0, v189, s[82:83]
  s_mov_b32 s80, 0xff00ff
  s_mov_b32 s81, 0xff00ff00
  v_cndmask_b32 v6, 0, v190, s[80:81]
  s_mov_b32 s82, 0xff00ff
  s_mov_b32 s83, 0xff00ff00
  v_cndmask_b32 v7, 0, v191, s[82:83]
  v_cvt_pk_bf16_f32 v32, v4, v5
  v_cvt_pk_bf16_f32 v33, v6, v7
  v_cvt_pk_bf16_f32 v30, v144, v145
  v_cvt_pk_bf16_f32 v31, v146, v147
  s_mov_b32 s80, 0xff00ff00
  s_mov_b32 s81, 0xff00
  v_cndmask_b32 v4, 0, v192, s[80:81]
  s_mov_b32 s82, 0xff00ff00
  s_mov_b32 s83, 0xff00
  v_cndmask_b32 v5, 0, v193, s[82:83]
  s_mov_b32 s80, 0xff00ff00
  s_mov_b32 s81, 0x0
  v_cndmask_b32 v6, 0, v194, s[80:81]
  s_mov_b32 s82, 0xff00ff00
  s_mov_b32 s83, 0x0
  v_cndmask_b32 v7, 0, v195, s[82:83]
  v_cvt_pk_bf16_f32 v34, v4, v5
  v_cvt_pk_bf16_f32 v35, v6, v7
  ds_write_b128 v8, v[28:31] offset:18432
  ds_write_b128 v8, v[32:35] offset:19456
  v_mov_b32 v36, 0
  v_mov_b32 v37, 0
  v_mov_b32 v40, 0
  v_mov_b32 v41, 0
  v_cvt_pk_bf16_f32 v38, v148, v149
  v_cvt_pk_bf16_f32 v39, v150, v151
  s_mov_b32 s80, 0x0
  s_mov_b32 s81, 0xffff0000
  v_cndmask_b32 v6, 0, v198, s[80:81]
  s_mov_b32 s82, 0x0
  s_mov_b32 s83, 0xffff0000
  v_cndmask_b32 v7, 0, v199, s[82:83]
  v_cvt_pk_bf16_f32 v42, 0, 0
  v_cvt_pk_bf16_f32 v43, v6, v7
  ds_write_b128 v8, v[36:39] offset:32768
  ds_write_b128 v8, v[40:43] offset:33792
  v_cvt_pk_bf16_f32 v44, v152, v153
  v_cvt_pk_bf16_f32 v45, v154, v155
  v_cvt_pk_bf16_f32 v48, v200, v201
  v_cvt_pk_bf16_f32 v49, v202, v203
  v_mov_b32 v46, 0
  v_mov_b32 v47, 0
  v_mov_b32 v50, 0
  v_mov_b32 v51, 0
  ds_write_b128 v8, v[44:47] offset:34816
  ds_write_b128 v8, v[48:51] offset:35840
  s_branch L_bp_done
L_bp1:
  s_cmp_lg_u32 s70, 1
  s_cbranch_scc1 L_bp2
  s_add_u32 s77, s75, 1024
  buffer_load_dwordx4 v[128:131], v102, s[16:19], s77 offen sc1
  s_add_u32 s77, s75, 3072
  buffer_load_dwordx4 v[132:135], v102, s[16:19], s77 offen sc1
  s_add_u32 s77, s75, 5120
  buffer_load_dwordx4 v[136:139], v102, s[16:19], s77 offen sc1
  s_add_u32 s77, s75, 13312
  buffer_load_dwordx4 v[140:143], v102, s[16:19], s77 offen sc1
  s_add_u32 s77, s75, 15360
  buffer_load_dwordx4 v[144:147], v102, s[16:19], s77 offen sc1
  s_add_u32 s77, s75, 17408
  buffer_load_dwordx4 v[148:151], v102, s[16:19], s77 offen sc1
  buffer_load_dwordx4 v[176:179], v9, s[16:19], s76 offen offset:0 sc1
  buffer_load_dwordx4 v[180:183], v9, s[16:19], s76 offen offset:64 sc1
  buffer_load_dwordx4 v[184:187], v9, s[16:19], s76 offen offset:128 sc1
  buffer_load_dwordx4 v[188:191], v9, s[16:19], s76 offen offset:256 sc1
  buffer_load_dwordx4 v[192:195], v9, s[16:19], s76 offen offset:320 sc1
  buffer_load_dwordx4 v[196:199], v9, s[16:19], s76 offen offset:384 sc1
  s_waitcnt vmcnt(0)
  v_cvt_pk_bf16_f32 v12, v128, v129
  v_cvt_pk_bf16_f32 v13, v130, v131
  s_mov_b32 s80, 0x30003
  s_mov_b32 s81, 0x30003
  v_cndmask_b32 v4, 0, v176, s[80:81]
  s_mov_b32 s82, 0x30003
  s_mov_b32 s83, 0x30003
  v_cndmask_b32 v5, 0, v177, s[82:83]
  s_mov_b32 s80, 0x30003
  s_mov_b32 s81, 0x30003
  v_cndmask_b32 v6, 0, v178, s[80:81]
  s_mov_b32 s82, 0x30003
  s_mov_b32 s83, 0x30003
  v_cndmask_b32 v7, 0, v179, s[82:83]
  v_cvt_pk_bf16_f32 v16, v4, v5
  v_cvt_pk_bf16_f32 v17, v6, v7
  v_cvt_pk_bf16_f32 v14, v132, v133
  v_cvt_pk_bf16_f32 v15, v134, v135
  s_mov_b32 s80, 0xfffc0003
  s_mov_b32 s81, 0xfffcfffc
  v_cndmask_b32 v4, 0, v180, s[80:81]
  s_mov_b32 s82, 0xfffc0003
  s_mov_b32 s83, 0xfffcfffc
  v_cndmask_b32 v5, 0, v181, s[82:83]
  s_mov_b32 s80, 0xfffcfffc
  s_mov_b32 s81, 0xfffcfffc
  v_cndmask_b32 v6, 0, v182, s[80:81]
  s_mov_b32 s82, 0xfffcfffc
  s_mov_b32 s83, 0xfffcfffc
  v_cndmask_b32 v7, 0, v183, s[82:83]
  v_cvt_pk_bf16_f32 v18, v4, v5
  v_cvt_pk_bf16_f32 v19, v6, v7
  ds_write_b128 v8, v[12:15] offset:4096
  ds_write_b128 v8, v[16:19] offset:5120
  v_cvt_pk_bf16_f32 v20, v136, v137
  v_cvt_pk_bf16_f32 v21, v138, v139
  s_mov_b32 s80, 0xfffc
  s_mov_b32 s81, 0x0
  v_cndmask_b32 v4, 0, v184, s[80:81]
  s_mov_b32 s82, 0xfffc
  s_mov_b32 s83, 0x0
  v_cndmask_b32 v5, 0, v185, s[82:83]
  s_mov_b32 s80, 0xfffc
  s_mov_b32 s81, 0x0
  v_cndmask_b32 v6, 0, v186, s[80:81]
  s_mov_b32 s82, 0xfffc
  s_mov_b32 s83, 0x0
  v_cndmask_b32 v7, 0, v187, s[82:83]
  v_cvt_pk_bf16_f32 v24, v4, v5
  v_cvt_pk_bf16_f32 v25, v6, v7
  v_mov_b32 v22, 0
  v_mov_b32 v23, 0
  v_mov_b32 v26, 0
  v_mov_b32 v27, 0
  ds_write_b128 v8, v[20:23] offset:6144
  ds_write_b128 v8, v[24:27] offset:7168
  v_cvt_pk_bf16_f32 v28, v140, v141
  v_cvt_pk_bf16_f32 v29, v142, v143
  s_mov_b32 s80, 0x0
  s_mov_b32 s81, 0x3ff03ff
  v_cndmask_b32 v4, 0, v188, s[80:81]
  s_mov_b32 s82, 0x0
  s_mov_b32 s83, 0x3ff03ff
  v_cndmask_b32 v5, 0, v189, s[82:83]
  s_mov_b32 s80, 0x0
  s_mov_b32 s81, 0x3ff03ff
  v_cndmask_b32 v6, 0, v190, s[80:81]
  s_mov_b32 s82, 0x0
  s_mov_b32 s83, 0x3ff03ff
  v_cndmask_b32 v7, 0, v191, s[82:83]
  v_cvt_pk_bf16_f32 v32, v4, v5
  v_cvt_pk_bf16_f32 v33, v6, v7
  v_cvt_pk_bf16_f32 v30, v144, v145
  v_cvt_pk_bf16_f32 v31, v146, v147
  s_mov_b32 s80, 0x3ff03ff
  s_mov_b32 s81, 0xfc0003ff
  v_cndmask_b32 v4, 0, v192, s[80:81]
  s_mov_b32 s82, 0x3ff03ff
  s_mov_b32 s83, 0xfc0003ff
  v_cndmask_b32 v5, 0, v193, s[82:83]
  s_mov_b32 s80, 0x3ff03ff
  s_mov_b32 s81, 0xfc00fc00
  v_cndmask_b32 v6, 0, v194, s[80:81]
  s_mov_b32 s82, 0x3ff03ff
  s_mov_b32 s83, 0xfc00fc00
  v_cndmask_b32 v7, 0, v195, s[82:83]
  v_cvt_pk_bf16_f32 v34, v4, v5
  v_cvt_pk_bf16_f32 v35, v6, v7
  ds_write_b128 v8, v[28:31] offset:20480
  ds_write_b128 v8, v[32:35] offset:21504
  v_cvt_pk_bf16_f32 v36, v148, v149
  v_cvt_pk_bf16_f32 v37, v150, v151
  s_mov_b32 s80, 0xfc00fc00
  s_mov_b32 s81, 0xfc00
  v_cndmask_b32 v4, 0, v196, s[80:81]
  s_mov_b32 s82, 0xfc00fc00
  s_mov_b32 s83, 0xfc00
  v_cndmask_b32 v5, 0, v197, s[82:83]
  s_mov_b32 s80, 0xfc00fc00
  s_mov_b32 s81, 0xfc00
  v_cndmask_b32 v6, 0, v198, s[80:81]
  s_mov_b32 s82, 0xfc00fc00
  s_mov_b32 s83, 0xfc00
  v_cndmask_b32 v7, 0, v199, s[82:83]
  v_cvt_pk_bf16_f32 v40, v4, v5
  v_cvt_pk_bf16_f32 v41, v6, v7
  v_mov_b32 v38, 0
  v_mov_b32 v39, 0
  v_mov_b32 v42, 0
  v_mov_b32 v43, 0
  ds_write_b128 v8, v[36:39] offset:22528
  ds_write_b128 v8, v[40:43] offset:23552
  s_branch L_bp_done
L_bp2:
  s_cmp_lg_u32 s70, 2
  s_cbranch_scc1 L_bp3
  s_add_u32 s77, s75, 4096
  buffer_load_dwordx4 v[128:131], v102, s[16:19], s77 offen sc1
  s_add_u32 s77, s75, 6144
  buffer_load_dwordx4 v[132:135], v102, s[16:19], s77 offen sc1
  s_add_u32 s77, s75, 8192
  buffer_load_dwordx4 v[136:139], v102, s[16:19], s77 offen sc1
  s_add_u32 s77, s75, 16384
  buffer_load_dwordx4 v[140:143], v102, s[16:19], s77 offen sc1
  s_add_u32 s77, s75, 18432
  buffer_load_dwordx4 v[144:147], v102, s[16:19], s77 offen sc1
  s_add_u32 s77, s75, 20480
  buffer_load_dwordx4 v[148:151], v102, s[16:19], s77 offen sc1
  buffer_load_dwordx4 v[176:179], v9, s[16:19], s76 offen offset:64 sc1
  buffer_load_dwordx4 v[180:183], v9, s[16:19], s76 offen offset:128 sc1
  buffer_load_dwordx4 v[184:187], v9, s[16:19], s76 offen offset:192 sc1
  buffer_load_dwordx4 v[188:191], v9, s[16:19], s76 offen offset:320 sc1
  buffer_load_dwordx4 v[192:195], v9, s[16:19], s76 offen offset:384 sc1
  buffer_load_dwordx4 v[196:199], v9, s[16:19], s76 offen offset:448 sc1
  s_waitcnt vmcnt(0)
  v_mov_b32 v12, 0
  v_mov_b32 v13, 0
  v_mov_b32 v16, 0
  v_mov_b32 v17, 0
  v_cvt_pk_bf16_f32 v14, v128, v129
  v_cvt_pk_bf16_f32 v15, v130, v131
  s_mov_b32 s80, 0xf0000
  s_mov_b32 s81, 0xf000f
  v_cndmask_b32 v4, 0, v176, s[80:81]
  s_mov_b32 s82, 0xf0000
  s_mov_b32 s83, 0xf000f
  v_cndmask_b32 v5, 0, v177, s[82:83]
  s_mov_b32 s80, 0xf000f
  s_mov_b32 s81, 0xf000f
  v_cndmask_b32 v6, 0, v178, s[80:81]
  s_mov_b32 s82, 0xf000f
  s_mov_b32 s83, 0xf000f
  v_cndmask_b32 v7, 0, v179, s[82:83]
  v_cvt_pk_bf16_f32 v18, v4, v5
  v_cvt_pk_bf16_f32 v19, v6, v7
  ds_write_b128 v8, v[12:15] offset:8192
  ds_write_b128 v8, v[16:19] offset:9216
  v_cvt_pk_bf16_f32 v20, v132, v133
  v_cvt_pk_bf16_f32 v21, v134, v135
  s_mov_b32 s80, 0xfff0000f
  s_mov_b32 s81, 0xfff0fff0
  v_cndmask_b32 v4, 0, v180, s[80:81]
  s_mov_b32 s82, 0xfff0000f
  s_mov_b32 s83, 0xfff0fff0
  v_cndmask_b32 v5, 0, v181, s[82:83]
  s_mov_b32 s80, 0xfff0000f
  s_mov_b32 s81, 0xfff0fff0
  v_cndmask_b32 v6, 0, v182, s[80:81]
  s_mov_b32 s82, 0xfff0000f
  s_mov_b32 s83, 0xfff0fff0
  v_cndmask_b32 v7, 0, v183, s[82:83]
  v_cvt_pk_bf16_f32 v24, v4, v5
  v_cvt_pk_bf16_f32 v25, v6, v7
  v_cvt_pk_bf16_f32 v22, v136, v137
  v_cvt_pk_bf16_f32 v23, v138, v139
  s_mov_b32 s80, 0xfff0fff0
  s_mov_b32 s81, 0x0
  v_cndmask_b32 v4, 0, v184, s[80:81]
  s_mov_b32 s82, 0xfff0fff0
  s_mov_b32 s83, 0x0
  v_cndmask_b32 v5, 0, v185, s[82:83]
  s_mov_b32 s80, 0xfff0
  s_mov_b32 s81, 0x0
  v_cndmask_b32 v6, 0, v186, s[80:81]
  s_mov_b32 s82, 0xfff0
  s_mov_b32 s83, 0x0
  v_cndmask_b32 v7, 0, v187, s[82:83]
  v_cvt_pk_bf16_f32 v26, v4, v5
  v_cvt_pk_bf16_f32 v27, v6, v7
  ds_write_b128 v8, v[20:23] offset:10240
  ds_write_b128 v8, v[24:27] offset:11264
  v_mov_b32 v28, 0
  v_mov_b32 v29, 0
  v_mov_b32 v32, 0
  v_mov_b32 v33, 0
  v_cvt_pk_bf16_f32 v30, v140, v141
  v_cvt_pk_bf16_f32 v31, v142, v143
  s_mov_b32 s80, 0x0
  s_mov_b32 s81, 0xfff0000
  v_cndmask_b32 v4, 0, v188, s[80:81]
  s_mov_b32 s82, 0x0
  s_mov_b32 s83, 0xfff0000
  v_cndmask_b32 v5, 0, v189, s[82:83]
  s_mov_b32 s80, 0x0
  s_mov_b32 s81, 0xfff0fff
  v_cndmask_b32 v6, 0, v190, s[80:81]
  s_mov_b32 s82, 0x0
  s_mov_b32 s83, 0xfff0fff
  v_cndmask_b32 v7, 0, v191, s[82:83]
  v_cvt_pk_bf16_f32 v34, v4, v5
  v_cvt_pk_bf16_f32 v35, v6, v7
  ds_write_b128 v8, v[28:31] offset:24576
  ds_write_b128 v8, v[32:35] offset:25600
  v_cvt_pk_bf16_f32 v36, v144, v145
  v_cvt_pk_bf16_f32 v37, v146, v147
  s_mov_b32 s80, 0xfff0fff
  s_mov_b32 s81, 0xf0000fff
  v_cndmask_b32 v4, 0, v192, s[80:81]
  s_mov_b32 s82, 0xfff0fff
  s_mov_b32 s83, 0xf0000fff
  v_cndmask_b32 v5, 0, v193, s[82:83]
  s_mov_b32 s80, 0xfff0fff
  s_mov_b32 s81, 0xf0000fff
  v_cndmask_b32 v6, 0, v194, s[80:81]
  s_mov_b32 s82, 0xfff0fff
  s_mov_b32 s83, 0xf0000fff
  v_cndmask_b32 v7, 0, v195, s[82:83]
  v_cvt_pk_bf16_f32 v40, v4, v5
  v_cvt_pk_bf16_f32 v41, v6, v7
  v_cvt_pk_bf16_f32 v38, v148, v149
  v_cvt_pk_bf16_f32 v39, v150, v151
  s_mov_b32 s80, 0xf000f000
  s_mov_b32 s81, 0xf000f000
  v_cndmask_b32 v4, 0, v196, s[80:81]
  s_mov_b32 s82, 0xf000f000
  s_mov_b32 s83, 0xf000f000
  v_cndmask_b32 v5, 0, v197, s[82:83]
  s_mov_b32 s80, 0xf000f000
  s_mov_b32 s81, 0xf000
  v_cndmask_b32 v6, 0, v198, s[80:81]
  s_mov_b32 s82, 0xf000f000
  s_mov_b32 s83, 0xf000
  v_cndmask_b32 v7, 0, v199, s[82:83]
  v_cvt_pk_bf16_f32 v42, v4, v5
  v_cvt_pk_bf16_f32 v43, v6, v7
  ds_write_b128 v8, v[36:39] offset:26624
  ds_write_b128 v8, v[40:43] offset:27648
  s_branch L_bp_done
L_bp3:
  s_add_u32 s77, s75, 7168
  buffer_load_dwordx4 v[128:131], v102, s[16:19], s77 offen sc1
  s_add_u32 s77, s75, 9216
  buffer_load_dwordx4 v[132:135], v102, s[16:19], s77 offen sc1
  s_add_u32 s77, s75, 11264
  buffer_load_dwordx4 v[136:139], v102, s[16:19], s77 offen sc1
  s_add_u32 s77, s75, 19456
  buffer_load_dwordx4 v[140:143], v102, s[16:19], s77 offen sc1
  s_add_u32 s77, s75, 21504
  buffer_load_dwordx4 v[144:147], v102, s[16:19], s77 offen sc1
  s_add_u32 s77, s75, 23552
  buffer_load_dwordx4 v[148:151], v102, s[16:19], s77 offen sc1
  buffer_load_dwordx4 v[176:179], v9, s[16:19], s76 offen offset:128 sc1
  buffer_load_dwordx4 v[180:183], v9, s[16:19], s76 offen offset:192 sc1
  buffer_load_dwordx4 v[184:187], v9, s[16:19], s76 offen offset:256 sc1
  buffer_load_dwordx4 v[188:191], v9, s[16:19], s76 offen offset:384 sc1
  buffer_load_dwordx4 v[192:195], v9, s[16:19], s76 offen offset:448 sc1
  buffer_load_dwordx4 v[196:199], v9, s[16:19], s76 offen offset:512 sc1
  s_waitcnt vmcnt(0)
  v_cvt_pk_bf16_f32 v12, v128, v129
  v_cvt_pk_bf16_f32 v13, v130, v131
  s_mov_b32 s80, 0x3f0000
  s_mov_b32 s81, 0x3f003f
  v_cndmask_b32 v4, 0, v176, s[80:81]
  s_mov_b32 s82, 0x3f0000
  s_mov_b32 s83, 0x3f003f
  v_cndmask_b32 v5, 0, v177, s[82:83]
  s_mov_b32 s80, 0x3f0000
  s_mov_b32 s81, 0x3f003f
  v_cndmask_b32 v6, 0, v178, s[80:81]
  s_mov_b32 s82, 0x3f0000
  s_mov_b32 s83, 0x3f003f
  v_cndmask_b32 v7, 0, v179, s[82:83]
  v_cvt_pk_bf16_f32 v16, v4, v5
  v_cvt_pk_bf16_f32 v17, v6, v7
  v_cvt_pk_bf16_f32 v14, v132, v133
  v_cvt_pk_bf16_f32 v15, v134, v135
  s_mov_b32 s80, 0x3f003f
  s_mov_b32 s81, 0xffc0ffc0
  v_cndmask_b32 v4, 0, v180, s[80:81]
  s_mov_b32 s82, 0x3f003f
  s_mov_b32 s83, 0xffc0ffc0
  v_cndmask_b32 v5, 0, v181, s[82:83]
  s_mov_b32 s80, 0xffc0003f
  s_mov_b32 s81, 0xffc0ffc0
  v_cndmask_b32 v6, 0, v182, s[80:81]
  s_mov_b32 s82, 0xffc0003f
  s_mov_b32 s83, 0xffc0ffc0
  v_cndmask_b32 v7, 0, v183, s[82:83]
  v_cvt_pk_bf16_f32 v18, v4, v5
  v_cvt_pk_bf16_f32 v19, v6, v7
  ds_write_b128 v8, v[12:15] offset:12288
  ds_write_b128 v8, v[16:19] offset:13312
  v_cvt_pk_bf16_f32 v20, v136, v137
  v_cvt_pk_bf16_f32 v21, v138, v139
  s_mov_b32 s80, 0xffc0ffc0
  s_mov_b32 s81, 0x0
  v_cndmask_b32 v4, 0, v184, s[80:81]
  s_mov_b32 s82, 0xffc0ffc0
  s_mov_b32 s83, 0x0
  v_cndmask_b32 v5, 0, v185, s[82:83]
  s_mov_b32 s80, 0xffc0ffc0
  s_mov_b32 s81, 0x0
  v_cndmask_b32 v6, 0, v186, s[80:81]
  s_mov_b32 s82, 0xffc0ffc0
  s_mov_b32 s83, 0x0
  v_cndmask_b32 v7, 0, v187, s[82:83]
  v_cvt_pk_bf16_f32 v24, v4, v5
  v_cvt_pk_bf16_f32 v25, v6, v7
  v_mov_b32 v22, 0
  v_mov_b32 v23, 0
  v_mov_b32 v26, 0
  v_mov_b32 v27, 0
  ds_write_b128 v8, v[20:23] offset:14336
  ds_write_b128 v8, v[24:27] offset:15360
  v_cvt_pk_bf16_f32 v28, v140, v141
  v_cvt_pk_bf16_f32 v29, v142, v143
  s_mov_b32 s80, 0x0
  s_mov_b32 s81, 0x3fff0000
  v_cndmask_b32 v4, 0, v188, s[80:81]
  s_mov_b32 s82, 0x0
  s_mov_b32 s83, 0x3fff0000
  v_cndmask_b32 v5, 0, v189, s[82:83]
  s_mov_b32 s80, 0x0
  s_mov_b32 s81, 0x3fff0000
  v_cndmask_b32 v6, 0, v190, s[80:81]
  s_mov_b32 s82, 0x0
  s_mov_b32 s83, 0x3fff0000
  v_cndmask_b32 v7, 0, v191, s[82:83]
  v_cvt_pk_bf16_f32 v32, v4, v5
  v_cvt_pk_bf16_f32 v33, v6, v7
  v_cvt_pk_bf16_f32 v30, v144, v145
  v_cvt_pk_bf16_f32 v31, v146, v147
  s_mov_b32 s80, 0x3fff3fff
  s_mov_b32 s81, 0x3fff3fff
  v_cndmask_b32 v4, 0, v192, s[80:81]
  s_mov_b32 s82, 0x3fff3fff
  s_mov_b32 s83, 0x3fff3fff
  v_cndmask_b32 v5, 0, v193, s[82:83]
  s_mov_b32 s80, 0x3fff3fff
  s_mov_b32 s81, 0xc0003fff
  v_cndmask_b32 v6, 0, v194, s[80:81]
  s_mov_b32 s82, 0x3fff3fff
  s_mov_b32 s83, 0xc0003fff
  v_cndmask_b32 v7, 0, v195, s[82:83]
  v_cvt_pk_bf16_f32 v34, v4, v5
  v_cvt_pk_bf16_f32 v35, v6, v7
  ds_write_b128 v8, v[28:31] offset:28672
  ds_write_b128 v8, v[32:35] offset:29696
  v_cvt_pk_bf16_f32 v36, v148, v149
  v_cvt_pk_bf16_f32 v37, v150, v151
  s_mov_b32 s80, 0xc000c000
  s_mov_b32 s81, 0xc000c000
  v_cndmask_b32 v4, 0, v196, s[80:81]
  s_mov_b32 s82, 0xc000c000
  s_mov_b32 s83, 0xc000c000
  v_cndmask_b32 v5, 0, v197, s[82:83]
  s_mov_b32 s80, 0xc000c000
  s_mov_b32 s81, 0xc000c000
  v_cndmask_b32 v6, 0, v198, s[80:81]
  s_mov_b32 s82, 0xc000c000
  s_mov_b32 s83, 0xc000c000
  v_cndmask_b32 v7, 0, v199, s[82:83]
  v_cvt_pk_bf16_f32 v40, v4, v5
  v_cvt_pk_bf16_f32 v41, v6, v7
  v_mov_b32 v38, 0
  v_mov_b32 v39, 0
  v_mov_b32 v42, 0
  v_mov_b32 v43, 0
  ds_write_b128 v8, v[36:39] offset:30720
  ds_write_b128 v8, v[40:43] offset:31744
L_bp_done:
  s_waitcnt lgkmcnt(0)
  s_barrier
  s_cmp_eq_u32 s72, 3
  s_cbranch_scc1 L_fin
  s_mul_i32 s67, s70, 192
  v_add_u32 v7, s67, v1
  v_add_u32 v8, 0, v7
  s_mov_b32 s67, 178956971
  v_mul_hi_u32 v9, v8, s67
  v_mul_u32_u24 v10, 24, v9
  v_sub_u32 v10, v8, v10
  v_bfe_u32 v8, v9, 1, 1
  v_lshlrev_b32 v8, 2, v8
  v_xor_b32 v10, v10, v8
  v_mul_u32_u24 v24, 1152, v9
  v_lshl_add_u32 v24, v10, 4, v24
  v_add_u32 v8, 64, v7
  s_mov_b32 s67, 178956971
  v_mul_hi_u32 v9, v8, s67
  v_mul_u32_u24 v10, 24, v9
  v_sub_u32 v10, v8, v10
  v_bfe_u32 v8, v9, 1, 1
  v_lshlrev_b32 v8, 2, v8
  v_xor_b32 v10, v10, v8
  v_mul_u32_u24 v25, 1152, v9
  v_lshl_add_u32 v25, v10, 4, v25
  v_subrev_u32 v25, 1024, v25
  v_add_u32 v8, 128, v7
  s_mov_b32 s67, 178956971
  v_mul_hi_u32 v9, v8, s67
  v_mul_u32_u24 v10, 24, v9
  v_sub_u32 v10, v8, v10
  v_bfe_u32 v8, v9, 1, 1
  v_lshlrev_b32 v8, 2, v8
  v_xor_b32 v10, v10, v8
  v_mul_u32_u24 v26, 1152, v9
  v_lshl_add_u32 v26, v10, 4, v26
  v_subrev_u32 v26, 2048, v26
  s_mul_i32 s73, s70, 3072
  s_lshl_b32 s74, s70, 11
  s_mul_i32 s63, s72, 166272
  s_mov_b32 s79, 0
  s_mul_i32 s65, s72, 384
  s_add_u32 s65, s65, 663552
  s_lshl_b32 s64, s71, 13
  s_add_u32 s64, s64, s74
  s_add_u32 s64, s64, 10027008
  s_mul_i32 s62, s72, 655360
  s_add_u32 s62, s62, s64
  s_add_u32 s64, s64, 2621440
  s_add_u32 s74, s74, 12288
  s_mov_b32 s76, 18432
  s_mov_b32 s77, 36864
  s_mov_b32 s60, 0
  s_barrier
  s_add_u32 m0, s60, s73
  s_add_u32 s79, s79, 1
  buffer_load_dwordx4 v24, s[32:35], s63 offen lds
  buffer_load_dwordx4 v25, s[32:35], s63 offen offset:1024 lds
  buffer_load_dwordx4 v26, s[32:35], s63 offen offset:2048 lds
  s_cmp_eq_u32 s79, 5
  s_cselect_b32 s79, 0, s79
  s_cselect_b32 s67, s76, s77
  s_add_u32 s63, s63, s67
  s_cmp_eq_u32 s63, s65
  s_cselect_b32 s67, 663552, 0
  s_sub_u32 s63, s63, s67
  s_add_u32 s60, s60, 20480
  s_cmp_eq_u32 s60, 102400
  s_cselect_b32 s60, 0, s60
  s_add_u32 m0, s60, s73
  s_add_u32 s79, s79, 1
  buffer_load_dwordx4 v24, s[32:35], s63 offen lds
  buffer_load_dwordx4 v25, s[32:35], s63 offen offset:1024 lds
  buffer_load_dwordx4 v26, s[32:35], s63 offen offset:2048 lds
  s_cmp_eq_u32 s79, 5
  s_cselect_b32 s79, 0, s79
  s_cselect_b32 s67, s76, s77
  s_add_u32 s63, s63, s67
  s_cmp_eq_u32 s63, s65
  s_cselect_b32 s67, 663552, 0
  s_sub_u32 s63, s63, s67
  s_add_u32 s60, s60, 20480
  s_cmp_eq_u32 s60, 102400
  s_cselect_b32 s60, 0, s60
  s_add_u32 m0, s60, s73
  s_add_u32 s79, s79, 1
  buffer_load_dwordx4 v24, s[32:35], s63 offen lds
  buffer_load_dwordx4 v25, s[32:35], s63 offen offset:1024 lds
  buffer_load_dwordx4 v26, s[32:35], s63 offen offset:2048 lds
  s_cmp_eq_u32 s79, 5
  s_cselect_b32 s79, 0, s79
  s_cselect_b32 s67, s76, s77
  s_add_u32 s63, s63, s67
  s_cmp_eq_u32 s63, s65
  s_cselect_b32 s67, 663552, 0
  s_sub_u32 s63, s63, s67
  s_add_u32 s60, s60, 20480
  s_cmp_eq_u32 s60, 102400
  s_cselect_b32 s60, 0, s60
  s_add_u32 m0, s60, s73
  s_add_u32 s79, s79, 1
  buffer_load_dwordx4 v24, s[32:35], s63 offen lds
  buffer_load_dwordx4 v25, s[32:35], s63 offen offset:1024 lds
  buffer_load_dwordx4 v26, s[32:35], s63 offen offset:2048 lds
  s_cmp_eq_u32 s79, 5
  s_cselect_b32 s79, 0, s79
  s_cselect_b32 s67, s76, s77
  s_add_u32 s63, s63, s67
  s_cmp_eq_u32 s63, s65
  s_cselect_b32 s67, 663552, 0
  s_sub_u32 s63, s63, s67
  s_add_u32 s60, s60, 20480
  s_cmp_eq_u32 s60, 102400
  s_cselect_b32 s60, 0, s60
  s_add_u32 m0, s60, s73
  s_add_u32 s79, s79, 1
  buffer_load_dwordx4 v24, s[32:35], s63 offen lds
  buffer_load_dwordx4 v25, s[32:35], s63 offen offset:1024 lds
  buffer_load_dwordx4 v26, s[32:35], s63 offen offset:2048 lds
  s_cmp_eq_u32 s79, 5
  s_cselect_b32 s79, 0, s79
  s_cselect_b32 s67, s76, s77
  s_add_u32 s63, s63, s67
  s_cmp_eq_u32 s63, s65
  s_cselect_b32 s67, 663552, 0
  s_sub_u32 s63, s63, s67
  s_add_u32 s60, s60, 20480
  s_cmp_eq_u32 s60, 102400
  s_cselect_b32 s60, 0, s60
  v_mov_b32 v40, 163816
  s_mov_b32 s68, 0x80000
L_pj_own:
  ds_read_b32 v41, v40
  s_sub_u32 s68, s68, 1
  s_cmp_eq_u32 s68, 0
  s_cbranch_scc1 L_pj_own_x
  s_waitcnt lgkmcnt(0)
  v_readfirstlane_b32 s67, v41
  s_cmp_ge_u32 s67, 4
  s_cbranch_scc1 L_pj_own_x
  s_sleep 1
  s_branch L_pj_own
L_pj_own_x:
  s_waitcnt lgkmcnt(0)
  s_add_u32 m0, s60, s74
  s_nop 0
  buffer_load_dwordx4 v102, s[16:19], s62 offen sc1 lds
  buffer_load_dwordx4 v102, s[16:19], s62 offen offset:1024 sc1 lds
  s_add_u32 s62, s62, 131072
  s_cmp_eq_u32 s62, s64
  s_cselect_b32 s67, 2621440, 0
  s_sub_u32 s62, s62, s67
  s_add_u32 s60, s60, 20480
  s_cmp_eq_u32 s60, 102400
  s_cselect_b32 s60, 0, s60
  s_add_u32 m0, s60, s74
  s_nop 0
  buffer_load_dwordx4 v102, s[16:19], s62 offen sc1 lds
  buffer_load_dwordx4 v102, s[16:19], s62 offen offset:1024 sc1 lds
  s_add_u32 s62, s62, 131072
  s_cmp_eq_u32 s62, s64
  s_cselect_b32 s67, 2621440, 0
  s_sub_u32 s62, s62, s67
  s_add_u32 s60, s60, 20480
  s_cmp_eq_u32 s60, 102400
  s_cselect_b32 s60, 0, s60
  s_add_u32 m0, s60, s74
  s_nop 0
  buffer_load_dwordx4 v102, s[16:19], s62 offen sc1 lds
  buffer_load_dwordx4 v102, s[16:19], s62 offen offset:1024 sc1 lds
  s_add_u32 s62, s62, 131072
  s_cmp_eq_u32 s62, s64
  s_cselect_b32 s67, 2621440, 0
  s_sub_u32 s62, s62, s67
  s_add_u32 s60, s60, 20480
  s_cmp_eq_u32 s60, 102400
  s_cselect_b32 s60, 0, s60
  s_add_u32 m0, s60, s74
  s_nop 0
  buffer_load_dwordx4 v102, s[16:19], s62 offen sc1 lds
  buffer_load_dwordx4 v102, s[16:19], s62 offen offset:1024 sc1 lds
  s_add_u32 s62, s62, 131072
  s_cmp_eq_u32 s62, s64
  s_cselect_b32 s67, 2621440, 0
  s_sub_u32 s62, s62, s67
  s_add_u32 s60, s60, 20480
  s_cmp_eq_u32 s60, 102400
  s_cselect_b32 s60, 0, s60
  s_add_u32 m0, s60, s74
  s_nop 0
  buffer_load_dwordx4 v102, s[16:19], s62 offen sc1 lds
  buffer_load_dwordx4 v102, s[16:19], s62 offen offset:1024 sc1 lds
  s_add_u32 s62, s62, 131072
  s_cmp_eq_u32 s62, s64
  s_cselect_b32 s67, 2621440, 0
  s_sub_u32 s62, s62, s67
  s_add_u32 s60, s60, 20480
  s_cmp_eq_u32 s60, 102400
  s_cselect_b32 s60, 0, s60
  s_waitcnt vmcnt(8)
  s_barrier
  s_cmp_lg_u32 s3, 5
  s_cbranch_scc1 L_pj_g
  s_lshl_b32 s83, s71, 9
  s_add_u32 s83, s83, 27688960
  s_mov_b64 s[84:85], 15
  v_and_b32 v41, 3, v1
  v_lshlrev_b32 v41, 7, v41
  s_mov_b32 s68, 0x8000
L_pj_p:
  buffer_load_dword v40, v41, s[16:19], s83 offen sc1
  s_waitcnt vmcnt(0)
  v_xor_b32 v40, s54, v40
  v_cmp_ne_u32 vcc, 0, v40
  s_sub_u32 s68, s68, 1
  s_cmp_eq_u32 s68, 0
  s_cbranch_scc1 L_pj_p_x
  s_and_b64 vcc, vcc, s[84:85]
  s_cbranch_scc0 L_pj_p_x
  s_sleep 2
  s_branch L_pj_p
L_pj_p_x:
L_pj_g:
  s_waitcnt vmcnt(6)
  s_barrier
  s_add_u32 m0, s60, s73
  s_add_u32 s79, s79, 1
  buffer_load_dwordx4 v24, s[32:35], s63 offen lds
  buffer_load_dwordx4 v25, s[32:35], s63 offen offset:1024 lds
  buffer_load_dwordx4 v26, s[32:35], s63 offen offset:2048 lds
  s_cmp_eq_u32 s79, 5
  s_cselect_b32 s79, 0, s79
  s_cselect_b32 s67, s76, s77
  s_add_u32 s63, s63, s67
  s_cmp_eq_u32 s63, s65
  s_cselect_b32 s67, 663552, 0
  s_sub_u32 s63, s63, s67
  s_add_u32 m0, s60, s74
  s_nop 0
  buffer_load_dwordx4 v102, s[16:19], s62 offen sc1 lds
  buffer_load_dwordx4 v102, s[16:19], s62 offen offset:1024 sc1 lds
  s_add_u32 s62, s62, 131072
  s_cmp_eq_u32 s62, s64
  s_cselect_b32 s67, 2621440, 0
  s_sub_u32 s62, s62, s67
  s_add_u32 s60, s60, 20480
  s_cmp_eq_u32 s60, 102400
  s_cselect_b32 s60, 0, s60
  s_waitcnt vmcnt(9)
  s_barrier
  s_add_u32 m0, s60, s73
  s_add_u32 s79, s79, 1
  buffer_load_dwordx4 v24, s[32:35], s63 offen lds
  buffer_load_dwordx4 v25, s[32:35], s63 offen offset:1024 lds
  buffer_load_dwordx4 v26, s[32:35], s63 offen offset:2048 lds
  s_cmp_eq_u32 s79, 5
  s_cselect_b32 s79, 0, s79
  s_cselect_b32 s67, s76, s77
  s_add_u32 s63, s63, s67
  s_cmp_eq_u32 s63, s65
  s_cselect_b32 s67, 663552, 0
  s_sub_u32 s63, s63, s67
  s_add_u32 m0, s60, s74
  s_nop 0
  buffer_load_dwordx4 v102, s[16:19], s62 offen sc1 lds
  buffer_load_dwordx4 v102, s[16:19], s62 offen offset:1024 sc1 lds
  s_add_u32 s62, s62, 131072
  s_cmp_eq_u32 s62, s64
  s_cselect_b32 s67, 2621440, 0
  s_sub_u32 s62, s62, s67
  s_add_u32 s60, s60, 20480
  s_cmp_eq_u32 s60, 102400
  s_cselect_b32 s60, 0, s60
  s_waitcnt vmcnt(12)
  s_barrier
  s_add_u32 m0, s60, s73
  s_add_u32 s79, s79, 1
  buffer_load_dwordx4 v24, s[32:35], s63 offen lds
  buffer_load_dwordx4 v25, s[32:35], s63 offen offset:1024 lds
  buffer_load_dwordx4 v26, s[32:35], s63 offen offset:2048 lds
  s_cmp_eq_u32 s79, 5
  s_cselect_b32 s79, 0, s79
  s_cselect_b32 s67, s76, s77
  s_add_u32 s63, s63, s67
  s_cmp_eq_u32 s63, s65
  s_cselect_b32 s67, 663552, 0
  s_sub_u32 s63, s63, s67
  s_add_u32 m0, s60, s74
  s_nop 0
  buffer_load_dwordx4 v102, s[16:19], s62 offen sc1 lds
  buffer_load_dwordx4 v102, s[16:19], s62 offen offset:1024 sc1 lds
  s_add_u32 s62, s62, 131072
  s_cmp_eq_u32 s62, s64
  s_cselect_b32 s67, 2621440, 0
  s_sub_u32 s62, s62, s67
  s_add_u32 s60, s60, 20480
  s_cmp_eq_u32 s60, 102400
  s_cselect_b32 s60, 0, s60
  s_waitcnt vmcnt(15)
  s_barrier
  s_add_u32 m0, s60, s73
  s_add_u32 s79, s79, 1
  buffer_load_dwordx4 v24, s[32:35], s63 offen lds
  buffer_load_dwordx4 v25, s[32:35], s63 offen offset:1024 lds
  buffer_load_dwordx4 v26, s[32:35], s63 offen offset:2048 lds
  s_cmp_eq_u32 s79, 5
  s_cselect_b32 s79, 0, s79
  s_cselect_b32 s67, s76, s77
  s_add_u32 s63, s63, s67
  s_cmp_eq_u32 s63, s65
  s_cselect_b32 s67, 663552, 0
  s_sub_u32 s63, s63, s67
  s_add_u32 m0, s60, s74
  s_nop 0
  buffer_load_dwordx4 v102, s[16:19], s62 offen sc1 lds
  buffer_load_dwordx4 v102, s[16:19], s62 offen offset:1024 sc1 lds
  s_add_u32 s62, s62, 131072
  s_cmp_eq_u32 s62, s64
  s_cselect_b32 s67, 2621440, 0
  s_sub_u32 s62, s62, s67
  s_add_u32 s60, s60, 20480
  s_cmp_eq_u32 s60, 102400
  s_cselect_b32 s60, 0, s60
  s_mov_b32 s61, 11
L_pj_ld:
  s_waitcnt vmcnt(15)
  s_barrier
  s_add_u32 m0, s60, s73
  s_add_u32 s79, s79, 1
  buffer_load_dwordx4 v24, s[32:35], s63 offen lds
  buffer_load_dwordx4 v25, s[32:35], s63 offen offset:1024 lds
  buffer_load_dwordx4 v26, s[32:35], s63 offen offset:2048 lds
  s_cmp_eq_u32 s79, 5
  s_cselect_b32 s79, 0, s79
  s_cselect_b32 s67, s76, s77
  s_add_u32 s63, s63, s67
  s_cmp_eq_u32 s63, s65
  s_cselect_b32 s67, 663552, 0
  s_sub_u32 s63, s63, s67
  s_add_u32 m0, s60, s74
  s_nop 0
  buffer_load_dwordx4 v102, s[16:19], s62 offen sc1 lds
  buffer_load_dwordx4 v102, s[16:19], s62 offen offset:1024 sc1 lds
  s_add_u32 s62, s62, 131072
  s_cmp_eq_u32 s62, s64
  s_cselect_b32 s67, 2621440, 0
  s_sub_u32 s62, s62, s67
  s_add_u32 s60, s60, 20480
  s_cmp_eq_u32 s60, 102400
  s_cselect_b32 s60, 0, s60
  s_sub_u32 s61, s61, 1
  s_cmp_lg_u32 s61, 0
  s_cbranch_scc1 L_pj_ld
  s_waitcnt vmcnt(15)
  s_barrier
  s_waitcnt vmcnt(10)
  s_barrier
  s_waitcnt vmcnt(5)
  s_barrier
  s_waitcnt vmcnt(0)
  s_barrier
L_fin:
L_end:
  s_endpgm
L_code_end:
.section .rodata,"a"
.p2align 6
.amdhsa_kernel parallel_sum__linear_attn_block__mixer_token_mlp__prompt_kernel
  .amdhsa_next_free_vgpr 256
  .amdhsa_next_free_sgpr 102
  .amdhsa_accum_offset 256
  .amdhsa_group_segment_fixed_size 0
  .amdhsa_kernarg_size 88
  .amdhsa_user_sgpr_count 2
  .amdhsa_user_sgpr_kernarg_segment_ptr 1
  .amdhsa_system_sgpr_workgroup_id_x 1
  .amdhsa_float_denorm_mode_32 3
.end_amdhsa_kernel
.text
```
